```python
import torch

def _softmax(x, axis=-1):
    return torch.softmax(x, dim=axis)
def _gelu(x):
    return torch.nn.functional.gelu(x, approximate="tanh")
def _silu(x):
    return torch.nn.functional.silu(x)
def _sigmoid(x):
    return torch.sigmoid(x)
def _layernorm(x, axis=-1, eps=1e-5):
    m = x.mean(dim=axis, keepdim=True)
    v = x.var(dim=axis, keepdim=True, unbiased=False)
    return (x - m) / torch.sqrt(v + eps)
def _scatter_add(tgt, idx, src, axis=0):
    return tgt.clone().index_add_(axis, idx, src)
def _segment_sum(src, seg, n):
    out = torch.zeros((n,) + src.shape[1:], dtype=src.dtype)
    return out.index_add_(0, seg, src)
def _pad(x, pw):
    flat = tuple(v for pair in reversed(pw) for v in pair)
    return torch.nn.functional.pad(x, flat)

kernel_name = 'recurrent_scan__spectral_gfnet__dense_activation_squared_relu__prompt'

def setup_inputs():

    _w = (lambda a: (lambda t: t.to(torch.bfloat16) if t.is_floating_point() else t)(torch.as_tensor(a)))
    def _A_setup():
        B, S, D = 1, 2048, 1024
        Df = D // 2 + 1
        return {
            "x": _w((lambda *s: torch.randn(*s, dtype=torch.bfloat16) * 0.05)(B, S, D)),
            "w_r": _w((lambda *s: torch.randn(*s, dtype=torch.bfloat16) * 0.05)(S, Df) * 0.02),
            "w_i": _w((lambda *s: torch.randn(*s, dtype=torch.bfloat16) * 0.05)(S, Df) * 0.02),
        }
    _A_in = _A_setup()

    def _B_setup():
        B, S, D, F = 1, 2048, 1024, 3584
        return {
            "x": _w((lambda *s: torch.randn(*s, dtype=torch.bfloat16) * 0.05)(B, S, D)),
            "w1": _w((lambda *s: torch.randn(*s, dtype=torch.bfloat16) * 0.05)(D, F)),
            "b1": _w((lambda *s: torch.randn(*s, dtype=torch.bfloat16) * 0.4)(F)),
            "w2": _w((lambda *s: torch.randn(*s, dtype=torch.bfloat16) * 0.05)(F, D)),
            "b2": _w((lambda *s: torch.randn(*s, dtype=torch.bfloat16) * 3.2)(D)),
        }
    _B_in = _B_setup()

    return {
        "A_x": _A_in["x"],
        "A_w_r": _A_in["w_r"],
        "A_w_i": _A_in["w_i"],
        "B_x": _B_in["x"],
        "B_w1": _B_in["w1"],
        "B_b1": _B_in["b1"],
        "B_w2": _B_in["w2"],
        "B_b2": _B_in["b2"],
    }

def reference(A_x, A_w_r, A_w_i, B_x, B_w1, B_b1, B_w2, B_b2):
    def _A_ref(x, w_r, w_i):
        B, S, D = x.shape
        X = (lambda x, axes=(-2,-1): torch.fft.rfft2(x.float(), dim=axes))(x, axes=(-2, -1))
        W = w_r + 1j * w_i
        X = X * W
        y = (lambda x, s, axes=(-2,-1): torch.fft.irfft2(x, s=s, dim=axes).to(torch.bfloat16))(X, (S, D), axes=(-2, -1))
        return y

    def _B_ref(x, w1, b1, w2, b2):
        h = torch.einsum("bsd,df->bsf", x, w1) + b1
        zero = torch.zeros_like(h)
        r = torch.where(h > zero, h, zero)
        h = r * r
        out = torch.einsum("bsf,fd->bsd", h, w2) + b2
        return out

    x = A_x
    xn = _layernorm(x, axis=-1)
    s = _A_ref(xn, A_w_r, A_w_i)
    g = _silu(_B_ref(xn, B_w1, B_b1, B_w2, B_b2))
    return x + s * g
```

```asm
; @launch kernel=fused_kernel grid=(256,1,1) block=(512,1,1) lds=163840
.amdgcn_target "amdgcn-amd-amdhsa--gfx950"
.text
.globl fused_kernel
.p2align 8
.type fused_kernel,@function
fused_kernel:
  s_cmp_ge_u32 s2, 256
  s_cbranch_scc1 f_exit
  s_load_dwordx16 s[60:75], s[0:1], 0
  s_load_dwordx4 s[52:55], s[0:1], 64
  s_load_dwordx2 s[50:51], s[0:1], 80
  v_lshrrev_b32 v1, 6, v0
  v_and_b32 v0, 63, v0
  s_lshr_b32 s6, s2, 3
  v_readfirstlane_b32 s5, v1
  s_nop 1
  s_cmp_lg_u32 s5, 7
  s_cbranch_scc1 f_noct
  s_getpc_b64 s[28:29]
f_pc:
  s_sub_u32 s28, s28, f_pc-fused_kernel
  s_subb_u32 s29, s29, 0
  s_and_b32 s30, s6, 3
  s_lshl_b32 s30, s30, 4
  s_mul_i32 s31, s6, 16
  s_add_u32 s31, s31, 48
  v_mov_b32 v190, s31
  v_mov_b32 v191, s30
  v_cmp_gt_u32 vcc, 16, v0
  s_nop 1
  v_cndmask_b32 v190, v190, v191, vcc
  v_add_lshl_u32 v190, v190, v0, 7
  v_min_u32 v190, f_exit-fused_kernel, v190
  s_mov_b32 exec_hi, 0
  global_load_dword v190, v190, s[28:29]
  s_mov_b32 exec_hi, -1
f_noct:
  s_and_b32 s7, s2, 7
  s_and_b32 s44, s7, 1
  s_lshr_b32 s3, s7, 1
  s_lshl_b32 s3, s3, 2
  s_lshr_b32 s7, s6, 3
  s_add_u32 s3, s3, s7
  s_and_b32 s4, s6, 7
  s_lshl_b32 s4, s4, 1
  s_add_u32 s4, s4, s44
  s_lshl_b32 s2, s3, 4
  s_add_u32 s2, s2, s4
  s_lshr_b32 s45, s4, 1
  s_mov_b32 s46, s45
  s_cmp_ge_u32 s4, 14
  s_cselect_b32 s47, 1, 0
  s_cmp_ge_u32 s5, 4
  s_cbranch_scc1 f_hi
  s_setprio 2
  v_lshlrev_b32 v1, 4, v0
  s_lshl_b32 s28, s5, 8
  s_add_u32 s28, s28, s2
  s_lshl_b32 s28, s28, 11
  s_add_u32 s29, s28, 2097152
  s_lshl_b32 s33, s5, 11
  s_add_u32 s33, s33, 147456
  s_mov_b32 m0, s33
  s_waitcnt lgkmcnt(0)
  s_mov_b32 s16, s60
  s_and_b32 s17, s61, 0xffff
  s_mov_b32 s18, 0x400000
  s_mov_b32 s19, 0x20000
  buffer_load_dwordx4 v1, s[16:19], s28 offen offset:0 lds
  buffer_load_dwordx4 v1, s[16:19], s28 offen offset:1024 lds
  s_add_u32 m0, s33, 8192
  s_nop 0
  buffer_load_dwordx4 v1, s[16:19], s29 offen offset:0 lds
  buffer_load_dwordx4 v1, s[16:19], s29 offen offset:1024 lds
  s_cmp_eq_u32 s47, 0
  s_cbranch_scc1 p1_nomid_1
  v_mov_b32 v198, 146432
  v_mov_b32 v199, 0
  ds_write_b32 v198, v199
  s_waitcnt lgkmcnt(0)
  s_barrier
p1_nomid_1:
  s_mov_b32 s56, s50
  s_and_b32 s57, s51, 0xffff
  s_mov_b32 s58, 0x3800000
  s_mov_b32 s59, 0x20000
  v_lshrrev_b32 v92, 5, v0
  v_and_b32 v93, 31, v0
  v_cvt_f32_u32 v92, v92
  v_cvt_f32_u32 v94, v93
  v_mul_f32 v94, 0x3d000000, v94
  v_mul_f32 v95, 0x41000000, v92
  v_mul_f32 v95, v95, v94
  v_lshlrev_b32 v96, 31, v0
  v_lshrrev_b32 v97, 16, v96
  v_or_b32 v96, v96, v97
  v_fmamk_f32 v156, v94, 0x00000000, v95
  v_fmamk_f32 v157, v94, 0x3f800000, v95
  v_cos_f32 v158, v156
  v_cos_f32 v159, v157
  v_sin_f32 v160, -v156
  v_sin_f32 v161, -v157
  v_cvt_pk_bf16_f32 v4, v158, v159
  v_cvt_pk_bf16_f32 v12, v160, v161
  v_fmamk_f32 v156, v94, 0x40000000, v95
  v_fmamk_f32 v157, v94, 0x40400000, v95
  v_cos_f32 v158, v156
  v_cos_f32 v159, v157
  v_sin_f32 v160, -v156
  v_sin_f32 v161, -v157
  v_cvt_pk_bf16_f32 v5, v158, v159
  v_cvt_pk_bf16_f32 v13, v160, v161
  v_fmamk_f32 v156, v94, 0x40800000, v95
  v_fmamk_f32 v157, v94, 0x40a00000, v95
  v_cos_f32 v158, v156
  v_cos_f32 v159, v157
  v_sin_f32 v160, -v156
  v_sin_f32 v161, -v157
  v_cvt_pk_bf16_f32 v6, v158, v159
  v_cvt_pk_bf16_f32 v14, v160, v161
  v_fmamk_f32 v156, v94, 0x40c00000, v95
  v_fmamk_f32 v157, v94, 0x40e00000, v95
  v_cos_f32 v158, v156
  v_cos_f32 v159, v157
  v_sin_f32 v160, -v156
  v_sin_f32 v161, -v157
  v_cvt_pk_bf16_f32 v7, v158, v159
  v_cvt_pk_bf16_f32 v15, v160, v161
  v_xor_b32 v8, v96, v4
  v_xor_b32 v16, v96, v12
  v_xor_b32 v9, v96, v5
  v_xor_b32 v17, v96, v13
  v_xor_b32 v10, v96, v6
  v_xor_b32 v18, v96, v14
  v_xor_b32 v11, v96, v7
  v_xor_b32 v19, v96, v15
  v_mul_f32 v98, 0x3e800000, v94
  v_mul_f32 v94, 0x3d000000, v94
  v_mul_f32 v95, 0x40800000, v92
  v_mul_f32 v95, v95, v94
  v_sin_f32 v99, -v98
  v_cos_f32 v98, v98
  v_fmamk_f32 v156, v94, 0x00000000, v95
  v_cos_f32 v36, v156
  v_sin_f32 v52, -v156
  v_fmamk_f32 v157, v94, 0x3f800000, v95
  v_cos_f32 v37, v157
  v_sin_f32 v53, -v157
  v_fmamk_f32 v156, v94, 0x40000000, v95
  v_cos_f32 v38, v156
  v_sin_f32 v54, -v156
  v_fmamk_f32 v157, v94, 0x40400000, v95
  v_cos_f32 v39, v157
  v_sin_f32 v55, -v157
  v_lshrrev_b32 v94, 1, v93
  v_lshlrev_b32 v96, 31, v94
  v_cvt_f32_u32 v94, v94
  v_lshrrev_b32 v97, 16, v96
  v_mul_f32 v94, 0x3d000000, v94
  v_or_b32 v96, v96, v97
  v_and_b32 v93, 1, v93
  v_cvt_f32_u32 v93, v93
  v_mul_f32 v95, 0x40800000, v92
  v_mul_f32 v95, v95, v94
  v_fmac_f32 v95, 0x3e800000, v93
  v_fmamk_f32 v156, v94, 0x00000000, v95
  v_pk_mul_f32 v[40:41], v[52:53], v[98:99] op_sel:[0,1] op_sel_hi:[1,1]
  v_fmamk_f32 v157, v94, 0x3f800000, v95
  v_pk_mul_f32 v[56:57], v[52:53], v[98:99] op_sel_hi:[1,0]
  v_cos_f32 v158, v156
  v_pk_fma_f32 v[40:41], v[36:37], v[98:99], v[40:41] op_sel_hi:[1,0,1] neg_lo:[0,0,1] neg_hi:[0,0,1]
  v_cos_f32 v159, v157
  v_pk_fma_f32 v[56:57], v[36:37], v[98:99], v[56:57] op_sel:[0,1,0] op_sel_hi:[1,1,1]
  v_sin_f32 v160, v156
  v_pk_mul_f32 v[42:43], v[54:55], v[98:99] op_sel:[0,1] op_sel_hi:[1,1]
  v_sin_f32 v161, v157
  v_pk_mul_f32 v[58:59], v[54:55], v[98:99] op_sel_hi:[1,0]
  v_cvt_pk_bf16_f32 v20, v158, v159
  v_pk_fma_f32 v[42:43], v[38:39], v[98:99], v[42:43] op_sel_hi:[1,0,1] neg_lo:[0,0,1] neg_hi:[0,0,1]
  v_cvt_pk_bf16_f32 v28, v160, v161
  v_pk_fma_f32 v[58:59], v[38:39], v[98:99], v[58:59] op_sel:[0,1,0] op_sel_hi:[1,1,1]
  v_fmamk_f32 v156, v94, 0x40000000, v95
  v_pk_mul_f32 v[44:45], v[56:57], v[98:99] op_sel:[0,1] op_sel_hi:[1,1]
  v_fmamk_f32 v157, v94, 0x40400000, v95
  v_pk_mul_f32 v[60:61], v[56:57], v[98:99] op_sel_hi:[1,0]
  v_cos_f32 v158, v156
  v_pk_fma_f32 v[44:45], v[40:41], v[98:99], v[44:45] op_sel_hi:[1,0,1] neg_lo:[0,0,1] neg_hi:[0,0,1]
  v_cos_f32 v159, v157
  v_pk_fma_f32 v[60:61], v[40:41], v[98:99], v[60:61] op_sel:[0,1,0] op_sel_hi:[1,1,1]
  v_sin_f32 v160, v156
  v_pk_mul_f32 v[46:47], v[58:59], v[98:99] op_sel:[0,1] op_sel_hi:[1,1]
  v_sin_f32 v161, v157
  v_pk_mul_f32 v[62:63], v[58:59], v[98:99] op_sel_hi:[1,0]
  v_cvt_pk_bf16_f32 v21, v158, v159
  v_pk_fma_f32 v[46:47], v[42:43], v[98:99], v[46:47] op_sel_hi:[1,0,1] neg_lo:[0,0,1] neg_hi:[0,0,1]
  v_cvt_pk_bf16_f32 v29, v160, v161
  v_pk_fma_f32 v[62:63], v[42:43], v[98:99], v[62:63] op_sel:[0,1,0] op_sel_hi:[1,1,1]
  v_fmamk_f32 v156, v94, 0x41000000, v95
  v_pk_mul_f32 v[48:49], v[60:61], v[98:99] op_sel:[0,1] op_sel_hi:[1,1]
  v_fmamk_f32 v157, v94, 0x41100000, v95
  v_pk_mul_f32 v[64:65], v[60:61], v[98:99] op_sel_hi:[1,0]
  v_cos_f32 v158, v156
  v_pk_fma_f32 v[48:49], v[44:45], v[98:99], v[48:49] op_sel_hi:[1,0,1] neg_lo:[0,0,1] neg_hi:[0,0,1]
  v_cos_f32 v159, v157
  v_pk_fma_f32 v[64:65], v[44:45], v[98:99], v[64:65] op_sel:[0,1,0] op_sel_hi:[1,1,1]
  v_sin_f32 v160, v156
  v_pk_mul_f32 v[50:51], v[62:63], v[98:99] op_sel:[0,1] op_sel_hi:[1,1]
  v_sin_f32 v161, v157
  v_pk_mul_f32 v[66:67], v[62:63], v[98:99] op_sel_hi:[1,0]
  v_cvt_pk_bf16_f32 v22, v158, v159
  v_pk_fma_f32 v[50:51], v[46:47], v[98:99], v[50:51] op_sel_hi:[1,0,1] neg_lo:[0,0,1] neg_hi:[0,0,1]
  v_cvt_pk_bf16_f32 v30, v160, v161
  v_pk_fma_f32 v[66:67], v[46:47], v[98:99], v[66:67] op_sel:[0,1,0] op_sel_hi:[1,1,1]
  v_fmamk_f32 v156, v94, 0x41200000, v95
  v_fmamk_f32 v157, v94, 0x41300000, v95
  v_cos_f32 v158, v156
  v_cos_f32 v159, v157
  v_sin_f32 v160, v156
  v_sin_f32 v161, v157
  v_cvt_pk_bf16_f32 v23, v158, v159
  v_cvt_pk_bf16_f32 v31, v160, v161
  v_xor_b32 v24, v96, v20
  v_xor_b32 v32, v96, v28
  v_xor_b32 v25, v96, v21
  v_xor_b32 v33, v96, v29
  v_xor_b32 v26, v96, v22
  v_xor_b32 v34, v96, v30
  v_xor_b32 v27, v96, v23
  v_xor_b32 v35, v96, v31
  v_bfe_u32 v94, v0, 1, 3
  v_cvt_f32_u32 v94, v94
  v_lshrrev_b32 v92, 4, v0
  v_lshlrev_b32 v92, 9, v92
  v_add_u32 v92, s2, v92
  v_cvt_f32_u32 v92, v92
  v_mul_f32 v92, 0x3a000000, v92
  v_mul_f32 v95, v92, v94
  v_fmac_f32 v95, 0x3e800000, v93
  v_fmamk_f32 v92, v94, 0x3e000000, v95
  v_cos_f32 v156, v95
  v_sin_f32 v157, v95
  v_cos_f32 v158, v92
  v_sin_f32 v159, v92
  v_lshrrev_b32 v160, 5, v0
  v_lshlrev_b32 v162, 9, v160
  v_bfe_u32 v161, v0, 2, 2
  v_lshl_add_u32 v162, v161, 6, v162
  v_bfe_u32 v163, v0, 4, 1
  v_lshl_add_u32 v162, v163, 5, v162
  v_and_b32 v164, 3, v0
  v_lshl_add_u32 v162, v164, 3, v162
  v_add_u32 v2, s33, v162
  v_cvt_pk_bf16_f32 v68, v156, v157
  v_cvt_pk_bf16_f32 v69, v158, v159
  v_and_b32 v162, 31, v0
  v_lshl_add_u32 v162, v160, 6, v162
  v_lshl_add_u32 v3, v162, 2, s33
  v_lshrrev_b32 v162, 4, v0
  v_lshlrev_b32 v162, 12, v162
  v_bfe_u32 v165, v0, 2, 1
  v_lshl_add_u32 v162, v165, 7, v162
  v_lshl_add_u32 v162, v164, 4, v162
  v_bfe_u32 v165, v0, 3, 1
  v_lshl_add_u32 v162, v165, 2, v162
  s_lshl_b32 s29, s5, 9
  s_add_u32 s29, s29, 147456
  v_add_u32 v72, s29, v162
  v_add_u32 v73, 64, v72
  v_add_u32 v74, 8, v72
  v_add_u32 v75, 72, v72
  s_lshl_b32 s36, s2, 3
  s_add_u32 s36, s36, s5
  s_lshl_b32 s36, s36, 3
  s_add_u32 s36, s36, 34603008
  v_bfe_u32 v156, v0, 1, 3
  v_lshlrev_b32 v70, 19, v156
  v_lshl_add_u32 v70, v160, 6, v70
  v_and_b32 v156, 1, v0
  v_lshl_add_u32 v70, v156, 5, v70
  v_lshl_add_u32 v70, v163, 4, v70
  s_and_b32 s38, s2, 15
  s_lshl_b32 s38, s38, 4
  s_lshr_b32 s32, s2, 4
  s_add_u32 s38, s38, s32
  s_lshl_b32 s38, s38, 8
  s_lshl_b32 s32, s5, 17
  s_add_u32 s38, s38, s32
  s_add_u32 s38, s38, 4194304
  s_add_u32 s39, s38, 65536
  s_mov_b32 s30, 0x3f803f80
  s_mov_b32 s31, 0xffff0000
  s_mov_b32 s34, 1
  s_mov_b32 s35, 1
  v_mov_b32 v164, 0
  v_mov_b32 v165, 0
  v_mov_b32 v176, 0
  v_mov_b32 v177, 0
  v_cmp_eq_u32 vcc, 0, v0
  s_waitcnt vmcnt(0)
  ds_read_b64_tr_b16 v[76:77], v2 offset:0
  ds_read_b64_tr_b16 v[78:79], v2 offset:256
  ds_read_b64_tr_b16 v[80:81], v2 offset:1024
  ds_read_b64_tr_b16 v[82:83], v2 offset:1280
  ds_read_b64_tr_b16 v[84:85], v2 offset:8192
  ds_read_b64_tr_b16 v[86:87], v2 offset:8448
  ds_read_b64_tr_b16 v[88:89], v2 offset:9216
  ds_read_b64_tr_b16 v[90:91], v2 offset:9472
  s_waitcnt lgkmcnt(6)
  v_mfma_f32_32x32x16_bf16 v[92:107], v[76:79], v[4:7], 0
  v_dot2_f32_bf16 v164, v76, s30, v164
  v_dot2_f32_bf16 v165, v76, v76, v165
  v_dot2_f32_bf16 v164, v77, s30, v164
  v_dot2_f32_bf16 v165, v77, v77, v165
  v_mfma_f32_32x32x16_bf16 v[124:139], v[76:79], v[12:15], 0
  v_dot2_f32_bf16 v164, v78, s30, v164
  v_dot2_f32_bf16 v165, v78, v78, v165
  v_dot2_f32_bf16 v164, v79, s30, v164
  v_dot2_f32_bf16 v165, v79, v79, v165
  s_waitcnt lgkmcnt(4)
  v_mfma_f32_32x32x16_bf16 v[92:107], v[80:83], v[8:11], v[92:107]
  v_dot2_f32_bf16 v164, v80, s30, v164
  v_dot2_f32_bf16 v165, v80, v80, v165
  v_dot2_f32_bf16 v164, v81, s30, v164
  v_dot2_f32_bf16 v165, v81, v81, v165
  v_mfma_f32_32x32x16_bf16 v[124:139], v[80:83], v[16:19], v[124:139]
  v_dot2_f32_bf16 v164, v82, s30, v164
  v_dot2_f32_bf16 v165, v82, v82, v165
  v_dot2_f32_bf16 v164, v83, s30, v164
  v_dot2_f32_bf16 v165, v83, v83, v165
  s_waitcnt lgkmcnt(2)
  v_mfma_f32_32x32x16_bf16 v[108:123], v[84:87], v[4:7], 0
  v_dot2_f32_bf16 v176, v84, s30, v176
  v_dot2_f32_bf16 v177, v84, v84, v177
  v_dot2_f32_bf16 v176, v85, s30, v176
  v_dot2_f32_bf16 v177, v85, v85, v177
  v_mfma_f32_32x32x16_bf16 v[140:155], v[84:87], v[12:15], 0
  v_dot2_f32_bf16 v176, v86, s30, v176
  v_dot2_f32_bf16 v177, v86, v86, v177
  v_dot2_f32_bf16 v176, v87, s30, v176
  v_dot2_f32_bf16 v177, v87, v87, v177
  s_waitcnt lgkmcnt(0)
  v_mfma_f32_32x32x16_bf16 v[108:123], v[88:91], v[8:11], v[108:123]
  v_dot2_f32_bf16 v176, v88, s30, v176
  v_dot2_f32_bf16 v177, v88, v88, v177
  v_dot2_f32_bf16 v176, v89, s30, v176
  v_dot2_f32_bf16 v177, v89, v89, v177
  v_mfma_f32_32x32x16_bf16 v[140:155], v[88:91], v[16:19], v[140:155]
  v_dot2_f32_bf16 v176, v90, s30, v176
  v_dot2_f32_bf16 v177, v90, v90, v177
  v_dot2_f32_bf16 v176, v91, s30, v176
  v_dot2_f32_bf16 v177, v91, v91, v177
  v_add_f32_dpp v164, v164, v164 row_shr:1 row_mask:0xf bank_mask:0xf bound_ctrl:0
  s_nop 0
  v_add_f32_dpp v176, v176, v176 row_shr:1 row_mask:0xf bank_mask:0xf bound_ctrl:0
  v_add_f32_dpp v165, v165, v165 row_shr:1 row_mask:0xf bank_mask:0xf bound_ctrl:0
  v_add_f32_dpp v177, v177, v177 row_shr:1 row_mask:0xf bank_mask:0xf bound_ctrl:0
  v_add_f32_dpp v164, v164, v164 row_shr:2 row_mask:0xf bank_mask:0xf bound_ctrl:0
  v_add_f32_dpp v176, v176, v176 row_shr:2 row_mask:0xf bank_mask:0xf bound_ctrl:0
  v_add_f32_dpp v165, v165, v165 row_shr:2 row_mask:0xf bank_mask:0xf bound_ctrl:0
  v_add_f32_dpp v177, v177, v177 row_shr:2 row_mask:0xf bank_mask:0xf bound_ctrl:0
  v_add_f32_dpp v164, v164, v164 row_shr:4 row_mask:0xf bank_mask:0xf bound_ctrl:0
  v_add_f32_dpp v176, v176, v176 row_shr:4 row_mask:0xf bank_mask:0xf bound_ctrl:0
  v_add_f32_dpp v165, v165, v165 row_shr:4 row_mask:0xf bank_mask:0xf bound_ctrl:0
  v_add_f32_dpp v177, v177, v177 row_shr:4 row_mask:0xf bank_mask:0xf bound_ctrl:0
  v_add_f32_dpp v164, v164, v164 row_shr:8 row_mask:0xf bank_mask:0xf bound_ctrl:0
  v_add_f32_dpp v176, v176, v176 row_shr:8 row_mask:0xf bank_mask:0xf bound_ctrl:0
  v_add_f32_dpp v165, v165, v165 row_shr:8 row_mask:0xf bank_mask:0xf bound_ctrl:0
  v_add_f32_dpp v177, v177, v177 row_shr:8 row_mask:0xf bank_mask:0xf bound_ctrl:0
  v_add_f32_dpp v164, v164, v164 row_bcast:15 row_mask:0xa bank_mask:0xf
  v_add_f32_dpp v176, v176, v176 row_bcast:15 row_mask:0xa bank_mask:0xf
  v_add_f32_dpp v165, v165, v165 row_bcast:15 row_mask:0xa bank_mask:0xf
  v_add_f32_dpp v177, v177, v177 row_bcast:15 row_mask:0xa bank_mask:0xf
  v_add_f32_dpp v164, v164, v164 row_bcast:31 row_mask:0xc bank_mask:0xf
  v_add_f32_dpp v176, v176, v176 row_bcast:31 row_mask:0xc bank_mask:0xf
  v_add_f32_dpp v165, v165, v165 row_bcast:31 row_mask:0xc bank_mask:0xf
  v_add_f32_dpp v177, v177, v177 row_bcast:31 row_mask:0xc bank_mask:0xf
  v_readlane_b32 s40, v164, 63
  v_readlane_b32 s41, v165, 63
  v_readlane_b32 s42, v176, 63
  v_readlane_b32 s43, v177, 63
  v_mov_b32 v164, 0x3a800000
  v_pk_add_f32 v[158:159], v[92:93], v[94:95]
  v_mov_b32 v176, 0x3a800000
  v_pk_add_f32 v[170:171], v[108:109], v[110:111]
  v_mul_f32 v166, s41, v164
  v_pk_add_f32 v[158:159], v[158:159], v[96:97]
  v_mul_f32 v178, s43, v176
  v_pk_add_f32 v[170:171], v[170:171], v[112:113]
  v_mul_f32 v164, s40, v164
  v_pk_add_f32 v[158:159], v[158:159], v[98:99]
  v_mul_f32 v176, s42, v176
  v_pk_add_f32 v[170:171], v[170:171], v[114:115]
  v_fma_f32 v166, -v164, v164, v166
  v_pk_add_f32 v[158:159], v[158:159], v[100:101]
  v_fma_f32 v178, -v176, v176, v178
  v_pk_add_f32 v[170:171], v[170:171], v[116:117]
  v_max_f32 v166, 0, v166
  v_pk_add_f32 v[158:159], v[158:159], v[102:103]
  v_max_f32 v178, 0, v178
  v_pk_add_f32 v[170:171], v[170:171], v[118:119]
  v_cvt_pk_bf16_f32 v164, v164, v166
  v_pk_add_f32 v[158:159], v[158:159], v[104:105]
  v_cvt_pk_bf16_f32 v176, v176, v178
  v_pk_add_f32 v[170:171], v[170:171], v[120:121]
  v_and_b32 v166, s31, v164
  v_pk_add_f32 v[158:159], v[158:159], v[106:107]
  v_and_b32 v178, s31, v176
  v_pk_add_f32 v[170:171], v[170:171], v[122:123]
  v_lshlrev_b32 v165, 16, v164
  v_sub_f32 v158, v158, v159
  v_lshlrev_b32 v177, 16, v176
  v_sub_f32 v170, v170, v171
  v_add_f32 v166, 0x3727c5ac, v166
  v_add_f32 v178, 0x3727c5ac, v178
  v_mul_f32 v164, 0x42000000, v165
  v_mul_f32 v176, 0x42000000, v177
  v_cvt_pk_bf16_f32 v166, v166, v166
  v_cvt_pk_bf16_f32 v178, v178, v178
  v_cndmask_b32 v164, 0, v164, s[34:35]
  v_cndmask_b32 v176, 0, v176, s[34:35]
  v_and_b32 v166, s31, v166
  v_and_b32 v178, s31, v178
  v_sqrt_f32 v166, v166
  v_sqrt_f32 v178, v178
  v_pk_add_f32 v[92:93], v[92:93], v[164:165] op_sel_hi:[1,0] neg_lo:[0,1] neg_hi:[0,1]
  v_pk_add_f32 v[94:95], v[94:95], v[164:165] op_sel_hi:[1,0] neg_lo:[0,1] neg_hi:[0,1]
  v_pk_mul_f32 v[156:157], v[92:93], v[36:37]
  v_pk_mul_f32 v[92:93], v[92:93], v[52:53]
  v_pk_fma_f32 v[156:157], v[124:125], v[52:53], v[156:157] neg_lo:[1,0,0] neg_hi:[1,0,0]
  v_pk_fma_f32 v[92:93], v[124:125], v[36:37], v[92:93]
  v_cvt_pk_bf16_f32 v166, v166, v166
  v_cvt_pk_bf16_f32 v76, v156, v157
  v_cvt_pk_bf16_f32 v180, v92, v93
  v_readlane_b32 s40, v158, 0
  v_readlane_b32 s41, v158, 32
  v_pk_add_f32 v[96:97], v[96:97], v[164:165] op_sel_hi:[1,0] neg_lo:[0,1] neg_hi:[0,1]
  v_pk_mul_f32 v[160:161], v[94:95], v[38:39]
  v_pk_mul_f32 v[94:95], v[94:95], v[54:55]
  v_pk_fma_f32 v[160:161], v[126:127], v[54:55], v[160:161] neg_lo:[1,0,0] neg_hi:[1,0,0]
  v_pk_fma_f32 v[94:95], v[126:127], v[38:39], v[94:95]
  v_and_b32 v166, s31, v166
  v_cvt_pk_bf16_f32 v77, v160, v161
  v_cvt_pk_bf16_f32 v181, v94, v95
  v_pk_add_f32 v[98:99], v[98:99], v[164:165] op_sel_hi:[1,0] neg_lo:[0,1] neg_hi:[0,1]
  v_pk_mul_f32 v[156:157], v[96:97], v[40:41]
  v_pk_mul_f32 v[96:97], v[96:97], v[56:57]
  v_pk_fma_f32 v[156:157], v[128:129], v[56:57], v[156:157] neg_lo:[1,0,0] neg_hi:[1,0,0]
  v_pk_fma_f32 v[96:97], v[128:129], v[40:41], v[96:97]
  v_cvt_pk_bf16_f32 v162, -v165, v166
  v_cvt_pk_bf16_f32 v78, v156, v157
  v_cvt_pk_bf16_f32 v182, v96, v97
  v_pk_add_f32 v[100:101], v[100:101], v[164:165] op_sel_hi:[1,0] neg_lo:[0,1] neg_hi:[0,1]
  v_pk_mul_f32 v[160:161], v[98:99], v[42:43]
  v_pk_mul_f32 v[98:99], v[98:99], v[58:59]
  v_pk_fma_f32 v[160:161], v[130:131], v[58:59], v[160:161] neg_lo:[1,0,0] neg_hi:[1,0,0]
  v_pk_fma_f32 v[98:99], v[130:131], v[42:43], v[98:99]
  v_rcp_f32 v166, v166
  v_cvt_pk_bf16_f32 v79, v160, v161
  v_cvt_pk_bf16_f32 v183, v98, v99
  v_pk_add_f32 v[102:103], v[102:103], v[164:165] op_sel_hi:[1,0] neg_lo:[0,1] neg_hi:[0,1]
  v_pk_mul_f32 v[156:157], v[100:101], v[44:45]
  v_pk_mul_f32 v[100:101], v[100:101], v[60:61]
  v_pk_fma_f32 v[156:157], v[132:133], v[60:61], v[156:157] neg_lo:[1,0,0] neg_hi:[1,0,0]
  v_pk_fma_f32 v[100:101], v[132:133], v[44:45], v[100:101]
  v_cvt_pk_bf16_f32 v80, v156, v157
  v_cvt_pk_bf16_f32 v184, v100, v101
  v_pk_add_f32 v[104:105], v[104:105], v[164:165] op_sel_hi:[1,0] neg_lo:[0,1] neg_hi:[0,1]
  v_pk_mul_f32 v[160:161], v[102:103], v[46:47]
  v_pk_mul_f32 v[102:103], v[102:103], v[62:63]
  v_pk_fma_f32 v[160:161], v[134:135], v[62:63], v[160:161] neg_lo:[1,0,0] neg_hi:[1,0,0]
  v_pk_fma_f32 v[102:103], v[134:135], v[46:47], v[102:103]
  v_cvt_pk_bf16_f32 v81, v160, v161
  v_cvt_pk_bf16_f32 v185, v102, v103
  v_pk_add_f32 v[106:107], v[106:107], v[164:165] op_sel_hi:[1,0] neg_lo:[0,1] neg_hi:[0,1]
  v_pk_mul_f32 v[156:157], v[104:105], v[48:49]
  v_pk_mul_f32 v[104:105], v[104:105], v[64:65]
  v_pk_fma_f32 v[156:157], v[136:137], v[64:65], v[156:157] neg_lo:[1,0,0] neg_hi:[1,0,0]
  v_pk_fma_f32 v[104:105], v[136:137], v[48:49], v[104:105]
  v_mul_f32 v163, v166, v166
  v_cvt_pk_bf16_f32 v82, v156, v157
  v_cvt_pk_bf16_f32 v186, v104, v105
  v_pk_mul_f32 v[160:161], v[106:107], v[50:51]
  v_pk_mul_f32 v[106:107], v[106:107], v[66:67]
  v_pk_fma_f32 v[160:161], v[138:139], v[66:67], v[160:161] neg_lo:[1,0,0] neg_hi:[1,0,0]
  v_pk_fma_f32 v[106:107], v[138:139], v[50:51], v[106:107]
  v_cvt_pk_bf16_f32 v83, v160, v161
  v_cvt_pk_bf16_f32 v187, v106, v107
  v_mfma_f32_32x32x16_bf16 v[124:139], v[20:23], v[76:79], 0
  v_mfma_f32_32x32x16_bf16 v[124:139], v[28:31], v[180:183], v[124:139]
  v_mfma_f32_32x32x16_bf16 v[124:139], v[24:27], v[80:83], v[124:139]
  v_mfma_f32_32x32x16_bf16 v[124:139], v[32:35], v[184:187], v[124:139]
  v_mov_b32 v158, s40
  v_add_f32 v158, s41, v158
  v_pk_add_f32 v[108:109], v[108:109], v[176:177] op_sel_hi:[1,0] neg_lo:[0,1] neg_hi:[0,1]
  v_pk_add_f32 v[110:111], v[110:111], v[176:177] op_sel_hi:[1,0] neg_lo:[0,1] neg_hi:[0,1]
  v_pk_mul_f32 v[168:169], v[108:109], v[36:37]
  v_pk_mul_f32 v[108:109], v[108:109], v[52:53]
  v_pk_fma_f32 v[168:169], v[140:141], v[52:53], v[168:169] neg_lo:[1,0,0] neg_hi:[1,0,0]
  v_pk_fma_f32 v[108:109], v[140:141], v[36:37], v[108:109]
  v_cvt_pk_bf16_f32 v178, v178, v178
  v_cvt_pk_bf16_f32 v84, v168, v169
  v_cvt_pk_bf16_f32 v76, v108, v109
  v_readlane_b32 s42, v170, 0
  v_readlane_b32 s43, v170, 32
  v_pk_add_f32 v[112:113], v[112:113], v[176:177] op_sel_hi:[1,0] neg_lo:[0,1] neg_hi:[0,1]
  v_pk_mul_f32 v[172:173], v[110:111], v[38:39]
  v_pk_mul_f32 v[110:111], v[110:111], v[54:55]
  v_pk_fma_f32 v[172:173], v[142:143], v[54:55], v[172:173] neg_lo:[1,0,0] neg_hi:[1,0,0]
  v_pk_fma_f32 v[110:111], v[142:143], v[38:39], v[110:111]
  v_and_b32 v178, s31, v178
  v_cvt_pk_bf16_f32 v85, v172, v173
  v_cvt_pk_bf16_f32 v77, v110, v111
  v_pk_add_f32 v[114:115], v[114:115], v[176:177] op_sel_hi:[1,0] neg_lo:[0,1] neg_hi:[0,1]
  v_pk_mul_f32 v[168:169], v[112:113], v[40:41]
  v_pk_mul_f32 v[112:113], v[112:113], v[56:57]
  v_pk_fma_f32 v[168:169], v[144:145], v[56:57], v[168:169] neg_lo:[1,0,0] neg_hi:[1,0,0]
  v_pk_fma_f32 v[112:113], v[144:145], v[40:41], v[112:113]
  v_cvt_pk_bf16_f32 v174, -v177, v178
  v_cvt_pk_bf16_f32 v86, v168, v169
  v_cvt_pk_bf16_f32 v78, v112, v113
  v_pk_add_f32 v[116:117], v[116:117], v[176:177] op_sel_hi:[1,0] neg_lo:[0,1] neg_hi:[0,1]
  v_pk_mul_f32 v[172:173], v[114:115], v[42:43]
  v_pk_mul_f32 v[114:115], v[114:115], v[58:59]
  v_pk_fma_f32 v[172:173], v[146:147], v[58:59], v[172:173] neg_lo:[1,0,0] neg_hi:[1,0,0]
  v_pk_fma_f32 v[114:115], v[146:147], v[42:43], v[114:115]
  v_rcp_f32 v178, v178
  v_cvt_pk_bf16_f32 v87, v172, v173
  v_cvt_pk_bf16_f32 v79, v114, v115
  v_pk_add_f32 v[118:119], v[118:119], v[176:177] op_sel_hi:[1,0] neg_lo:[0,1] neg_hi:[0,1]
  v_pk_mul_f32 v[168:169], v[116:117], v[44:45]
  v_pk_mul_f32 v[116:117], v[116:117], v[60:61]
  v_pk_fma_f32 v[168:169], v[148:149], v[60:61], v[168:169] neg_lo:[1,0,0] neg_hi:[1,0,0]
  v_pk_fma_f32 v[116:117], v[148:149], v[44:45], v[116:117]
  v_cvt_pk_bf16_f32 v88, v168, v169
  v_cvt_pk_bf16_f32 v80, v116, v117
  v_pk_add_f32 v[120:121], v[120:121], v[176:177] op_sel_hi:[1,0] neg_lo:[0,1] neg_hi:[0,1]
  v_pk_mul_f32 v[172:173], v[118:119], v[46:47]
  v_pk_mul_f32 v[118:119], v[118:119], v[62:63]
  v_pk_fma_f32 v[172:173], v[150:151], v[62:63], v[172:173] neg_lo:[1,0,0] neg_hi:[1,0,0]
  v_pk_fma_f32 v[118:119], v[150:151], v[46:47], v[118:119]
  v_cvt_pk_bf16_f32 v89, v172, v173
  v_cvt_pk_bf16_f32 v81, v118, v119
  v_pk_add_f32 v[122:123], v[122:123], v[176:177] op_sel_hi:[1,0] neg_lo:[0,1] neg_hi:[0,1]
  v_pk_mul_f32 v[168:169], v[120:121], v[48:49]
  v_pk_mul_f32 v[120:121], v[120:121], v[64:65]
  v_pk_fma_f32 v[168:169], v[152:153], v[64:65], v[168:169] neg_lo:[1,0,0] neg_hi:[1,0,0]
  v_pk_fma_f32 v[120:121], v[152:153], v[48:49], v[120:121]
  v_mul_f32 v175, v178, v178
  v_cvt_pk_bf16_f32 v90, v168, v169
  v_cvt_pk_bf16_f32 v82, v120, v121
  v_pk_mul_f32 v[172:173], v[122:123], v[50:51]
  v_pk_mul_f32 v[122:123], v[122:123], v[66:67]
  v_pk_fma_f32 v[172:173], v[154:155], v[66:67], v[172:173] neg_lo:[1,0,0] neg_hi:[1,0,0]
  v_pk_fma_f32 v[122:123], v[154:155], v[50:51], v[122:123]
  v_cvt_pk_bf16_f32 v91, v172, v173
  v_cvt_pk_bf16_f32 v83, v122, v123
  v_mfma_f32_32x32x16_bf16 v[140:155], v[20:23], v[84:87], 0
  v_mfma_f32_32x32x16_bf16 v[140:155], v[28:31], v[76:79], v[140:155]
  v_mfma_f32_32x32x16_bf16 v[140:155], v[24:27], v[88:91], v[140:155]
  v_mfma_f32_32x32x16_bf16 v[140:155], v[32:35], v[80:83], v[140:155]
  v_mov_b32 v170, s42
  v_add_f32 v170, s43, v170
  v_cndmask_b32 v125, v125, v158, vcc
  v_pk_mul_f32 v[124:125], v[124:125], v[166:167] op_sel_hi:[1,0]
  v_pk_mul_f32 v[126:127], v[126:127], v[166:167] op_sel_hi:[1,0]
  v_pk_mul_f32 v[128:129], v[128:129], v[166:167] op_sel_hi:[1,0]
  v_pk_mul_f32 v[130:131], v[130:131], v[166:167] op_sel_hi:[1,0]
  v_pk_mul_f32 v[132:133], v[132:133], v[166:167] op_sel_hi:[1,0]
  v_pk_mul_f32 v[134:135], v[134:135], v[166:167] op_sel_hi:[1,0]
  v_pk_mul_f32 v[136:137], v[136:137], v[166:167] op_sel_hi:[1,0]
  v_pk_mul_f32 v[138:139], v[138:139], v[166:167] op_sel_hi:[1,0]
  v_cvt_pk_bf16_f32 v92, v124, v125
  ds_write_b32 v3, v92 offset:0
  v_cvt_pk_bf16_f32 v93, v126, v127
  ds_write_b32 v3, v93 offset:128
  v_cvt_pk_bf16_f32 v94, v128, v129
  ds_write_b32 v3, v94 offset:512
  v_cvt_pk_bf16_f32 v95, v130, v131
  ds_write_b32 v3, v95 offset:640
  v_cvt_pk_bf16_f32 v96, v132, v133
  ds_write_b32 v3, v96 offset:1024
  v_cvt_pk_bf16_f32 v97, v134, v135
  ds_write_b32 v3, v97 offset:1152
  v_cvt_pk_bf16_f32 v98, v136, v137
  ds_write_b32 v3, v98 offset:1536
  v_cvt_pk_bf16_f32 v99, v138, v139
  ds_write_b32 v3, v99 offset:1664
  s_mov_b64 exec, 1
  buffer_store_dwordx2 v[162:163], off, s[56:59], s36 offset:0 sc1
  buffer_store_dwordx2 v[174:175], off, s[56:59], s36 offset:32 sc1
  s_mov_b64 exec, -1
  v_cndmask_b32 v141, v141, v170, vcc
  v_pk_mul_f32 v[140:141], v[140:141], v[178:179] op_sel_hi:[1,0]
  v_pk_mul_f32 v[142:143], v[142:143], v[178:179] op_sel_hi:[1,0]
  v_pk_mul_f32 v[144:145], v[144:145], v[178:179] op_sel_hi:[1,0]
  v_pk_mul_f32 v[146:147], v[146:147], v[178:179] op_sel_hi:[1,0]
  v_pk_mul_f32 v[148:149], v[148:149], v[178:179] op_sel_hi:[1,0]
  v_pk_mul_f32 v[150:151], v[150:151], v[178:179] op_sel_hi:[1,0]
  v_pk_mul_f32 v[152:153], v[152:153], v[178:179] op_sel_hi:[1,0]
  v_pk_mul_f32 v[154:155], v[154:155], v[178:179] op_sel_hi:[1,0]
  v_cvt_pk_bf16_f32 v108, v140, v141
  ds_write_b32 v3, v108 offset:8192
  v_cvt_pk_bf16_f32 v109, v142, v143
  ds_write_b32 v3, v109 offset:8320
  v_cvt_pk_bf16_f32 v110, v144, v145
  ds_write_b32 v3, v110 offset:8704
  v_cvt_pk_bf16_f32 v111, v146, v147
  ds_write_b32 v3, v111 offset:8832
  v_cvt_pk_bf16_f32 v112, v148, v149
  ds_write_b32 v3, v112 offset:9216
  v_cvt_pk_bf16_f32 v113, v150, v151
  ds_write_b32 v3, v113 offset:9344
  v_cvt_pk_bf16_f32 v114, v152, v153
  ds_write_b32 v3, v114 offset:9728
  v_cvt_pk_bf16_f32 v115, v154, v155
  ds_write_b32 v3, v115 offset:9856
  v_readfirstlane_b32 s48, v163
  v_readfirstlane_b32 s49, v175
  s_waitcnt lgkmcnt(0)
  s_cmp_lg_u32 s47, 0
  s_cbranch_scc1 p1_lds_2
  s_barrier
  s_branch p1_synced_3
p1_lds_2:
  v_mov_b32 v156, 146432
  v_mov_b32 v157, 1
  s_mov_b32 s28, 0
  s_waitcnt lgkmcnt(0)
  s_mov_b64 exec, 1
  ds_add_rtn_u32 v157, v156, v157
  s_waitcnt lgkmcnt(0)
  v_add_u32 v157, 1, v157
lsync_4:
  s_nop 0
  v_readfirstlane_b32 s29, v157
  s_nop 1
  s_cmp_ge_u32 s29, 4
  s_cbranch_scc1 lsynced_5
  ds_read_b32 v157, v156
  s_add_u32 s28, s28, 1
  s_cmp_lt_u32 s28, 65536
  s_waitcnt lgkmcnt(0)
  s_cbranch_scc1 lsync_4
lsynced_5:
  s_mov_b64 exec, -1
p1_synced_3:
  ds_read2st64_b32 v[76:77], v72 offset0:0 offset1:8
  ds_read2st64_b32 v[78:79], v73 offset0:0 offset1:8
  ds_read2st64_b32 v[80:81], v74 offset0:0 offset1:8
  ds_read2st64_b32 v[82:83], v75 offset0:0 offset1:8
  ds_read2st64_b32 v[84:85], v72 offset0:1 offset1:9
  ds_read2st64_b32 v[86:87], v73 offset0:1 offset1:9
  ds_read2st64_b32 v[88:89], v74 offset0:1 offset1:9
  ds_read2st64_b32 v[90:91], v75 offset0:1 offset1:9
  s_waitcnt lgkmcnt(7)
  v_mfma_f32_16x16x16_bf16 v[124:127], v[76:77], v[68:69], 0
  s_waitcnt lgkmcnt(6)
  v_mfma_f32_16x16x16_bf16 v[128:131], v[78:79], v[68:69], 0
  s_waitcnt lgkmcnt(5)
  v_mfma_f32_16x16x16_bf16 v[132:135], v[80:81], v[68:69], 0
  s_waitcnt lgkmcnt(4)
  v_mfma_f32_16x16x16_bf16 v[136:139], v[82:83], v[68:69], 0
  s_waitcnt lgkmcnt(3)
  v_mfma_f32_16x16x16_bf16 v[140:143], v[84:85], v[68:69], 0
  s_waitcnt lgkmcnt(2)
  v_mfma_f32_16x16x16_bf16 v[144:147], v[86:87], v[68:69], 0
  s_waitcnt lgkmcnt(1)
  v_mfma_f32_16x16x16_bf16 v[148:151], v[88:89], v[68:69], 0
  s_waitcnt lgkmcnt(0)
  v_mfma_f32_16x16x16_bf16 v[152:155], v[90:91], v[68:69], 0
  v_cvt_pk_bf16_f32 v92, v124, v125
  v_cvt_pk_bf16_f32 v93, v126, v127
  v_cvt_pk_bf16_f32 v94, v128, v129
  v_cvt_pk_bf16_f32 v95, v130, v131
  buffer_store_dwordx4 v[92:95], v70, s[56:59], s38 offen offset:0 sc1
  v_cvt_pk_bf16_f32 v96, v132, v133
  v_cvt_pk_bf16_f32 v97, v134, v135
  v_cvt_pk_bf16_f32 v98, v136, v137
  v_cvt_pk_bf16_f32 v99, v138, v139
  buffer_store_dwordx4 v[96:99], v70, s[56:59], s38 offen offset:128 sc1
  v_cvt_pk_bf16_f32 v108, v140, v141
  v_cvt_pk_bf16_f32 v109, v142, v143
  v_cvt_pk_bf16_f32 v110, v144, v145
  v_cvt_pk_bf16_f32 v111, v146, v147
  buffer_store_dwordx4 v[108:111], v70, s[56:59], s39 offen offset:0 sc1
  v_cvt_pk_bf16_f32 v112, v148, v149
  v_cvt_pk_bf16_f32 v113, v150, v151
  v_cvt_pk_bf16_f32 v114, v152, v153
  v_cvt_pk_bf16_f32 v115, v154, v155
  buffer_store_dwordx4 v[112:115], v70, s[56:59], s39 offen offset:128 sc1
  s_setprio 0
  s_cmp_lg_u32 s47, 0
  s_cbranch_scc1 f_midlo
  v_lshrrev_b32 v138, 4, v0
  v_and_b32 v139, 15, v0
  v_lshrrev_b32 v140, 1, v139
  v_xor_b32 v140, v140, v138
  v_lshlrev_b32 v140, 4, v140
  v_lshl_add_u32 v128, v139, 7, v140
  v_xor_b32 v129, 64, v128
  v_bfe_u32 v141, v0, 2, 2
  v_lshl_add_u32 v142, v138, 3, v141
  v_lshlrev_b32 v142, 9, v142
  v_and_b32 v143, 3, v0
  v_lshl_add_u32 v142, v143, 3, v142
  v_add_u32 v142, 49152, v142
  v_and_b32 v143, 1, v138
  v_lshl_or_b32 v141, v143, 2, v141
  s_lshl_b32 s15, s5, 2
  s_add_u32 s28, s15, 0
  v_xor_b32 v143, s28, v141
  v_lshl_add_u32 v130, v143, 5, v142
  s_add_u32 s28, s15, 1
  v_xor_b32 v143, s28, v141
  v_lshl_add_u32 v131, v143, 5, v142
  s_add_u32 s28, s15, 2
  v_xor_b32 v143, s28, v141
  v_lshl_add_u32 v132, v143, 5, v142
  s_add_u32 s28, s15, 3
  v_xor_b32 v143, s28, v141
  v_lshl_add_u32 v133, v143, 5, v142
  s_mov_b32 s30, 0
  s_mov_b32 s31, 0
  s_and_b32 s35, s3, 0
  s_mov_b32 s34, 0xffff8000
  s_barrier
  ds_read_b64_tr_b16 v[160:161], v130 offset:0
  ds_read_b64_tr_b16 v[162:163], v130 offset:2048
  ds_read_b64_tr_b16 v[164:165], v131 offset:0
  ds_read_b64_tr_b16 v[166:167], v131 offset:2048
  ds_read_b64_tr_b16 v[168:169], v132 offset:0
  ds_read_b64_tr_b16 v[170:171], v132 offset:2048
  ds_read_b64_tr_b16 v[172:173], v133 offset:0
  ds_read_b64_tr_b16 v[174:175], v133 offset:2048
  ds_read_b128 v[192:195], v128 offset:0
  ds_read_b128 v[196:199], v128 offset:2048
  ds_read_b128 v[200:203], v128 offset:4096
  ds_read_b128 v[204:207], v128 offset:6144
  ds_read_b128 v[208:211], v128 offset:8192
  ds_read_b128 v[212:215], v128 offset:10240
  ds_read_b128 v[216:219], v128 offset:12288
  ds_read_b128 v[220:223], v128 offset:14336
  v_lshlrev_b32 v137, 4, v0
  s_lshr_b32 s29, s5, 1
  s_lshl_b32 s29, s29, 14
  s_and_b32 s28, s5, 1
  s_lshl_b32 s28, s28, 10
  s_add_u32 s29, s29, s28
  v_add_u32 v137, s29, v137
  s_lshl_b32 s29, s5, 9
  s_add_u32 s29, s29, 151552
  v_lshl_add_u32 v135, v139, 3, s29
  v_min_u32 v136, 1, v138
  v_lshlrev_b32 v136, 10, v136
  v_lshl_add_u32 v136, v139, 3, v136
  v_add_u32 v136, 153600, v136
  v_mov_b32 v156, 0x3f803f80
  v_mov_b32 v157, 0x3f803f80
  v_mov_b32 v158, 0x3f803f80
  v_mov_b32 v159, 0x3f803f80
  v_lshlrev_b32 v138, 4, v138
  s_waitcnt lgkmcnt(0)
  s_lshl_b32 s28, s5, 8
  s_add_u32 s28, s28, 151552
  v_add_u32 v138, s28, v138
g1_nocs_9:
  v_mfma_f32_16x16x32_bf16 v[0:3], v[160:163], v[192:195], 0
  ds_read_b64_tr_b16 v[176:177], v130 offset:16384
  v_mfma_f32_16x16x32_bf16 v[32:35], v[164:167], v[192:195], 0
  ds_read_b64_tr_b16 v[178:179], v130 offset:18432
  v_mfma_f32_16x16x32_bf16 v[140:143], v[160:163], v[156:159], 0
  v_mfma_f32_16x16x32_bf16 v[64:67], v[168:171], v[192:195], 0
  ds_read_b64_tr_b16 v[180:181], v131 offset:16384
  v_mfma_f32_16x16x32_bf16 v[96:99], v[172:175], v[192:195], 0
  ds_read_b64_tr_b16 v[182:183], v131 offset:18432
  v_mfma_f32_16x16x32_bf16 v[100:103], v[172:175], v[196:199], 0
  ds_read_b64_tr_b16 v[184:185], v132 offset:16384
  v_mfma_f32_16x16x32_bf16 v[68:71], v[168:171], v[196:199], 0
  ds_read_b64_tr_b16 v[186:187], v132 offset:18432
  v_mfma_f32_16x16x32_bf16 v[144:147], v[164:167], v[156:159], 0
  v_mfma_f32_16x16x32_bf16 v[36:39], v[164:167], v[196:199], 0
  ds_read_b64_tr_b16 v[188:189], v133 offset:16384
  v_mfma_f32_16x16x32_bf16 v[4:7], v[160:163], v[196:199], 0
  ds_read_b64_tr_b16 v[190:191], v133 offset:18432
  v_mfma_f32_16x16x32_bf16 v[8:11], v[160:163], v[200:203], 0
  ds_read_b128 v[224:227], v129 offset:0
  v_mfma_f32_16x16x32_bf16 v[40:43], v[164:167], v[200:203], 0
  ds_read_b128 v[228:231], v129 offset:2048
  v_mfma_f32_16x16x32_bf16 v[148:151], v[168:171], v[156:159], 0
  v_mfma_f32_16x16x32_bf16 v[72:75], v[168:171], v[200:203], 0
  ds_read_b128 v[232:235], v129 offset:4096
  v_mfma_f32_16x16x32_bf16 v[104:107], v[172:175], v[200:203], 0
  ds_read_b128 v[236:239], v129 offset:6144
  v_mfma_f32_16x16x32_bf16 v[108:111], v[172:175], v[204:207], 0
  ds_read_b128 v[240:243], v129 offset:8192
  v_mfma_f32_16x16x32_bf16 v[76:79], v[168:171], v[204:207], 0
  ds_read_b128 v[244:247], v129 offset:10240
  v_mfma_f32_16x16x32_bf16 v[152:155], v[172:175], v[156:159], 0
  v_mfma_f32_16x16x32_bf16 v[44:47], v[164:167], v[204:207], 0
  ds_read_b128 v[248:251], v129 offset:12288
  v_mfma_f32_16x16x32_bf16 v[12:15], v[160:163], v[204:207], 0
  ds_read_b128 v[252:255], v129 offset:14336
  v_mfma_f32_16x16x32_bf16 v[16:19], v[160:163], v[208:211], 0
  s_add_u32 s31, s31, 1
  v_mfma_f32_16x16x32_bf16 v[48:51], v[164:167], v[208:211], 0
  s_cmp_eq_u32 s31, 3
  v_mfma_f32_16x16x32_bf16 v[80:83], v[168:171], v[208:211], 0
  s_cselect_b32 s32, s34, 16384
  v_mfma_f32_16x16x32_bf16 v[112:115], v[172:175], v[208:211], 0
  s_cselect_b32 s31, 0, s31
  v_mfma_f32_16x16x32_bf16 v[116:119], v[172:175], v[212:215], 0
  s_lshl_b32 s33, s32, 1
  v_mfma_f32_16x16x32_bf16 v[84:87], v[168:171], v[212:215], 0
  v_add_u32 v128, s32, v128
  v_mfma_f32_16x16x32_bf16 v[52:55], v[164:167], v[212:215], 0
  v_add_u32 v129, s32, v129
  v_mfma_f32_16x16x32_bf16 v[20:23], v[160:163], v[212:215], 0
  v_add_u32 v130, s33, v130
  v_mfma_f32_16x16x32_bf16 v[24:27], v[160:163], v[216:219], 0
  v_add_u32 v131, s33, v131
  v_mfma_f32_16x16x32_bf16 v[56:59], v[164:167], v[216:219], 0
  v_add_u32 v132, s33, v132
  v_mfma_f32_16x16x32_bf16 v[88:91], v[168:171], v[216:219], 0
  v_add_u32 v133, s33, v133
  v_mfma_f32_16x16x32_bf16 v[120:123], v[172:175], v[216:219], 0
  v_mfma_f32_16x16x32_bf16 v[124:127], v[172:175], v[220:223], 0
  v_mfma_f32_16x16x32_bf16 v[92:95], v[168:171], v[220:223], 0
  v_mfma_f32_16x16x32_bf16 v[60:63], v[164:167], v[220:223], 0
  v_mfma_f32_16x16x32_bf16 v[28:31], v[160:163], v[220:223], 0
  s_waitcnt lgkmcnt(0)
  v_mfma_f32_16x16x32_bf16 v[140:143], v[176:179], v[156:159], v[140:143]
  v_mfma_f32_16x16x32_bf16 v[144:147], v[180:183], v[156:159], v[144:147]
  v_mfma_f32_16x16x32_bf16 v[148:151], v[184:187], v[156:159], v[148:151]
  v_mfma_f32_16x16x32_bf16 v[152:155], v[188:191], v[156:159], v[152:155]
  s_mov_b32 exec_lo, 0x00010001
  s_mov_b32 exec_hi, 0x00010001
  s_nop 2
  ds_write_b128 v138, v[140:143] offset:0
  ds_write_b128 v138, v[144:147] offset:64
  ds_write_b128 v138, v[148:151] offset:128
  ds_write_b128 v138, v[152:155] offset:192
  s_mov_b64 exec, -1
  s_waitcnt vmcnt(0)
  s_waitcnt lgkmcnt(0)
  s_barrier
  v_mfma_f32_16x16x32_bf16 v[0:3], v[176:179], v[224:227], v[0:3]
  ds_read_b64_tr_b16 v[160:161], v130 offset:0
  v_mbcnt_lo_u32_b32 v147, -1, 0
  v_mfma_f32_16x16x32_bf16 v[32:35], v[180:183], v[224:227], v[32:35]
  ds_read_b64_tr_b16 v[162:163], v130 offset:2048
  v_mbcnt_hi_u32_b32 v147, -1, v147
  v_mfma_f32_16x16x32_bf16 v[64:67], v[184:187], v[224:227], v[64:67]
  ds_read_b64_tr_b16 v[164:165], v131 offset:0
  s_lshr_b32 s28, s5, 1
  s_and_b32 s29, s5, 1
  v_mfma_f32_16x16x32_bf16 v[96:99], v[188:191], v[224:227], v[96:99]
  ds_read_b64_tr_b16 v[166:167], v131 offset:2048
  v_lshrrev_b32 v148, 4, v147
  v_mfma_f32_16x16x32_bf16 v[100:103], v[188:191], v[228:231], v[100:103]
  ds_read_b64_tr_b16 v[168:169], v132 offset:0
  s_lshl_b32 s36, s28, 13
  v_lshl_add_u32 v140, v147, 4, s36
  v_mfma_f32_16x16x32_bf16 v[68:71], v[184:187], v[228:231], v[68:71]
  ds_read_b64_tr_b16 v[170:171], v132 offset:2048
  v_bfe_u32 v149, v147, 2, 2
  v_mfma_f32_16x16x32_bf16 v[36:39], v[180:183], v[228:231], v[36:39]
  ds_read_b64_tr_b16 v[172:173], v133 offset:0
  v_lshl_add_u32 v149, v148, 2, v149
  v_mfma_f32_16x16x32_bf16 v[4:7], v[176:179], v[228:231], v[4:7]
  ds_read_b64_tr_b16 v[174:175], v133 offset:2048
  v_and_b32 v150, 7, v149
  v_mfma_f32_16x16x32_bf16 v[8:11], v[176:179], v[232:235], v[8:11]
  ds_read_b128 v[192:195], v128 offset:0
  v_lshlrev_b32 v149, 8, v149
  v_mfma_f32_16x16x32_bf16 v[40:43], v[180:183], v[232:235], v[40:43]
  ds_read_b128 v[196:199], v128 offset:2048
  v_and_b32 v151, 3, v147
  v_mfma_f32_16x16x32_bf16 v[72:75], v[184:187], v[232:235], v[72:75]
  ds_read_b128 v[200:203], v128 offset:4096
  v_lshl_add_u32 v149, v151, 3, v149
  v_mfma_f32_16x16x32_bf16 v[104:107], v[188:191], v[232:235], v[104:107]
  ds_read_b128 v[204:207], v128 offset:6144
  v_add_u32 v149, 81920, v149
  v_mfma_f32_16x16x32_bf16 v[108:111], v[188:191], v[236:239], v[108:111]
  ds_read_b128 v[208:211], v128 offset:8192
  s_lshl_b32 s36, s29, 2
  s_add_u32 s37, s36, 0
  v_mfma_f32_16x16x32_bf16 v[76:79], v[184:187], v[236:239], v[76:79]
  ds_read_b128 v[212:215], v128 offset:10240
  v_xor_b32 v151, s37, v150
  v_mfma_f32_16x16x32_bf16 v[44:47], v[180:183], v[236:239], v[44:47]
  ds_read_b128 v[216:219], v128 offset:12288
  v_lshl_add_u32 v141, v151, 5, v149
  v_mfma_f32_16x16x32_bf16 v[12:15], v[176:179], v[236:239], v[12:15]
  ds_read_b128 v[220:223], v128 offset:14336
  s_add_u32 s37, s36, 1
  v_xor_b32 v151, s37, v150
  v_mfma_f32_16x16x32_bf16 v[16:19], v[176:179], v[240:243], v[16:19]
  s_mov_b32 s30, 1
  v_lshl_add_u32 v142, v151, 5, v149
  v_mfma_f32_16x16x32_bf16 v[48:51], v[180:183], v[240:243], v[48:51]
  s_add_u32 s37, s36, 2
  v_xor_b32 v151, s37, v150
  v_lshl_add_u32 v143, v151, 5, v149
  v_mfma_f32_16x16x32_bf16 v[80:83], v[184:187], v[240:243], v[80:83]
  s_add_u32 s37, s36, 3
  v_xor_b32 v151, s37, v150
  v_lshl_add_u32 v144, v151, 5, v149
  v_mfma_f32_16x16x32_bf16 v[112:115], v[188:191], v[240:243], v[112:115]
  v_and_b32 v149, 1, v148
  v_lshrrev_b32 v148, 1, v148
  v_mfma_f32_16x16x32_bf16 v[116:119], v[188:191], v[244:247], v[116:119]
  v_lshl_add_u32 v148, v149, 1, v148
  s_lshl_b32 s36, s29, 3
  v_and_b32 v149, 15, v147
  v_mfma_f32_16x16x32_bf16 v[84:87], v[184:187], v[244:247], v[84:87]
  v_xor_b32 v148, v148, v149
  v_xor_b32 v148, s36, v148
  v_mfma_f32_16x16x32_bf16 v[52:55], v[180:183], v[244:247], v[52:55]
  s_lshl_b32 s36, s28, 14
  s_add_u32 s36, s36, 81920
  v_lshl_add_u32 v149, v149, 8, s36
  v_mfma_f32_16x16x32_bf16 v[20:23], v[176:179], v[244:247], v[20:23]
  v_lshl_add_u32 v145, v148, 4, v149
  v_xor_b32 v146, 64, v145
  v_mfma_f32_16x16x32_bf16 v[24:27], v[176:179], v[248:251], v[24:27]
  v_mfma_f32_16x16x32_bf16 v[56:59], v[180:183], v[248:251], v[56:59]
  v_mfma_f32_16x16x32_bf16 v[88:91], v[184:187], v[248:251], v[88:91]
  v_mfma_f32_16x16x32_bf16 v[120:123], v[188:191], v[248:251], v[120:123]
  v_mfma_f32_16x16x32_bf16 v[124:127], v[188:191], v[252:255], v[124:127]
  v_mfma_f32_16x16x32_bf16 v[92:95], v[184:187], v[252:255], v[92:95]
  v_mfma_f32_16x16x32_bf16 v[60:63], v[180:183], v[252:255], v[60:63]
  v_mfma_f32_16x16x32_bf16 v[28:31], v[176:179], v[252:255], v[28:31]
  s_waitcnt lgkmcnt(0)
  v_mfma_f32_16x16x32_bf16 v[0:3], v[160:163], v[192:195], v[0:3]
  ds_read_b64_tr_b16 v[176:177], v130 offset:16384
  v_mfma_f32_16x16x32_bf16 v[32:35], v[164:167], v[192:195], v[32:35]
  ds_read_b64_tr_b16 v[178:179], v130 offset:18432
  v_mfma_f32_16x16x32_bf16 v[64:67], v[168:171], v[192:195], v[64:67]
  ds_read_b64_tr_b16 v[180:181], v131 offset:16384
  v_mfma_f32_16x16x32_bf16 v[96:99], v[172:175], v[192:195], v[96:99]
  ds_read_b64_tr_b16 v[182:183], v131 offset:18432
  v_mfma_f32_16x16x32_bf16 v[100:103], v[172:175], v[196:199], v[100:103]
  ds_read_b64_tr_b16 v[184:185], v132 offset:16384
  v_mfma_f32_16x16x32_bf16 v[68:71], v[168:171], v[196:199], v[68:71]
  ds_read_b64_tr_b16 v[186:187], v132 offset:18432
  v_mfma_f32_16x16x32_bf16 v[36:39], v[164:167], v[196:199], v[36:39]
  ds_read_b64_tr_b16 v[188:189], v133 offset:16384
  v_mfma_f32_16x16x32_bf16 v[4:7], v[160:163], v[196:199], v[4:7]
  ds_read_b64_tr_b16 v[190:191], v133 offset:18432
  v_mfma_f32_16x16x32_bf16 v[8:11], v[160:163], v[200:203], v[8:11]
  ds_read_b128 v[224:227], v129 offset:0
  v_mfma_f32_16x16x32_bf16 v[40:43], v[164:167], v[200:203], v[40:43]
  ds_read_b128 v[228:231], v129 offset:2048
  v_mfma_f32_16x16x32_bf16 v[72:75], v[168:171], v[200:203], v[72:75]
  ds_read_b128 v[232:235], v129 offset:4096
  v_mfma_f32_16x16x32_bf16 v[104:107], v[172:175], v[200:203], v[104:107]
  ds_read_b128 v[236:239], v129 offset:6144
  v_mfma_f32_16x16x32_bf16 v[108:111], v[172:175], v[204:207], v[108:111]
  ds_read_b128 v[240:243], v129 offset:8192
  v_mfma_f32_16x16x32_bf16 v[76:79], v[168:171], v[204:207], v[76:79]
  ds_read_b128 v[244:247], v129 offset:10240
  v_mfma_f32_16x16x32_bf16 v[44:47], v[164:167], v[204:207], v[44:47]
  ds_read_b128 v[248:251], v129 offset:12288
  v_mfma_f32_16x16x32_bf16 v[12:15], v[160:163], v[204:207], v[12:15]
  ds_read_b128 v[252:255], v129 offset:14336
  v_mfma_f32_16x16x32_bf16 v[16:19], v[160:163], v[208:211], v[16:19]
  s_add_u32 s31, s31, 1
  v_mfma_f32_16x16x32_bf16 v[48:51], v[164:167], v[208:211], v[48:51]
  s_cmp_eq_u32 s31, 3
  v_mfma_f32_16x16x32_bf16 v[80:83], v[168:171], v[208:211], v[80:83]
  s_cselect_b32 s32, s34, 16384
  v_mfma_f32_16x16x32_bf16 v[112:115], v[172:175], v[208:211], v[112:115]
  s_cselect_b32 s31, 0, s31
  v_mfma_f32_16x16x32_bf16 v[116:119], v[172:175], v[212:215], v[116:119]
  s_lshl_b32 s33, s32, 1
  v_mfma_f32_16x16x32_bf16 v[84:87], v[168:171], v[212:215], v[84:87]
  v_add_u32 v128, s32, v128
  v_mfma_f32_16x16x32_bf16 v[52:55], v[164:167], v[212:215], v[52:55]
  v_add_u32 v129, s32, v129
  v_mfma_f32_16x16x32_bf16 v[20:23], v[160:163], v[212:215], v[20:23]
  v_add_u32 v130, s33, v130
  v_mfma_f32_16x16x32_bf16 v[24:27], v[160:163], v[216:219], v[24:27]
  v_add_u32 v131, s33, v131
  v_mfma_f32_16x16x32_bf16 v[56:59], v[164:167], v[216:219], v[56:59]
  v_add_u32 v132, s33, v132
  v_mfma_f32_16x16x32_bf16 v[88:91], v[168:171], v[216:219], v[88:91]
  v_add_u32 v133, s33, v133
  v_mfma_f32_16x16x32_bf16 v[120:123], v[172:175], v[216:219], v[120:123]
  v_mfma_f32_16x16x32_bf16 v[124:127], v[172:175], v[220:223], v[124:127]
  v_mfma_f32_16x16x32_bf16 v[92:95], v[168:171], v[220:223], v[92:95]
  v_mfma_f32_16x16x32_bf16 v[60:63], v[164:167], v[220:223], v[60:63]
  v_mfma_f32_16x16x32_bf16 v[28:31], v[160:163], v[220:223], v[28:31]
g1_loop_6:
  s_waitcnt lgkmcnt(0)
  s_barrier
  v_mfma_f32_16x16x32_bf16 v[0:3], v[176:179], v[224:227], v[0:3]
  ds_read_b64_tr_b16 v[160:161], v130 offset:0
  v_mfma_f32_16x16x32_bf16 v[32:35], v[180:183], v[224:227], v[32:35]
  ds_read_b64_tr_b16 v[162:163], v130 offset:2048
  v_mfma_f32_16x16x32_bf16 v[64:67], v[184:187], v[224:227], v[64:67]
  ds_read_b64_tr_b16 v[164:165], v131 offset:0
  v_mfma_f32_16x16x32_bf16 v[96:99], v[188:191], v[224:227], v[96:99]
  ds_read_b64_tr_b16 v[166:167], v131 offset:2048
  v_mfma_f32_16x16x32_bf16 v[100:103], v[188:191], v[228:231], v[100:103]
  ds_read_b64_tr_b16 v[168:169], v132 offset:0
  v_mfma_f32_16x16x32_bf16 v[68:71], v[184:187], v[228:231], v[68:71]
  ds_read_b64_tr_b16 v[170:171], v132 offset:2048
  v_mfma_f32_16x16x32_bf16 v[36:39], v[180:183], v[228:231], v[36:39]
  ds_read_b64_tr_b16 v[172:173], v133 offset:0
  v_mfma_f32_16x16x32_bf16 v[4:7], v[176:179], v[228:231], v[4:7]
  ds_read_b64_tr_b16 v[174:175], v133 offset:2048
  v_mfma_f32_16x16x32_bf16 v[8:11], v[176:179], v[232:235], v[8:11]
  ds_read_b128 v[192:195], v128 offset:0
  v_mfma_f32_16x16x32_bf16 v[40:43], v[180:183], v[232:235], v[40:43]
  ds_read_b128 v[196:199], v128 offset:2048
  v_mfma_f32_16x16x32_bf16 v[72:75], v[184:187], v[232:235], v[72:75]
  ds_read_b128 v[200:203], v128 offset:4096
  v_mfma_f32_16x16x32_bf16 v[104:107], v[188:191], v[232:235], v[104:107]
  ds_read_b128 v[204:207], v128 offset:6144
  v_mfma_f32_16x16x32_bf16 v[108:111], v[188:191], v[236:239], v[108:111]
  ds_read_b128 v[208:211], v128 offset:8192
  v_mfma_f32_16x16x32_bf16 v[76:79], v[184:187], v[236:239], v[76:79]
  ds_read_b128 v[212:215], v128 offset:10240
  v_mfma_f32_16x16x32_bf16 v[44:47], v[180:183], v[236:239], v[44:47]
  ds_read_b128 v[216:219], v128 offset:12288
  v_mfma_f32_16x16x32_bf16 v[12:15], v[176:179], v[236:239], v[12:15]
  ds_read_b128 v[220:223], v128 offset:14336
  v_mfma_f32_16x16x32_bf16 v[16:19], v[176:179], v[240:243], v[16:19]
  s_add_u32 s30, s30, 1
  v_mfma_f32_16x16x32_bf16 v[48:51], v[180:183], v[240:243], v[48:51]
  v_mfma_f32_16x16x32_bf16 v[80:83], v[184:187], v[240:243], v[80:83]
  v_mfma_f32_16x16x32_bf16 v[112:115], v[188:191], v[240:243], v[112:115]
  v_mfma_f32_16x16x32_bf16 v[116:119], v[188:191], v[244:247], v[116:119]
  v_mfma_f32_16x16x32_bf16 v[84:87], v[184:187], v[244:247], v[84:87]
  v_mfma_f32_16x16x32_bf16 v[52:55], v[180:183], v[244:247], v[52:55]
  v_mfma_f32_16x16x32_bf16 v[20:23], v[176:179], v[244:247], v[20:23]
  v_mfma_f32_16x16x32_bf16 v[24:27], v[176:179], v[248:251], v[24:27]
  v_mfma_f32_16x16x32_bf16 v[56:59], v[180:183], v[248:251], v[56:59]
  v_mfma_f32_16x16x32_bf16 v[88:91], v[184:187], v[248:251], v[88:91]
  v_mfma_f32_16x16x32_bf16 v[120:123], v[188:191], v[248:251], v[120:123]
  v_mfma_f32_16x16x32_bf16 v[124:127], v[188:191], v[252:255], v[124:127]
  v_mfma_f32_16x16x32_bf16 v[92:95], v[184:187], v[252:255], v[92:95]
  v_mfma_f32_16x16x32_bf16 v[60:63], v[180:183], v[252:255], v[60:63]
  v_mfma_f32_16x16x32_bf16 v[28:31], v[176:179], v[252:255], v[28:31]
  s_waitcnt lgkmcnt(0)
  v_mfma_f32_16x16x32_bf16 v[0:3], v[160:163], v[192:195], v[0:3]
  ds_read_b64_tr_b16 v[176:177], v130 offset:16384
  v_mfma_f32_16x16x32_bf16 v[32:35], v[164:167], v[192:195], v[32:35]
  ds_read_b64_tr_b16 v[178:179], v130 offset:18432
  v_mfma_f32_16x16x32_bf16 v[64:67], v[168:171], v[192:195], v[64:67]
  ds_read_b64_tr_b16 v[180:181], v131 offset:16384
  v_mfma_f32_16x16x32_bf16 v[96:99], v[172:175], v[192:195], v[96:99]
  ds_read_b64_tr_b16 v[182:183], v131 offset:18432
  v_mfma_f32_16x16x32_bf16 v[100:103], v[172:175], v[196:199], v[100:103]
  ds_read_b64_tr_b16 v[184:185], v132 offset:16384
  v_mfma_f32_16x16x32_bf16 v[68:71], v[168:171], v[196:199], v[68:71]
  ds_read_b64_tr_b16 v[186:187], v132 offset:18432
  v_mfma_f32_16x16x32_bf16 v[36:39], v[164:167], v[196:199], v[36:39]
  ds_read_b64_tr_b16 v[188:189], v133 offset:16384
  v_mfma_f32_16x16x32_bf16 v[4:7], v[160:163], v[196:199], v[4:7]
  ds_read_b64_tr_b16 v[190:191], v133 offset:18432
  v_mfma_f32_16x16x32_bf16 v[8:11], v[160:163], v[200:203], v[8:11]
  ds_read_b128 v[224:227], v129 offset:0
  v_mfma_f32_16x16x32_bf16 v[40:43], v[164:167], v[200:203], v[40:43]
  ds_read_b128 v[228:231], v129 offset:2048
  v_mfma_f32_16x16x32_bf16 v[72:75], v[168:171], v[200:203], v[72:75]
  ds_read_b128 v[232:235], v129 offset:4096
  v_mfma_f32_16x16x32_bf16 v[104:107], v[172:175], v[200:203], v[104:107]
  ds_read_b128 v[236:239], v129 offset:6144
  v_mfma_f32_16x16x32_bf16 v[108:111], v[172:175], v[204:207], v[108:111]
  ds_read_b128 v[240:243], v129 offset:8192
  v_mfma_f32_16x16x32_bf16 v[76:79], v[168:171], v[204:207], v[76:79]
  ds_read_b128 v[244:247], v129 offset:10240
  v_mfma_f32_16x16x32_bf16 v[44:47], v[164:167], v[204:207], v[44:47]
  ds_read_b128 v[248:251], v129 offset:12288
  v_mfma_f32_16x16x32_bf16 v[12:15], v[160:163], v[204:207], v[12:15]
  ds_read_b128 v[252:255], v129 offset:14336
  v_mfma_f32_16x16x32_bf16 v[16:19], v[160:163], v[208:211], v[16:19]
  s_add_u32 s31, s31, 1
  v_mfma_f32_16x16x32_bf16 v[48:51], v[164:167], v[208:211], v[48:51]
  s_cmp_eq_u32 s31, 3
  v_mfma_f32_16x16x32_bf16 v[80:83], v[168:171], v[208:211], v[80:83]
  s_cselect_b32 s32, s34, 16384
  v_mfma_f32_16x16x32_bf16 v[112:115], v[172:175], v[208:211], v[112:115]
  s_cselect_b32 s31, 0, s31
  v_mfma_f32_16x16x32_bf16 v[116:119], v[172:175], v[212:215], v[116:119]
  s_lshl_b32 s33, s32, 1
  v_mfma_f32_16x16x32_bf16 v[84:87], v[168:171], v[212:215], v[84:87]
  v_add_u32 v128, s32, v128
  v_mfma_f32_16x16x32_bf16 v[52:55], v[164:167], v[212:215], v[52:55]
  v_add_u32 v129, s32, v129
  v_mfma_f32_16x16x32_bf16 v[20:23], v[160:163], v[212:215], v[20:23]
  v_add_u32 v130, s33, v130
  v_mfma_f32_16x16x32_bf16 v[24:27], v[160:163], v[216:219], v[24:27]
  v_add_u32 v131, s33, v131
  v_mfma_f32_16x16x32_bf16 v[56:59], v[164:167], v[216:219], v[56:59]
  v_add_u32 v132, s33, v132
  v_mfma_f32_16x16x32_bf16 v[88:91], v[168:171], v[216:219], v[88:91]
  v_add_u32 v133, s33, v133
  v_mfma_f32_16x16x32_bf16 v[120:123], v[172:175], v[216:219], v[120:123]
  v_mfma_f32_16x16x32_bf16 v[124:127], v[172:175], v[220:223], v[124:127]
  v_mfma_f32_16x16x32_bf16 v[92:95], v[168:171], v[220:223], v[92:95]
  v_mfma_f32_16x16x32_bf16 v[60:63], v[164:167], v[220:223], v[60:63]
  v_mfma_f32_16x16x32_bf16 v[28:31], v[160:163], v[220:223], v[28:31]
  s_waitcnt lgkmcnt(0)
  s_barrier
  v_mfma_f32_16x16x32_bf16 v[0:3], v[176:179], v[224:227], v[0:3]
  ds_read_b64_tr_b16 v[160:161], v130 offset:0
  v_mfma_f32_16x16x32_bf16 v[32:35], v[180:183], v[224:227], v[32:35]
  ds_read_b64_tr_b16 v[162:163], v130 offset:2048
  v_mfma_f32_16x16x32_bf16 v[64:67], v[184:187], v[224:227], v[64:67]
  ds_read_b64_tr_b16 v[164:165], v131 offset:0
  v_mfma_f32_16x16x32_bf16 v[96:99], v[188:191], v[224:227], v[96:99]
  ds_read_b64_tr_b16 v[166:167], v131 offset:2048
  v_mfma_f32_16x16x32_bf16 v[100:103], v[188:191], v[228:231], v[100:103]
  ds_read_b64_tr_b16 v[168:169], v132 offset:0
  v_mfma_f32_16x16x32_bf16 v[68:71], v[184:187], v[228:231], v[68:71]
  ds_read_b64_tr_b16 v[170:171], v132 offset:2048
  v_mfma_f32_16x16x32_bf16 v[36:39], v[180:183], v[228:231], v[36:39]
  ds_read_b64_tr_b16 v[172:173], v133 offset:0
  v_mfma_f32_16x16x32_bf16 v[4:7], v[176:179], v[228:231], v[4:7]
  ds_read_b64_tr_b16 v[174:175], v133 offset:2048
  v_mfma_f32_16x16x32_bf16 v[8:11], v[176:179], v[232:235], v[8:11]
  ds_read_b128 v[192:195], v128 offset:0
  v_mfma_f32_16x16x32_bf16 v[40:43], v[180:183], v[232:235], v[40:43]
  ds_read_b128 v[196:199], v128 offset:2048
  v_mfma_f32_16x16x32_bf16 v[72:75], v[184:187], v[232:235], v[72:75]
  ds_read_b128 v[200:203], v128 offset:4096
  v_mfma_f32_16x16x32_bf16 v[104:107], v[188:191], v[232:235], v[104:107]
  ds_read_b128 v[204:207], v128 offset:6144
  v_mfma_f32_16x16x32_bf16 v[108:111], v[188:191], v[236:239], v[108:111]
  ds_read_b128 v[208:211], v128 offset:8192
  v_mfma_f32_16x16x32_bf16 v[76:79], v[184:187], v[236:239], v[76:79]
  ds_read_b128 v[212:215], v128 offset:10240
  v_mfma_f32_16x16x32_bf16 v[44:47], v[180:183], v[236:239], v[44:47]
  ds_read_b128 v[216:219], v128 offset:12288
  v_mfma_f32_16x16x32_bf16 v[12:15], v[176:179], v[236:239], v[12:15]
  ds_read_b128 v[220:223], v128 offset:14336
  v_mfma_f32_16x16x32_bf16 v[16:19], v[176:179], v[240:243], v[16:19]
  s_add_u32 s30, s30, 1
  v_mfma_f32_16x16x32_bf16 v[48:51], v[180:183], v[240:243], v[48:51]
  v_mfma_f32_16x16x32_bf16 v[80:83], v[184:187], v[240:243], v[80:83]
  v_mfma_f32_16x16x32_bf16 v[112:115], v[188:191], v[240:243], v[112:115]
  v_mfma_f32_16x16x32_bf16 v[116:119], v[188:191], v[244:247], v[116:119]
  v_mfma_f32_16x16x32_bf16 v[84:87], v[184:187], v[244:247], v[84:87]
  v_mfma_f32_16x16x32_bf16 v[52:55], v[180:183], v[244:247], v[52:55]
  v_mfma_f32_16x16x32_bf16 v[20:23], v[176:179], v[244:247], v[20:23]
  v_mfma_f32_16x16x32_bf16 v[24:27], v[176:179], v[248:251], v[24:27]
  v_mfma_f32_16x16x32_bf16 v[56:59], v[180:183], v[248:251], v[56:59]
  v_mfma_f32_16x16x32_bf16 v[88:91], v[184:187], v[248:251], v[88:91]
  v_mfma_f32_16x16x32_bf16 v[120:123], v[188:191], v[248:251], v[120:123]
  v_mfma_f32_16x16x32_bf16 v[124:127], v[188:191], v[252:255], v[124:127]
  v_mfma_f32_16x16x32_bf16 v[92:95], v[184:187], v[252:255], v[92:95]
  v_mfma_f32_16x16x32_bf16 v[60:63], v[180:183], v[252:255], v[60:63]
  v_mfma_f32_16x16x32_bf16 v[28:31], v[176:179], v[252:255], v[28:31]
  s_waitcnt lgkmcnt(0)
  v_mfma_f32_16x16x32_bf16 v[0:3], v[160:163], v[192:195], v[0:3]
  ds_read_b64_tr_b16 v[176:177], v130 offset:16384
  v_mfma_f32_16x16x32_bf16 v[32:35], v[164:167], v[192:195], v[32:35]
  ds_read_b64_tr_b16 v[178:179], v130 offset:18432
  v_mfma_f32_16x16x32_bf16 v[64:67], v[168:171], v[192:195], v[64:67]
  ds_read_b64_tr_b16 v[180:181], v131 offset:16384
  v_mfma_f32_16x16x32_bf16 v[96:99], v[172:175], v[192:195], v[96:99]
  ds_read_b64_tr_b16 v[182:183], v131 offset:18432
  v_mfma_f32_16x16x32_bf16 v[100:103], v[172:175], v[196:199], v[100:103]
  ds_read_b64_tr_b16 v[184:185], v132 offset:16384
  v_mfma_f32_16x16x32_bf16 v[68:71], v[168:171], v[196:199], v[68:71]
  ds_read_b64_tr_b16 v[186:187], v132 offset:18432
  v_mfma_f32_16x16x32_bf16 v[36:39], v[164:167], v[196:199], v[36:39]
  ds_read_b64_tr_b16 v[188:189], v133 offset:16384
  v_mfma_f32_16x16x32_bf16 v[4:7], v[160:163], v[196:199], v[4:7]
  ds_read_b64_tr_b16 v[190:191], v133 offset:18432
  v_mfma_f32_16x16x32_bf16 v[8:11], v[160:163], v[200:203], v[8:11]
  ds_read_b128 v[224:227], v129 offset:0
  v_mfma_f32_16x16x32_bf16 v[40:43], v[164:167], v[200:203], v[40:43]
  ds_read_b128 v[228:231], v129 offset:2048
  v_mfma_f32_16x16x32_bf16 v[72:75], v[168:171], v[200:203], v[72:75]
  ds_read_b128 v[232:235], v129 offset:4096
  v_mfma_f32_16x16x32_bf16 v[104:107], v[172:175], v[200:203], v[104:107]
  ds_read_b128 v[236:239], v129 offset:6144
  v_mfma_f32_16x16x32_bf16 v[108:111], v[172:175], v[204:207], v[108:111]
  ds_read_b128 v[240:243], v129 offset:8192
  v_mfma_f32_16x16x32_bf16 v[76:79], v[168:171], v[204:207], v[76:79]
  ds_read_b128 v[244:247], v129 offset:10240
  v_mfma_f32_16x16x32_bf16 v[44:47], v[164:167], v[204:207], v[44:47]
  ds_read_b128 v[248:251], v129 offset:12288
  v_mfma_f32_16x16x32_bf16 v[12:15], v[160:163], v[204:207], v[12:15]
  ds_read_b128 v[252:255], v129 offset:14336
  v_mfma_f32_16x16x32_bf16 v[16:19], v[160:163], v[208:211], v[16:19]
  s_add_u32 s31, s31, 1
  v_mfma_f32_16x16x32_bf16 v[48:51], v[164:167], v[208:211], v[48:51]
  s_cmp_eq_u32 s31, 3
  v_mfma_f32_16x16x32_bf16 v[80:83], v[168:171], v[208:211], v[80:83]
  s_cselect_b32 s32, s34, 16384
  v_mfma_f32_16x16x32_bf16 v[112:115], v[172:175], v[208:211], v[112:115]
  s_cselect_b32 s31, 0, s31
  v_mfma_f32_16x16x32_bf16 v[116:119], v[172:175], v[212:215], v[116:119]
  s_lshl_b32 s33, s32, 1
  v_mfma_f32_16x16x32_bf16 v[84:87], v[168:171], v[212:215], v[84:87]
  v_add_u32 v128, s32, v128
  v_mfma_f32_16x16x32_bf16 v[52:55], v[164:167], v[212:215], v[52:55]
  v_add_u32 v129, s32, v129
  v_mfma_f32_16x16x32_bf16 v[20:23], v[160:163], v[212:215], v[20:23]
  v_add_u32 v130, s33, v130
  v_mfma_f32_16x16x32_bf16 v[24:27], v[160:163], v[216:219], v[24:27]
  v_add_u32 v131, s33, v131
  v_mfma_f32_16x16x32_bf16 v[56:59], v[164:167], v[216:219], v[56:59]
  v_add_u32 v132, s33, v132
  v_mfma_f32_16x16x32_bf16 v[88:91], v[168:171], v[216:219], v[88:91]
  v_add_u32 v133, s33, v133
  v_mfma_f32_16x16x32_bf16 v[120:123], v[172:175], v[216:219], v[120:123]
  s_cmp_lt_u32 s30, 15
  v_mfma_f32_16x16x32_bf16 v[124:127], v[172:175], v[220:223], v[124:127]
  v_mfma_f32_16x16x32_bf16 v[92:95], v[168:171], v[220:223], v[92:95]
  v_mfma_f32_16x16x32_bf16 v[60:63], v[164:167], v[220:223], v[60:63]
  v_mfma_f32_16x16x32_bf16 v[28:31], v[160:163], v[220:223], v[28:31]
  s_cbranch_scc1 g1_loop_6
  s_waitcnt lgkmcnt(0)
  s_barrier
g1_last_7:
f_epi:
  v_mfma_f32_16x16x32_bf16 v[0:3], v[176:179], v[224:227], v[0:3]
  ds_read_b64 v[160:161], v135 offset:0
  ds_read_b64 v[162:163], v135 offset:128
  v_mfma_f32_16x16x32_bf16 v[32:35], v[180:183], v[224:227], v[32:35]
  ds_read_b64 v[192:193], v136 offset:0
  ds_read_b64 v[194:195], v136 offset:128
  v_mfma_f32_16x16x32_bf16 v[36:39], v[180:183], v[228:231], v[36:39]
  ds_read_b64 v[196:197], v136 offset:256
  ds_read_b64 v[198:199], v136 offset:384
  v_mfma_f32_16x16x32_bf16 v[4:7], v[176:179], v[228:231], v[4:7]
  ds_read_b64 v[200:201], v136 offset:512
  ds_read_b64 v[202:203], v136 offset:640
  v_mfma_f32_16x16x32_bf16 v[8:11], v[176:179], v[232:235], v[8:11]
  ds_read_b64 v[204:205], v136 offset:768
  ds_read_b64 v[206:207], v136 offset:896
  v_mfma_f32_16x16x32_bf16 v[40:43], v[180:183], v[232:235], v[40:43]
  ds_read_b64 v[164:165], v135 offset:256
  ds_read_b64 v[166:167], v135 offset:384
  v_mfma_f32_16x16x32_bf16 v[44:47], v[180:183], v[236:239], v[44:47]
  v_mfma_f32_16x16x32_bf16 v[12:15], v[176:179], v[236:239], v[12:15]
  s_waitcnt lgkmcnt(8)
  v_mfma_f32_16x16x16_bf16 v[0:3], v[160:161], v[192:193], v[0:3]
  v_mfma_f32_16x16x16_bf16 v[32:35], v[162:163], v[192:193], v[32:35]
  v_mfma_f32_16x16x16_bf16 v[36:39], v[162:163], v[194:195], v[36:39]
  v_mfma_f32_16x16x16_bf16 v[4:7], v[160:161], v[194:195], v[4:7]
  v_mfma_f32_16x16x32_bf16 v[16:19], v[176:179], v[240:243], v[16:19]
  v_mfma_f32_16x16x32_bf16 v[48:51], v[180:183], v[240:243], v[48:51]
  v_mfma_f32_16x16x32_bf16 v[52:55], v[180:183], v[244:247], v[52:55]
  v_mfma_f32_16x16x32_bf16 v[20:23], v[176:179], v[244:247], v[20:23]
  s_waitcnt lgkmcnt(0)
  v_mfma_f32_16x16x16_bf16 v[8:11], v[160:161], v[196:197], v[8:11]
  v_mul_f32 v0, v0, |v0|
  v_mul_f32 v1, v1, |v1|
  v_mul_f32 v2, v2, |v2|
  v_mul_f32 v3, v3, |v3|
  v_mfma_f32_16x16x16_bf16 v[40:43], v[162:163], v[196:197], v[40:43]
  v_mul_f32 v32, v32, |v32|
  v_mul_f32 v33, v33, |v33|
  v_mul_f32 v34, v34, |v34|
  v_mul_f32 v35, v35, |v35|
  v_mfma_f32_16x16x16_bf16 v[44:47], v[162:163], v[198:199], v[44:47]
  v_cvt_pk_bf16_f32 v208, v0, v1
  v_cvt_pk_bf16_f32 v209, v2, v3
  v_cvt_pk_bf16_f32 v210, v32, v33
  v_cvt_pk_bf16_f32 v211, v34, v35
  v_mfma_f32_16x16x16_bf16 v[12:15], v[160:161], v[198:199], v[12:15]
  v_pk_max_i16 v208, v208, 0
  v_pk_max_i16 v209, v209, 0
  v_pk_max_i16 v210, v210, 0
  v_pk_max_i16 v211, v211, 0
  ds_write_b128 v137, v[208:211] offset:0
  v_mfma_f32_16x16x32_bf16 v[24:27], v[176:179], v[248:251], v[24:27]
  v_mul_f32 v4, v4, |v4|
  v_mul_f32 v5, v5, |v5|
  v_mul_f32 v6, v6, |v6|
  v_mul_f32 v7, v7, |v7|
  v_mfma_f32_16x16x32_bf16 v[56:59], v[180:183], v[248:251], v[56:59]
  v_mul_f32 v36, v36, |v36|
  v_mul_f32 v37, v37, |v37|
  v_mul_f32 v38, v38, |v38|
  v_mul_f32 v39, v39, |v39|
  v_mfma_f32_16x16x32_bf16 v[60:63], v[180:183], v[252:255], v[60:63]
  v_cvt_pk_bf16_f32 v212, v4, v5
  v_cvt_pk_bf16_f32 v213, v6, v7
  v_cvt_pk_bf16_f32 v214, v36, v37
  v_cvt_pk_bf16_f32 v215, v38, v39
  v_mfma_f32_16x16x32_bf16 v[28:31], v[176:179], v[252:255], v[28:31]
  v_pk_max_i16 v212, v212, 0
  v_pk_max_i16 v213, v213, 0
  v_pk_max_i16 v214, v214, 0
  v_pk_max_i16 v215, v215, 0
  ds_write_b128 v137, v[212:215] offset:2048
  v_mfma_f32_16x16x16_bf16 v[16:19], v[160:161], v[200:201], v[16:19]
  v_mul_f32 v8, v8, |v8|
  v_mul_f32 v9, v9, |v9|
  v_mul_f32 v10, v10, |v10|
  v_mul_f32 v11, v11, |v11|
  v_mfma_f32_16x16x16_bf16 v[48:51], v[162:163], v[200:201], v[48:51]
  v_mul_f32 v40, v40, |v40|
  v_mul_f32 v41, v41, |v41|
  v_mul_f32 v42, v42, |v42|
  v_mul_f32 v43, v43, |v43|
  v_mfma_f32_16x16x16_bf16 v[52:55], v[162:163], v[202:203], v[52:55]
  v_cvt_pk_bf16_f32 v216, v8, v9
  v_cvt_pk_bf16_f32 v217, v10, v11
  v_cvt_pk_bf16_f32 v218, v40, v41
  v_cvt_pk_bf16_f32 v219, v42, v43
  v_mfma_f32_16x16x16_bf16 v[20:23], v[160:161], v[202:203], v[20:23]
  v_pk_max_i16 v216, v216, 0
  v_pk_max_i16 v217, v217, 0
  v_pk_max_i16 v218, v218, 0
  v_pk_max_i16 v219, v219, 0
  ds_write_b128 v137, v[216:219] offset:4096
  v_mfma_f32_16x16x32_bf16 v[64:67], v[184:187], v[224:227], v[64:67]
  v_mul_f32 v12, v12, |v12|
  v_mul_f32 v13, v13, |v13|
  v_mul_f32 v14, v14, |v14|
  v_mul_f32 v15, v15, |v15|
  v_mfma_f32_16x16x32_bf16 v[96:99], v[188:191], v[224:227], v[96:99]
  v_mul_f32 v44, v44, |v44|
  v_mul_f32 v45, v45, |v45|
  v_mul_f32 v46, v46, |v46|
  v_mul_f32 v47, v47, |v47|
  v_mfma_f32_16x16x32_bf16 v[100:103], v[188:191], v[228:231], v[100:103]
  v_cvt_pk_bf16_f32 v220, v12, v13
  v_cvt_pk_bf16_f32 v221, v14, v15
  v_cvt_pk_bf16_f32 v222, v44, v45
  v_cvt_pk_bf16_f32 v223, v46, v47
  v_mfma_f32_16x16x32_bf16 v[68:71], v[184:187], v[228:231], v[68:71]
  v_pk_max_i16 v220, v220, 0
  v_pk_max_i16 v221, v221, 0
  v_pk_max_i16 v222, v222, 0
  v_pk_max_i16 v223, v223, 0
  ds_write_b128 v137, v[220:223] offset:6144
  v_mfma_f32_16x16x16_bf16 v[24:27], v[160:161], v[204:205], v[24:27]
  v_mul_f32 v16, v16, |v16|
  v_mul_f32 v17, v17, |v17|
  v_mul_f32 v18, v18, |v18|
  v_mul_f32 v19, v19, |v19|
  v_mfma_f32_16x16x16_bf16 v[56:59], v[162:163], v[204:205], v[56:59]
  v_mul_f32 v48, v48, |v48|
  v_mul_f32 v49, v49, |v49|
  v_mul_f32 v50, v50, |v50|
  v_mul_f32 v51, v51, |v51|
  v_mfma_f32_16x16x16_bf16 v[60:63], v[162:163], v[206:207], v[60:63]
  v_cvt_pk_bf16_f32 v208, v16, v17
  v_cvt_pk_bf16_f32 v209, v18, v19
  v_cvt_pk_bf16_f32 v210, v48, v49
  v_cvt_pk_bf16_f32 v211, v50, v51
  v_mfma_f32_16x16x16_bf16 v[28:31], v[160:161], v[206:207], v[28:31]
  v_pk_max_i16 v208, v208, 0
  v_pk_max_i16 v209, v209, 0
  v_pk_max_i16 v210, v210, 0
  v_pk_max_i16 v211, v211, 0
  ds_write_b128 v137, v[208:211] offset:8192
  v_mfma_f32_16x16x32_bf16 v[72:75], v[184:187], v[232:235], v[72:75]
  v_mul_f32 v20, v20, |v20|
  v_mul_f32 v21, v21, |v21|
  v_mul_f32 v22, v22, |v22|
  v_mul_f32 v23, v23, |v23|
  v_mfma_f32_16x16x32_bf16 v[104:107], v[188:191], v[232:235], v[104:107]
  v_mul_f32 v52, v52, |v52|
  v_mul_f32 v53, v53, |v53|
  v_mul_f32 v54, v54, |v54|
  v_mul_f32 v55, v55, |v55|
  v_mfma_f32_16x16x32_bf16 v[108:111], v[188:191], v[236:239], v[108:111]
  v_cvt_pk_bf16_f32 v212, v20, v21
  v_cvt_pk_bf16_f32 v213, v22, v23
  v_cvt_pk_bf16_f32 v214, v52, v53
  v_cvt_pk_bf16_f32 v215, v54, v55
  v_mfma_f32_16x16x32_bf16 v[76:79], v[184:187], v[236:239], v[76:79]
  v_pk_max_i16 v212, v212, 0
  v_pk_max_i16 v213, v213, 0
  v_pk_max_i16 v214, v214, 0
  v_pk_max_i16 v215, v215, 0
  ds_write_b128 v137, v[212:215] offset:10240
  v_mfma_f32_16x16x16_bf16 v[64:67], v[164:165], v[192:193], v[64:67]
  v_mul_f32 v24, v24, |v24|
  v_mul_f32 v25, v25, |v25|
  v_mul_f32 v26, v26, |v26|
  v_mul_f32 v27, v27, |v27|
  v_mfma_f32_16x16x16_bf16 v[96:99], v[166:167], v[192:193], v[96:99]
  v_mul_f32 v56, v56, |v56|
  v_mul_f32 v57, v57, |v57|
  v_mul_f32 v58, v58, |v58|
  v_mul_f32 v59, v59, |v59|
  v_mfma_f32_16x16x16_bf16 v[100:103], v[166:167], v[194:195], v[100:103]
  v_cvt_pk_bf16_f32 v216, v24, v25
  v_cvt_pk_bf16_f32 v217, v26, v27
  v_cvt_pk_bf16_f32 v218, v56, v57
  v_cvt_pk_bf16_f32 v219, v58, v59
  v_mfma_f32_16x16x16_bf16 v[68:71], v[164:165], v[194:195], v[68:71]
  v_pk_max_i16 v216, v216, 0
  v_pk_max_i16 v217, v217, 0
  v_pk_max_i16 v218, v218, 0
  v_pk_max_i16 v219, v219, 0
  ds_write_b128 v137, v[216:219] offset:12288
  v_mfma_f32_16x16x32_bf16 v[80:83], v[184:187], v[240:243], v[80:83]
  v_mul_f32 v28, v28, |v28|
  v_mul_f32 v29, v29, |v29|
  v_mul_f32 v30, v30, |v30|
  v_mul_f32 v31, v31, |v31|
  v_mfma_f32_16x16x32_bf16 v[112:115], v[188:191], v[240:243], v[112:115]
  v_mul_f32 v60, v60, |v60|
  v_mul_f32 v61, v61, |v61|
  v_mul_f32 v62, v62, |v62|
  v_mul_f32 v63, v63, |v63|
  v_mfma_f32_16x16x32_bf16 v[116:119], v[188:191], v[244:247], v[116:119]
  v_cvt_pk_bf16_f32 v220, v28, v29
  v_cvt_pk_bf16_f32 v221, v30, v31
  v_cvt_pk_bf16_f32 v222, v60, v61
  v_cvt_pk_bf16_f32 v223, v62, v63
  v_mfma_f32_16x16x32_bf16 v[84:87], v[184:187], v[244:247], v[84:87]
  v_pk_max_i16 v220, v220, 0
  v_pk_max_i16 v221, v221, 0
  v_pk_max_i16 v222, v222, 0
  v_pk_max_i16 v223, v223, 0
  ds_write_b128 v137, v[220:223] offset:14336
  v_mfma_f32_16x16x16_bf16 v[72:75], v[164:165], v[196:197], v[72:75]
  v_mul_f32 v64, v64, |v64|
  v_mul_f32 v65, v65, |v65|
  v_mul_f32 v66, v66, |v66|
  v_mul_f32 v67, v67, |v67|
  v_mfma_f32_16x16x16_bf16 v[104:107], v[166:167], v[196:197], v[104:107]
  v_mul_f32 v96, v96, |v96|
  v_mul_f32 v97, v97, |v97|
  v_mul_f32 v98, v98, |v98|
  v_mul_f32 v99, v99, |v99|
  v_mfma_f32_16x16x16_bf16 v[108:111], v[166:167], v[198:199], v[108:111]
  v_cvt_pk_bf16_f32 v208, v64, v65
  v_cvt_pk_bf16_f32 v209, v66, v67
  v_cvt_pk_bf16_f32 v210, v96, v97
  v_cvt_pk_bf16_f32 v211, v98, v99
  v_mfma_f32_16x16x16_bf16 v[76:79], v[164:165], v[198:199], v[76:79]
  v_pk_max_i16 v208, v208, 0
  v_pk_max_i16 v209, v209, 0
  v_pk_max_i16 v210, v210, 0
  v_pk_max_i16 v211, v211, 0
  s_waitcnt lgkmcnt(0)
  s_barrier
  ds_write_b128 v137, v[208:211] offset:32768
  v_mfma_f32_16x16x32_bf16 v[88:91], v[184:187], v[248:251], v[88:91]
  v_mul_f32 v68, v68, |v68|
  v_mul_f32 v69, v69, |v69|
  v_mul_f32 v70, v70, |v70|
  v_mul_f32 v71, v71, |v71|
  v_mfma_f32_16x16x32_bf16 v[120:123], v[188:191], v[248:251], v[120:123]
  v_mul_f32 v100, v100, |v100|
  v_mul_f32 v101, v101, |v101|
  v_mul_f32 v102, v102, |v102|
  v_mul_f32 v103, v103, |v103|
  v_mfma_f32_16x16x32_bf16 v[124:127], v[188:191], v[252:255], v[124:127]
  v_cvt_pk_bf16_f32 v212, v68, v69
  v_cvt_pk_bf16_f32 v213, v70, v71
  v_cvt_pk_bf16_f32 v214, v100, v101
  v_cvt_pk_bf16_f32 v215, v102, v103
  v_mfma_f32_16x16x32_bf16 v[92:95], v[184:187], v[252:255], v[92:95]
  v_pk_max_i16 v212, v212, 0
  v_pk_max_i16 v213, v213, 0
  v_pk_max_i16 v214, v214, 0
  v_pk_max_i16 v215, v215, 0
  ds_write_b128 v137, v[212:215] offset:34816
  v_mfma_f32_16x16x16_bf16 v[80:83], v[164:165], v[200:201], v[80:83]
  v_mul_f32 v72, v72, |v72|
  v_mul_f32 v73, v73, |v73|
  v_mul_f32 v74, v74, |v74|
  v_mul_f32 v75, v75, |v75|
  v_mul_f32 v104, v104, |v104|
  v_mul_f32 v105, v105, |v105|
  v_mul_f32 v106, v106, |v106|
  v_mul_f32 v107, v107, |v107|
  v_mfma_f32_16x16x16_bf16 v[112:115], v[166:167], v[200:201], v[112:115]
  v_cvt_pk_bf16_f32 v216, v72, v73
  v_cvt_pk_bf16_f32 v217, v74, v75
  v_cvt_pk_bf16_f32 v218, v104, v105
  v_cvt_pk_bf16_f32 v219, v106, v107
  v_pk_max_i16 v216, v216, 0
  v_pk_max_i16 v217, v217, 0
  v_pk_max_i16 v218, v218, 0
  v_pk_max_i16 v219, v219, 0
  ds_write_b128 v137, v[216:219] offset:36864
  v_mfma_f32_16x16x16_bf16 v[116:119], v[166:167], v[202:203], v[116:119]
  v_mul_f32 v76, v76, |v76|
  v_mul_f32 v77, v77, |v77|
  v_mul_f32 v78, v78, |v78|
  v_mul_f32 v79, v79, |v79|
  v_mul_f32 v108, v108, |v108|
  v_mul_f32 v109, v109, |v109|
  v_mul_f32 v110, v110, |v110|
  v_mul_f32 v111, v111, |v111|
  v_mfma_f32_16x16x16_bf16 v[84:87], v[164:165], v[202:203], v[84:87]
  v_cvt_pk_bf16_f32 v220, v76, v77
  v_cvt_pk_bf16_f32 v221, v78, v79
  v_cvt_pk_bf16_f32 v222, v108, v109
  v_cvt_pk_bf16_f32 v223, v110, v111
  v_pk_max_i16 v220, v220, 0
  v_pk_max_i16 v221, v221, 0
  v_pk_max_i16 v222, v222, 0
  v_pk_max_i16 v223, v223, 0
  ds_write_b128 v137, v[220:223] offset:38912
  v_mfma_f32_16x16x16_bf16 v[88:91], v[164:165], v[204:205], v[88:91]
  v_mul_f32 v80, v80, |v80|
  v_mul_f32 v81, v81, |v81|
  v_mul_f32 v82, v82, |v82|
  v_mul_f32 v83, v83, |v83|
  v_mul_f32 v112, v112, |v112|
  v_mul_f32 v113, v113, |v113|
  v_mul_f32 v114, v114, |v114|
  v_mul_f32 v115, v115, |v115|
  v_mfma_f32_16x16x16_bf16 v[120:123], v[166:167], v[204:205], v[120:123]
  v_cvt_pk_bf16_f32 v208, v80, v81
  v_cvt_pk_bf16_f32 v209, v82, v83
  v_cvt_pk_bf16_f32 v210, v112, v113
  v_cvt_pk_bf16_f32 v211, v114, v115
  v_pk_max_i16 v208, v208, 0
  v_pk_max_i16 v209, v209, 0
  v_pk_max_i16 v210, v210, 0
  v_pk_max_i16 v211, v211, 0
  ds_write_b128 v137, v[208:211] offset:40960
  v_mfma_f32_16x16x16_bf16 v[124:127], v[166:167], v[206:207], v[124:127]
  v_mul_f32 v84, v84, |v84|
  v_mul_f32 v85, v85, |v85|
  v_mul_f32 v86, v86, |v86|
  v_mul_f32 v87, v87, |v87|
  v_mul_f32 v116, v116, |v116|
  v_mul_f32 v117, v117, |v117|
  v_mul_f32 v118, v118, |v118|
  v_mul_f32 v119, v119, |v119|
  v_mfma_f32_16x16x16_bf16 v[92:95], v[164:165], v[206:207], v[92:95]
  v_cvt_pk_bf16_f32 v212, v84, v85
  v_cvt_pk_bf16_f32 v213, v86, v87
  v_cvt_pk_bf16_f32 v214, v116, v117
  v_cvt_pk_bf16_f32 v215, v118, v119
  v_pk_max_i16 v212, v212, 0
  v_pk_max_i16 v213, v213, 0
  v_pk_max_i16 v214, v214, 0
  v_pk_max_i16 v215, v215, 0
  ds_write_b128 v137, v[212:215] offset:43008
  v_mul_f32 v88, v88, |v88|
  v_mul_f32 v89, v89, |v89|
  v_mul_f32 v90, v90, |v90|
  v_mul_f32 v91, v91, |v91|
  v_mul_f32 v120, v120, |v120|
  v_mul_f32 v121, v121, |v121|
  v_mul_f32 v122, v122, |v122|
  v_mul_f32 v123, v123, |v123|
  v_cvt_pk_bf16_f32 v216, v88, v89
  v_cvt_pk_bf16_f32 v217, v90, v91
  v_cvt_pk_bf16_f32 v218, v120, v121
  v_cvt_pk_bf16_f32 v219, v122, v123
  v_pk_max_i16 v216, v216, 0
  v_pk_max_i16 v217, v217, 0
  v_pk_max_i16 v218, v218, 0
  v_pk_max_i16 v219, v219, 0
  ds_write_b128 v137, v[216:219] offset:45056
  v_mul_f32 v92, v92, |v92|
  v_mul_f32 v93, v93, |v93|
  v_mul_f32 v94, v94, |v94|
  v_mul_f32 v95, v95, |v95|
  v_mul_f32 v124, v124, |v124|
  v_mul_f32 v125, v125, |v125|
  v_mul_f32 v126, v126, |v126|
  v_mul_f32 v127, v127, |v127|
  v_cvt_pk_bf16_f32 v220, v92, v93
  v_cvt_pk_bf16_f32 v221, v94, v95
  v_cvt_pk_bf16_f32 v222, v124, v125
  v_cvt_pk_bf16_f32 v223, v126, v127
  v_pk_max_i16 v220, v220, 0
  v_pk_max_i16 v221, v221, 0
  v_pk_max_i16 v222, v222, 0
  v_pk_max_i16 v223, v223, 0
  ds_write_b128 v137, v[220:223] offset:47104
f_tailc:
  s_waitcnt lgkmcnt(0)
f_g2go:
  s_barrier
  ds_read_b128 v[208:211], v140 offset:0
  ds_read_b64_tr_b16 v[192:193], v141 offset:0
  ds_read_b64_tr_b16 v[194:195], v141 offset:4096
  ds_read_b64_tr_b16 v[196:197], v142 offset:0
  ds_read_b64_tr_b16 v[198:199], v142 offset:4096
  ds_read_b64_tr_b16 v[200:201], v143 offset:0
  ds_read_b64_tr_b16 v[202:203], v143 offset:4096
  ds_read_b64_tr_b16 v[204:205], v144 offset:0
  ds_read_b64_tr_b16 v[206:207], v144 offset:4096
  ds_read_b128 v[212:215], v140 offset:2048
  ds_read_b128 v[216:219], v140 offset:4096
  ds_read_b128 v[220:223], v140 offset:6144
  s_waitcnt lgkmcnt(0)
  v_mfma_f32_16x16x32_bf16 v[0:3], v[192:195], v[208:211], 0
  ds_read_b128 v[240:243], v140 offset:1024
  v_mfma_f32_16x16x32_bf16 v[4:7], v[196:199], v[208:211], 0
  ds_read_b64_tr_b16 v[224:225], v141 offset:8192
  v_mfma_f32_16x16x32_bf16 v[8:11], v[200:203], v[208:211], 0
  ds_read_b64_tr_b16 v[226:227], v141 offset:12288
  v_mfma_f32_16x16x32_bf16 v[12:15], v[204:207], v[208:211], 0
  ds_read_b64_tr_b16 v[228:229], v142 offset:8192
  v_mfma_f32_16x16x32_bf16 v[28:31], v[204:207], v[212:215], 0
  ds_read_b64_tr_b16 v[230:231], v142 offset:12288
  v_mfma_f32_16x16x32_bf16 v[24:27], v[200:203], v[212:215], 0
  ds_read_b64_tr_b16 v[232:233], v143 offset:8192
  v_mfma_f32_16x16x32_bf16 v[20:23], v[196:199], v[212:215], 0
  ds_read_b64_tr_b16 v[234:235], v143 offset:12288
  v_mfma_f32_16x16x32_bf16 v[16:19], v[192:195], v[212:215], 0
  ds_read_b64_tr_b16 v[236:237], v144 offset:8192
  v_mfma_f32_16x16x32_bf16 v[32:35], v[192:195], v[216:219], 0
  ds_read_b64_tr_b16 v[238:239], v144 offset:12288
  v_mfma_f32_16x16x32_bf16 v[36:39], v[196:199], v[216:219], 0
  ds_read_b128 v[244:247], v140 offset:3072
  v_mfma_f32_16x16x32_bf16 v[40:43], v[200:203], v[216:219], 0
  ds_read_b128 v[248:251], v140 offset:5120
  v_mfma_f32_16x16x32_bf16 v[44:47], v[204:207], v[216:219], 0
  ds_read_b128 v[252:255], v140 offset:7168
  v_mfma_f32_16x16x32_bf16 v[60:63], v[204:207], v[220:223], 0
  v_mfma_f32_16x16x32_bf16 v[56:59], v[200:203], v[220:223], 0
  v_mfma_f32_16x16x32_bf16 v[52:55], v[196:199], v[220:223], 0
  v_mfma_f32_16x16x32_bf16 v[48:51], v[192:195], v[220:223], 0
  s_waitcnt lgkmcnt(0)
  s_barrier
  v_mfma_f32_16x16x32_bf16 v[0:3], v[224:227], v[240:243], v[0:3]
  ds_read_b128 v[208:211], v140 offset:16384
  v_mfma_f32_16x16x32_bf16 v[4:7], v[228:231], v[240:243], v[4:7]
  ds_read_b64_tr_b16 v[192:193], v141 offset:16384
  v_mfma_f32_16x16x32_bf16 v[8:11], v[232:235], v[240:243], v[8:11]
  ds_read_b64_tr_b16 v[194:195], v141 offset:20480
  v_mfma_f32_16x16x32_bf16 v[12:15], v[236:239], v[240:243], v[12:15]
  ds_read_b64_tr_b16 v[196:197], v142 offset:16384
  v_mfma_f32_16x16x32_bf16 v[28:31], v[236:239], v[244:247], v[28:31]
  ds_read_b64_tr_b16 v[198:199], v142 offset:20480
  v_mfma_f32_16x16x32_bf16 v[24:27], v[232:235], v[244:247], v[24:27]
  ds_read_b64_tr_b16 v[200:201], v143 offset:16384
  v_mfma_f32_16x16x32_bf16 v[20:23], v[228:231], v[244:247], v[20:23]
  ds_read_b64_tr_b16 v[202:203], v143 offset:20480
  v_mfma_f32_16x16x32_bf16 v[16:19], v[224:227], v[244:247], v[16:19]
  ds_read_b64_tr_b16 v[204:205], v144 offset:16384
  v_mfma_f32_16x16x32_bf16 v[32:35], v[224:227], v[248:251], v[32:35]
  ds_read_b64_tr_b16 v[206:207], v144 offset:20480
  v_mfma_f32_16x16x32_bf16 v[36:39], v[228:231], v[248:251], v[36:39]
  ds_read_b128 v[212:215], v140 offset:18432
  v_mfma_f32_16x16x32_bf16 v[40:43], v[232:235], v[248:251], v[40:43]
  ds_read_b128 v[216:219], v140 offset:20480
  v_mfma_f32_16x16x32_bf16 v[44:47], v[236:239], v[248:251], v[44:47]
  ds_read_b128 v[220:223], v140 offset:22528
  v_mfma_f32_16x16x32_bf16 v[60:63], v[236:239], v[252:255], v[60:63]
  v_mfma_f32_16x16x32_bf16 v[56:59], v[232:235], v[252:255], v[56:59]
  v_mfma_f32_16x16x32_bf16 v[52:55], v[228:231], v[252:255], v[52:55]
  v_mfma_f32_16x16x32_bf16 v[48:51], v[224:227], v[252:255], v[48:51]
  s_waitcnt lgkmcnt(0)
  v_mfma_f32_16x16x32_bf16 v[0:3], v[192:195], v[208:211], v[0:3]
  ds_read_b128 v[240:243], v140 offset:17408
  v_mfma_f32_16x16x32_bf16 v[4:7], v[196:199], v[208:211], v[4:7]
  ds_read_b64_tr_b16 v[224:225], v141 offset:24576
  v_mfma_f32_16x16x32_bf16 v[8:11], v[200:203], v[208:211], v[8:11]
  ds_read_b64_tr_b16 v[226:227], v141 offset:28672
  v_mfma_f32_16x16x32_bf16 v[12:15], v[204:207], v[208:211], v[12:15]
  ds_read_b64_tr_b16 v[228:229], v142 offset:24576
  v_mfma_f32_16x16x32_bf16 v[28:31], v[204:207], v[212:215], v[28:31]
  ds_read_b64_tr_b16 v[230:231], v142 offset:28672
  v_mfma_f32_16x16x32_bf16 v[24:27], v[200:203], v[212:215], v[24:27]
  ds_read_b64_tr_b16 v[232:233], v143 offset:24576
  v_mfma_f32_16x16x32_bf16 v[20:23], v[196:199], v[212:215], v[20:23]
  ds_read_b64_tr_b16 v[234:235], v143 offset:28672
  v_mfma_f32_16x16x32_bf16 v[16:19], v[192:195], v[212:215], v[16:19]
  ds_read_b64_tr_b16 v[236:237], v144 offset:24576
  v_mfma_f32_16x16x32_bf16 v[32:35], v[192:195], v[216:219], v[32:35]
  ds_read_b64_tr_b16 v[238:239], v144 offset:28672
  v_mfma_f32_16x16x32_bf16 v[36:39], v[196:199], v[216:219], v[36:39]
  ds_read_b128 v[244:247], v140 offset:19456
  v_mfma_f32_16x16x32_bf16 v[40:43], v[200:203], v[216:219], v[40:43]
  ds_read_b128 v[248:251], v140 offset:21504
  v_mfma_f32_16x16x32_bf16 v[44:47], v[204:207], v[216:219], v[44:47]
  ds_read_b128 v[252:255], v140 offset:23552
  v_mfma_f32_16x16x32_bf16 v[60:63], v[204:207], v[220:223], v[60:63]
  v_mfma_f32_16x16x32_bf16 v[56:59], v[200:203], v[220:223], v[56:59]
  v_mfma_f32_16x16x32_bf16 v[52:55], v[196:199], v[220:223], v[52:55]
  v_mfma_f32_16x16x32_bf16 v[48:51], v[192:195], v[220:223], v[48:51]
  s_waitcnt lgkmcnt(0)
  s_waitcnt vmcnt(0)
  s_barrier
  v_mfma_f32_16x16x32_bf16 v[0:3], v[224:227], v[240:243], v[0:3]
  ds_read_b128 v[208:211], v140 offset:32768
  v_mfma_f32_16x16x32_bf16 v[4:7], v[228:231], v[240:243], v[4:7]
  ds_read_b64_tr_b16 v[192:193], v141 offset:32768
  v_mfma_f32_16x16x32_bf16 v[8:11], v[232:235], v[240:243], v[8:11]
  ds_read_b64_tr_b16 v[194:195], v141 offset:36864
  v_mfma_f32_16x16x32_bf16 v[12:15], v[236:239], v[240:243], v[12:15]
  ds_read_b64_tr_b16 v[196:197], v142 offset:32768
  v_mfma_f32_16x16x32_bf16 v[28:31], v[236:239], v[244:247], v[28:31]
  ds_read_b64_tr_b16 v[198:199], v142 offset:36864
  v_mfma_f32_16x16x32_bf16 v[24:27], v[232:235], v[244:247], v[24:27]
  ds_read_b64_tr_b16 v[200:201], v143 offset:32768
  v_mfma_f32_16x16x32_bf16 v[20:23], v[228:231], v[244:247], v[20:23]
  ds_read_b64_tr_b16 v[202:203], v143 offset:36864
  v_mfma_f32_16x16x32_bf16 v[16:19], v[224:227], v[244:247], v[16:19]
  ds_read_b64_tr_b16 v[204:205], v144 offset:32768
  v_mfma_f32_16x16x32_bf16 v[32:35], v[224:227], v[248:251], v[32:35]
  ds_read_b64_tr_b16 v[206:207], v144 offset:36864
  v_mfma_f32_16x16x32_bf16 v[36:39], v[228:231], v[248:251], v[36:39]
  ds_read_b128 v[212:215], v140 offset:34816
  v_mfma_f32_16x16x32_bf16 v[40:43], v[232:235], v[248:251], v[40:43]
  ds_read_b128 v[216:219], v140 offset:36864
  v_mfma_f32_16x16x32_bf16 v[44:47], v[236:239], v[248:251], v[44:47]
  ds_read_b128 v[220:223], v140 offset:38912
  v_mfma_f32_16x16x32_bf16 v[60:63], v[236:239], v[252:255], v[60:63]
  v_mfma_f32_16x16x32_bf16 v[56:59], v[232:235], v[252:255], v[56:59]
  v_mfma_f32_16x16x32_bf16 v[52:55], v[228:231], v[252:255], v[52:55]
  v_mfma_f32_16x16x32_bf16 v[48:51], v[224:227], v[252:255], v[48:51]
  s_waitcnt lgkmcnt(0)
  v_mfma_f32_16x16x32_bf16 v[0:3], v[192:195], v[208:211], v[0:3]
  ds_read_b128 v[240:243], v140 offset:33792
  v_mfma_f32_16x16x32_bf16 v[4:7], v[196:199], v[208:211], v[4:7]
  ds_read_b64_tr_b16 v[224:225], v141 offset:40960
  v_mfma_f32_16x16x32_bf16 v[8:11], v[200:203], v[208:211], v[8:11]
  ds_read_b64_tr_b16 v[226:227], v141 offset:45056
  v_mfma_f32_16x16x32_bf16 v[12:15], v[204:207], v[208:211], v[12:15]
  ds_read_b64_tr_b16 v[228:229], v142 offset:40960
  v_mfma_f32_16x16x32_bf16 v[28:31], v[204:207], v[212:215], v[28:31]
  ds_read_b64_tr_b16 v[230:231], v142 offset:45056
  v_mfma_f32_16x16x32_bf16 v[24:27], v[200:203], v[212:215], v[24:27]
  ds_read_b64_tr_b16 v[232:233], v143 offset:40960
  v_mfma_f32_16x16x32_bf16 v[20:23], v[196:199], v[212:215], v[20:23]
  ds_read_b64_tr_b16 v[234:235], v143 offset:45056
  v_mfma_f32_16x16x32_bf16 v[16:19], v[192:195], v[212:215], v[16:19]
  ds_read_b64_tr_b16 v[236:237], v144 offset:40960
  v_mfma_f32_16x16x32_bf16 v[32:35], v[192:195], v[216:219], v[32:35]
  ds_read_b64_tr_b16 v[238:239], v144 offset:45056
  v_mfma_f32_16x16x32_bf16 v[36:39], v[196:199], v[216:219], v[36:39]
  ds_read_b128 v[244:247], v140 offset:35840
  v_mfma_f32_16x16x32_bf16 v[40:43], v[200:203], v[216:219], v[40:43]
  ds_read_b128 v[248:251], v140 offset:37888
  v_mfma_f32_16x16x32_bf16 v[44:47], v[204:207], v[216:219], v[44:47]
  ds_read_b128 v[252:255], v140 offset:39936
  v_mfma_f32_16x16x32_bf16 v[60:63], v[204:207], v[220:223], v[60:63]
  v_mfma_f32_16x16x32_bf16 v[56:59], v[200:203], v[220:223], v[56:59]
  v_mfma_f32_16x16x32_bf16 v[52:55], v[196:199], v[220:223], v[52:55]
  v_mfma_f32_16x16x32_bf16 v[48:51], v[192:195], v[220:223], v[48:51]
  s_waitcnt lgkmcnt(0)
  s_barrier
  v_mfma_f32_16x16x32_bf16 v[0:3], v[224:227], v[240:243], v[0:3]
  ds_read_b128 v[208:211], v140 offset:49152
  v_mfma_f32_16x16x32_bf16 v[4:7], v[228:231], v[240:243], v[4:7]
  ds_read_b64_tr_b16 v[192:193], v141 offset:49152
  v_mfma_f32_16x16x32_bf16 v[8:11], v[232:235], v[240:243], v[8:11]
  ds_read_b64_tr_b16 v[194:195], v141 offset:53248
  v_mfma_f32_16x16x32_bf16 v[12:15], v[236:239], v[240:243], v[12:15]
  ds_read_b64_tr_b16 v[196:197], v142 offset:49152
  v_mfma_f32_16x16x32_bf16 v[28:31], v[236:239], v[244:247], v[28:31]
  ds_read_b64_tr_b16 v[198:199], v142 offset:53248
  v_mfma_f32_16x16x32_bf16 v[24:27], v[232:235], v[244:247], v[24:27]
  ds_read_b64_tr_b16 v[200:201], v143 offset:49152
  v_mfma_f32_16x16x32_bf16 v[20:23], v[228:231], v[244:247], v[20:23]
  ds_read_b64_tr_b16 v[202:203], v143 offset:53248
  v_mfma_f32_16x16x32_bf16 v[16:19], v[224:227], v[244:247], v[16:19]
  ds_read_b64_tr_b16 v[204:205], v144 offset:49152
  v_mfma_f32_16x16x32_bf16 v[32:35], v[224:227], v[248:251], v[32:35]
  ds_read_b64_tr_b16 v[206:207], v144 offset:53248
  v_mfma_f32_16x16x32_bf16 v[36:39], v[228:231], v[248:251], v[36:39]
  ds_read_b128 v[212:215], v140 offset:51200
  v_mfma_f32_16x16x32_bf16 v[40:43], v[232:235], v[248:251], v[40:43]
  ds_read_b128 v[216:219], v140 offset:53248
  v_mfma_f32_16x16x32_bf16 v[44:47], v[236:239], v[248:251], v[44:47]
  ds_read_b128 v[220:223], v140 offset:55296
  v_mfma_f32_16x16x32_bf16 v[60:63], v[236:239], v[252:255], v[60:63]
  v_mfma_f32_16x16x32_bf16 v[56:59], v[232:235], v[252:255], v[56:59]
  v_mfma_f32_16x16x32_bf16 v[52:55], v[228:231], v[252:255], v[52:55]
  v_mfma_f32_16x16x32_bf16 v[48:51], v[224:227], v[252:255], v[48:51]
  s_waitcnt lgkmcnt(0)
  v_mfma_f32_16x16x32_bf16 v[0:3], v[192:195], v[208:211], v[0:3]
  ds_read_b128 v[240:243], v140 offset:50176
  v_mfma_f32_16x16x32_bf16 v[4:7], v[196:199], v[208:211], v[4:7]
  ds_read_b64_tr_b16 v[224:225], v141 offset:57344
  v_mfma_f32_16x16x32_bf16 v[8:11], v[200:203], v[208:211], v[8:11]
  ds_read_b64_tr_b16 v[226:227], v141 offset:61440
  v_mfma_f32_16x16x32_bf16 v[12:15], v[204:207], v[208:211], v[12:15]
  ds_read_b64_tr_b16 v[228:229], v142 offset:57344
  v_mfma_f32_16x16x32_bf16 v[28:31], v[204:207], v[212:215], v[28:31]
  ds_read_b64_tr_b16 v[230:231], v142 offset:61440
  v_mfma_f32_16x16x32_bf16 v[24:27], v[200:203], v[212:215], v[24:27]
  ds_read_b64_tr_b16 v[232:233], v143 offset:57344
  v_mfma_f32_16x16x32_bf16 v[20:23], v[196:199], v[212:215], v[20:23]
  ds_read_b64_tr_b16 v[234:235], v143 offset:61440
  v_mfma_f32_16x16x32_bf16 v[16:19], v[192:195], v[212:215], v[16:19]
  ds_read_b64_tr_b16 v[236:237], v144 offset:57344
  v_mfma_f32_16x16x32_bf16 v[32:35], v[192:195], v[216:219], v[32:35]
  ds_read_b64_tr_b16 v[238:239], v144 offset:61440
  v_mfma_f32_16x16x32_bf16 v[36:39], v[196:199], v[216:219], v[36:39]
  ds_read_b128 v[244:247], v140 offset:52224
  v_mfma_f32_16x16x32_bf16 v[40:43], v[200:203], v[216:219], v[40:43]
  ds_read_b128 v[248:251], v140 offset:54272
  v_mfma_f32_16x16x32_bf16 v[44:47], v[204:207], v[216:219], v[44:47]
  ds_read_b128 v[252:255], v140 offset:56320
  v_mfma_f32_16x16x32_bf16 v[60:63], v[204:207], v[220:223], v[60:63]
  v_mfma_f32_16x16x32_bf16 v[56:59], v[200:203], v[220:223], v[56:59]
  v_mfma_f32_16x16x32_bf16 v[52:55], v[196:199], v[220:223], v[52:55]
  v_mfma_f32_16x16x32_bf16 v[48:51], v[192:195], v[220:223], v[48:51]
  s_waitcnt lgkmcnt(0)
  s_cmp_lg_u32 s47, 0
  s_cbranch_scc1 nogap_10
  v_bfe_u32 v172, v147, 1, 3
  v_lshlrev_b32 v172, 8, v172
  v_add_u32 v172, s2, v172
  v_cvt_f32_u32 v172, v172
  v_mul_f32 v172, 0x3a000000, v172
  v_lshrrev_b32 v170, 4, v147
  v_lshlrev_b32 v170, 1, v170
  v_cvt_f32_u32 v170, v170
  v_and_b32 v171, 1, v147
  v_cvt_f32_u32 v171, v171
  v_mul_f32 v173, v170, v172
  v_fmac_f32 v173, 0xbe800000, v171
  v_add_f32 v170, v173, v172
  v_cos_f32 v164, v173
  v_sin_f32 v165, -v173
  v_cos_f32 v166, v170
  v_sin_f32 v167, -v170
  v_fma_f32 v122, v171, -2.0, 1.0
  v_cmp_gt_u32 vcc, 32, v147
  v_mul_f32 v164, 0x35800000, v164
  v_mul_f32 v165, 0x35800000, v165
  v_mul_f32 v166, 0x35800000, v166
  v_mul_f32 v167, 0x35800000, v167
  v_cndmask_b32 v122, 0, v122, vcc
  v_cvt_pk_bf16_f32 v120, v164, v165
  v_cvt_pk_bf16_f32 v121, v166, v167
  v_and_b32 v173, 0x13, v147
  v_bfe_u32 v172, v147, 2, 1
  v_lshl_or_b32 v173, v172, 3, v173
  v_bfe_u32 v172, v147, 3, 1
  v_lshl_or_b32 v173, v172, 2, v173
  v_cvt_f32_u32 v172, v173
  v_mul_f32 v172, 0x3d000000, v172
  v_lshrrev_b32 v170, 5, v147
  v_cvt_f32_u32 v170, v170
  v_mul_f32 v173, 0x41000000, v170
  v_mul_f32 v173, v173, v172
  v_fmamk_f32 v164, v172, 0x00000000, v173
  v_fmamk_f32 v165, v172, 0x3f800000, v173
  v_cos_f32 v166, v164
  v_cos_f32 v167, v165
  v_sin_f32 v168, v164
  v_sin_f32 v169, v165
  v_cvt_pk_bf16_f32 v124, v166, v167
  v_cvt_pk_bf16_f32 v128, v168, v169
  v_cvt_pk_bf16_f32 v132, -v168, -v169
  v_fmamk_f32 v164, v172, 0x40000000, v173
  v_fmamk_f32 v165, v172, 0x40400000, v173
  v_cos_f32 v166, v164
  v_cos_f32 v167, v165
  v_sin_f32 v168, v164
  v_sin_f32 v169, v165
  v_cvt_pk_bf16_f32 v125, v166, v167
  v_cvt_pk_bf16_f32 v129, v168, v169
  v_cvt_pk_bf16_f32 v133, -v168, -v169
  v_fmamk_f32 v164, v172, 0x40800000, v173
  v_fmamk_f32 v165, v172, 0x40a00000, v173
  v_cos_f32 v166, v164
  v_cos_f32 v167, v165
  v_sin_f32 v168, v164
  v_sin_f32 v169, v165
  v_cvt_pk_bf16_f32 v126, v166, v167
  v_cvt_pk_bf16_f32 v130, v168, v169
  v_cvt_pk_bf16_f32 v134, -v168, -v169
  v_fmamk_f32 v164, v172, 0x40c00000, v173
  v_fmamk_f32 v165, v172, 0x40e00000, v173
  v_cos_f32 v166, v164
  v_cos_f32 v167, v165
  v_sin_f32 v168, v164
  v_sin_f32 v169, v165
  v_cvt_pk_bf16_f32 v127, v166, v167
  v_cvt_pk_bf16_f32 v131, v168, v169
  v_cvt_pk_bf16_f32 v135, -v168, -v169
  v_mul_f32 v172, 0x3d000000, v172
  v_mul_f32 v173, 0x40800000, v170
  v_mul_f32 v173, v173, v172
  v_fmamk_f32 v164, v172, 0x00000000, v173
  v_cos_f32 v64, v164
  v_sin_f32 v80, v164
  v_fmamk_f32 v165, v172, 0x3f800000, v173
  v_cos_f32 v65, v165
  v_sin_f32 v81, v165
  v_fmamk_f32 v164, v172, 0x40000000, v173
  v_cos_f32 v66, v164
  v_sin_f32 v82, v164
  v_fmamk_f32 v165, v172, 0x40400000, v173
  v_cos_f32 v67, v165
  v_sin_f32 v83, v165
  v_fmamk_f32 v164, v172, 0x41000000, v173
  v_cos_f32 v68, v164
  v_sin_f32 v84, v164
  v_fmamk_f32 v165, v172, 0x41100000, v173
  v_cos_f32 v69, v165
  v_sin_f32 v85, v165
  v_fmamk_f32 v164, v172, 0x41200000, v173
  v_cos_f32 v70, v164
  v_sin_f32 v86, v164
  v_fmamk_f32 v165, v172, 0x41300000, v173
  v_cos_f32 v71, v165
  v_sin_f32 v87, v165
  v_fmamk_f32 v164, v172, 0x41800000, v173
  v_cos_f32 v72, v164
  v_sin_f32 v88, v164
  v_fmamk_f32 v165, v172, 0x41880000, v173
  v_cos_f32 v73, v165
  v_sin_f32 v89, v165
  v_fmamk_f32 v164, v172, 0x41900000, v173
  v_cos_f32 v74, v164
  v_sin_f32 v90, v164
  v_fmamk_f32 v165, v172, 0x41980000, v173
  v_cos_f32 v75, v165
  v_sin_f32 v91, v165
  v_fmamk_f32 v164, v172, 0x41c00000, v173
  v_cos_f32 v76, v164
  v_sin_f32 v92, v164
  v_fmamk_f32 v165, v172, 0x41c80000, v173
  v_cos_f32 v77, v165
  v_sin_f32 v93, v165
  v_fmamk_f32 v164, v172, 0x41d00000, v173
  v_cos_f32 v78, v164
  v_sin_f32 v94, v164
  v_fmamk_f32 v165, v172, 0x41d80000, v173
  v_cos_f32 v79, v165
  v_sin_f32 v95, v165
  v_and_b32 v172, 31, v147
  v_cvt_f32_u32 v172, v172
  v_mul_f32 v172, 0x3d000000, v172
  v_mul_f32 v173, 0x40800000, v170
  v_mul_f32 v173, v173, v172
  v_fmamk_f32 v164, v172, 0x00000000, v173
  v_fmamk_f32 v165, v172, 0x3f800000, v173
  v_cos_f32 v166, v164
  v_cos_f32 v167, v165
  v_sin_f32 v168, -v164
  v_sin_f32 v169, -v165
  v_cvt_pk_bf16_f32 v148, v166, v167
  v_cvt_pk_bf16_f32 v156, v168, v169
  v_fmamk_f32 v164, v172, 0x40000000, v173
  v_fmamk_f32 v165, v172, 0x40400000, v173
  v_cos_f32 v166, v164
  v_cos_f32 v167, v165
  v_sin_f32 v168, -v164
  v_sin_f32 v169, -v165
  v_cvt_pk_bf16_f32 v149, v166, v167
  v_cvt_pk_bf16_f32 v157, v168, v169
  v_fmamk_f32 v164, v172, 0x41000000, v173
  v_fmamk_f32 v165, v172, 0x41100000, v173
  v_cos_f32 v166, v164
  v_cos_f32 v167, v165
  v_sin_f32 v168, -v164
  v_sin_f32 v169, -v165
  v_cvt_pk_bf16_f32 v150, v166, v167
  v_cvt_pk_bf16_f32 v158, v168, v169
  v_fmamk_f32 v164, v172, 0x41200000, v173
  v_fmamk_f32 v165, v172, 0x41300000, v173
  v_cos_f32 v166, v164
  v_cos_f32 v167, v165
  v_sin_f32 v168, -v164
  v_sin_f32 v169, -v165
  v_cvt_pk_bf16_f32 v151, v166, v167
  v_cvt_pk_bf16_f32 v159, v168, v169
  v_fmamk_f32 v164, v172, 0x41800000, v173
  v_fmamk_f32 v165, v172, 0x41880000, v173
  v_cos_f32 v166, v164
  v_cos_f32 v167, v165
  v_sin_f32 v168, -v164
  v_sin_f32 v169, -v165
  v_cvt_pk_bf16_f32 v152, v166, v167
  v_cvt_pk_bf16_f32 v160, v168, v169
  v_fmamk_f32 v164, v172, 0x41900000, v173
  v_fmamk_f32 v165, v172, 0x41980000, v173
  v_cos_f32 v166, v164
  v_cos_f32 v167, v165
  v_sin_f32 v168, -v164
  v_sin_f32 v169, -v165
  v_cvt_pk_bf16_f32 v153, v166, v167
  v_cvt_pk_bf16_f32 v161, v168, v169
  v_fmamk_f32 v164, v172, 0x41c00000, v173
  v_fmamk_f32 v165, v172, 0x41c80000, v173
  v_cos_f32 v166, v164
  v_cos_f32 v167, v165
  v_sin_f32 v168, -v164
  v_sin_f32 v169, -v165
  v_cvt_pk_bf16_f32 v154, v166, v167
  v_cvt_pk_bf16_f32 v162, v168, v169
  v_fmamk_f32 v164, v172, 0x41d00000, v173
  v_fmamk_f32 v165, v172, 0x41d80000, v173
  v_cos_f32 v166, v164
  v_cos_f32 v167, v165
  v_sin_f32 v168, -v164
  v_sin_f32 v169, -v165
  v_cvt_pk_bf16_f32 v155, v166, v167
  v_cvt_pk_bf16_f32 v163, v168, v169
  v_and_b32 v164, 15, v147
  v_lshrrev_b32 v166, 4, v147
  v_lshlrev_b32 v165, 3, v166
  v_and_b32 v167, 7, v147
  v_lshlrev_b32 v167, 4, v167
  v_xor_b32 v165, v165, v167
  v_lshl_add_u32 v165, v164, 10, v165
  s_lshl_b32 s28, s5, 8
  s_add_u32 s28, s28, 65536
  v_add_u32 v136, s28, v165
  v_xor_b32 v137, 32, v136
  v_xor_b32 v138, 64, v136
  v_xor_b32 v139, 96, v136
  v_lshrrev_b32 v165, 1, v164
  s_lshl_b32 s28, s5, 1
  v_xor_b32 v165, s28, v165
  v_lshlrev_b32 v165, 4, v165
  v_lshl_add_u32 v165, v164, 7, v165
  v_lshl_add_u32 v165, v166, 12, v165
  v_add_u32 v178, 147456, v165
  v_xor_b32 v179, 16, v178
  s_lshl_b32 s28, s5, 11
  s_add_u32 s28, s28, 65536
  s_lshl_b32 s29, s5, 5
  v_and_b32 v164, 31, v147
  v_lshlrev_b32 v164, 5, v164
  v_lshrrev_b32 v165, 5, v147
  v_lshl_add_u32 v164, v165, 4, v164
  v_xor_b32 v164, s29, v164
  v_add_u32 v176, s28, v164
  v_xor_b32 v177, 16, v176
  s_add_u32 s28, s28, s29
  s_add_u32 s28, s28, 16
  v_mov_b32 v123, s28
  v_and_b32 v164, 15, v147
  v_lshlrev_b32 v180, 6, v164
  v_bfe_u32 v164, v147, 4, 1
  v_lshl_add_u32 v180, v164, 5, v180
  v_lshrrev_b32 v164, 5, v147
  v_lshl_add_u32 v180, v164, 4, v180
nogap_10:
  s_barrier
  v_mfma_f32_16x16x32_bf16 v[0:3], v[224:227], v[240:243], v[0:3]
  ds_read_b128 v[208:211], v140 offset:0
  v_mfma_f32_16x16x32_bf16 v[4:7], v[228:231], v[240:243], v[4:7]
  ds_read_b64_tr_b16 v[192:193], v141 offset:0
  v_mfma_f32_16x16x32_bf16 v[8:11], v[232:235], v[240:243], v[8:11]
  ds_read_b64_tr_b16 v[194:195], v141 offset:4096
  v_mfma_f32_16x16x32_bf16 v[12:15], v[236:239], v[240:243], v[12:15]
  ds_read_b64_tr_b16 v[196:197], v142 offset:0
  v_mfma_f32_16x16x32_bf16 v[28:31], v[236:239], v[244:247], v[28:31]
  ds_read_b64_tr_b16 v[198:199], v142 offset:4096
  v_mfma_f32_16x16x32_bf16 v[24:27], v[232:235], v[244:247], v[24:27]
  ds_read_b64_tr_b16 v[200:201], v143 offset:0
  v_mfma_f32_16x16x32_bf16 v[20:23], v[228:231], v[244:247], v[20:23]
  ds_read_b64_tr_b16 v[202:203], v143 offset:4096
  v_mfma_f32_16x16x32_bf16 v[16:19], v[224:227], v[244:247], v[16:19]
  ds_read_b64_tr_b16 v[204:205], v144 offset:0
  v_mfma_f32_16x16x32_bf16 v[32:35], v[224:227], v[248:251], v[32:35]
  ds_read_b64_tr_b16 v[206:207], v144 offset:4096
  v_mfma_f32_16x16x32_bf16 v[36:39], v[228:231], v[248:251], v[36:39]
  ds_read_b128 v[212:215], v140 offset:2048
  v_mfma_f32_16x16x32_bf16 v[40:43], v[232:235], v[248:251], v[40:43]
  ds_read_b128 v[216:219], v140 offset:4096
  v_mfma_f32_16x16x32_bf16 v[44:47], v[236:239], v[248:251], v[44:47]
  ds_read_b128 v[220:223], v140 offset:6144
  v_mfma_f32_16x16x32_bf16 v[60:63], v[236:239], v[252:255], v[60:63]
  v_mfma_f32_16x16x32_bf16 v[56:59], v[232:235], v[252:255], v[56:59]
  v_mfma_f32_16x16x32_bf16 v[52:55], v[228:231], v[252:255], v[52:55]
  v_mfma_f32_16x16x32_bf16 v[48:51], v[224:227], v[252:255], v[48:51]
  s_waitcnt lgkmcnt(0)
  v_mfma_f32_16x16x32_bf16 v[0:3], v[192:195], v[208:211], v[0:3]
  ds_read_b128 v[240:243], v140 offset:1024
  v_mfma_f32_16x16x32_bf16 v[4:7], v[196:199], v[208:211], v[4:7]
  ds_read_b64_tr_b16 v[224:225], v141 offset:8192
  v_mfma_f32_16x16x32_bf16 v[8:11], v[200:203], v[208:211], v[8:11]
  ds_read_b64_tr_b16 v[226:227], v141 offset:12288
  v_mfma_f32_16x16x32_bf16 v[12:15], v[204:207], v[208:211], v[12:15]
  ds_read_b64_tr_b16 v[228:229], v142 offset:8192
  v_mfma_f32_16x16x32_bf16 v[28:31], v[204:207], v[212:215], v[28:31]
  ds_read_b64_tr_b16 v[230:231], v142 offset:12288
  v_mfma_f32_16x16x32_bf16 v[24:27], v[200:203], v[212:215], v[24:27]
  ds_read_b64_tr_b16 v[232:233], v143 offset:8192
  v_mfma_f32_16x16x32_bf16 v[20:23], v[196:199], v[212:215], v[20:23]
  ds_read_b64_tr_b16 v[234:235], v143 offset:12288
  v_mfma_f32_16x16x32_bf16 v[16:19], v[192:195], v[212:215], v[16:19]
  ds_read_b64_tr_b16 v[236:237], v144 offset:8192
  v_mfma_f32_16x16x32_bf16 v[32:35], v[192:195], v[216:219], v[32:35]
  ds_read_b64_tr_b16 v[238:239], v144 offset:12288
  v_mfma_f32_16x16x32_bf16 v[36:39], v[196:199], v[216:219], v[36:39]
  ds_read_b128 v[244:247], v140 offset:3072
  v_mfma_f32_16x16x32_bf16 v[40:43], v[200:203], v[216:219], v[40:43]
  ds_read_b128 v[248:251], v140 offset:5120
  v_mfma_f32_16x16x32_bf16 v[44:47], v[204:207], v[216:219], v[44:47]
  ds_read_b128 v[252:255], v140 offset:7168
  v_mfma_f32_16x16x32_bf16 v[60:63], v[204:207], v[220:223], v[60:63]
  v_mfma_f32_16x16x32_bf16 v[56:59], v[200:203], v[220:223], v[56:59]
  v_mfma_f32_16x16x32_bf16 v[52:55], v[196:199], v[220:223], v[52:55]
  v_mfma_f32_16x16x32_bf16 v[48:51], v[192:195], v[220:223], v[48:51]
  s_waitcnt lgkmcnt(0)
  s_barrier
  v_mfma_f32_16x16x32_bf16 v[0:3], v[224:227], v[240:243], v[0:3]
  ds_read_b128 v[208:211], v140 offset:16384
  v_mfma_f32_16x16x32_bf16 v[4:7], v[228:231], v[240:243], v[4:7]
  ds_read_b64_tr_b16 v[192:193], v141 offset:16384
  v_mfma_f32_16x16x32_bf16 v[8:11], v[232:235], v[240:243], v[8:11]
  ds_read_b64_tr_b16 v[194:195], v141 offset:20480
  v_mfma_f32_16x16x32_bf16 v[12:15], v[236:239], v[240:243], v[12:15]
  ds_read_b64_tr_b16 v[196:197], v142 offset:16384
  v_mfma_f32_16x16x32_bf16 v[28:31], v[236:239], v[244:247], v[28:31]
  ds_read_b64_tr_b16 v[198:199], v142 offset:20480
  v_mfma_f32_16x16x32_bf16 v[24:27], v[232:235], v[244:247], v[24:27]
  ds_read_b64_tr_b16 v[200:201], v143 offset:16384
  v_mfma_f32_16x16x32_bf16 v[20:23], v[228:231], v[244:247], v[20:23]
  ds_read_b64_tr_b16 v[202:203], v143 offset:20480
  v_mfma_f32_16x16x32_bf16 v[16:19], v[224:227], v[244:247], v[16:19]
  ds_read_b64_tr_b16 v[204:205], v144 offset:16384
  v_mfma_f32_16x16x32_bf16 v[32:35], v[224:227], v[248:251], v[32:35]
  ds_read_b64_tr_b16 v[206:207], v144 offset:20480
  v_mfma_f32_16x16x32_bf16 v[36:39], v[228:231], v[248:251], v[36:39]
  ds_read_b128 v[212:215], v140 offset:18432
  v_mfma_f32_16x16x32_bf16 v[40:43], v[232:235], v[248:251], v[40:43]
  ds_read_b128 v[216:219], v140 offset:20480
  v_mfma_f32_16x16x32_bf16 v[44:47], v[236:239], v[248:251], v[44:47]
  ds_read_b128 v[220:223], v140 offset:22528
  v_mfma_f32_16x16x32_bf16 v[60:63], v[236:239], v[252:255], v[60:63]
  v_mfma_f32_16x16x32_bf16 v[56:59], v[232:235], v[252:255], v[56:59]
  v_mfma_f32_16x16x32_bf16 v[52:55], v[228:231], v[252:255], v[52:55]
  v_mfma_f32_16x16x32_bf16 v[48:51], v[224:227], v[252:255], v[48:51]
  s_waitcnt lgkmcnt(0)
  v_mfma_f32_16x16x32_bf16 v[0:3], v[192:195], v[208:211], v[0:3]
  ds_read_b128 v[240:243], v140 offset:17408
  v_mfma_f32_16x16x32_bf16 v[4:7], v[196:199], v[208:211], v[4:7]
  ds_read_b64_tr_b16 v[224:225], v141 offset:24576
  v_mfma_f32_16x16x32_bf16 v[8:11], v[200:203], v[208:211], v[8:11]
  ds_read_b64_tr_b16 v[226:227], v141 offset:28672
  v_mfma_f32_16x16x32_bf16 v[12:15], v[204:207], v[208:211], v[12:15]
  ds_read_b64_tr_b16 v[228:229], v142 offset:24576
  v_mfma_f32_16x16x32_bf16 v[28:31], v[204:207], v[212:215], v[28:31]
  ds_read_b64_tr_b16 v[230:231], v142 offset:28672
  v_mfma_f32_16x16x32_bf16 v[24:27], v[200:203], v[212:215], v[24:27]
  ds_read_b64_tr_b16 v[232:233], v143 offset:24576
  v_mfma_f32_16x16x32_bf16 v[20:23], v[196:199], v[212:215], v[20:23]
  ds_read_b64_tr_b16 v[234:235], v143 offset:28672
  v_mfma_f32_16x16x32_bf16 v[16:19], v[192:195], v[212:215], v[16:19]
  ds_read_b64_tr_b16 v[236:237], v144 offset:24576
  v_mfma_f32_16x16x32_bf16 v[32:35], v[192:195], v[216:219], v[32:35]
  ds_read_b64_tr_b16 v[238:239], v144 offset:28672
  v_mfma_f32_16x16x32_bf16 v[36:39], v[196:199], v[216:219], v[36:39]
  ds_read_b128 v[244:247], v140 offset:19456
  v_mfma_f32_16x16x32_bf16 v[40:43], v[200:203], v[216:219], v[40:43]
  ds_read_b128 v[248:251], v140 offset:21504
  v_mfma_f32_16x16x32_bf16 v[44:47], v[204:207], v[216:219], v[44:47]
  ds_read_b128 v[252:255], v140 offset:23552
  v_mfma_f32_16x16x32_bf16 v[60:63], v[204:207], v[220:223], v[60:63]
  v_mfma_f32_16x16x32_bf16 v[56:59], v[200:203], v[220:223], v[56:59]
  v_mfma_f32_16x16x32_bf16 v[52:55], v[196:199], v[220:223], v[52:55]
  v_mfma_f32_16x16x32_bf16 v[48:51], v[192:195], v[220:223], v[48:51]
  s_waitcnt lgkmcnt(0)
  s_barrier
  v_mfma_f32_16x16x32_bf16 v[0:3], v[224:227], v[240:243], v[0:3]
  ds_read_b128 v[208:211], v140 offset:32768
  v_mfma_f32_16x16x32_bf16 v[4:7], v[228:231], v[240:243], v[4:7]
  ds_read_b64_tr_b16 v[192:193], v141 offset:32768
  v_mfma_f32_16x16x32_bf16 v[8:11], v[232:235], v[240:243], v[8:11]
  ds_read_b64_tr_b16 v[194:195], v141 offset:36864
  v_mfma_f32_16x16x32_bf16 v[12:15], v[236:239], v[240:243], v[12:15]
  ds_read_b64_tr_b16 v[196:197], v142 offset:32768
  v_mfma_f32_16x16x32_bf16 v[28:31], v[236:239], v[244:247], v[28:31]
  ds_read_b64_tr_b16 v[198:199], v142 offset:36864
  v_mfma_f32_16x16x32_bf16 v[24:27], v[232:235], v[244:247], v[24:27]
  ds_read_b64_tr_b16 v[200:201], v143 offset:32768
  v_mfma_f32_16x16x32_bf16 v[20:23], v[228:231], v[244:247], v[20:23]
  ds_read_b64_tr_b16 v[202:203], v143 offset:36864
  v_mfma_f32_16x16x32_bf16 v[16:19], v[224:227], v[244:247], v[16:19]
  ds_read_b64_tr_b16 v[204:205], v144 offset:32768
  v_mfma_f32_16x16x32_bf16 v[32:35], v[224:227], v[248:251], v[32:35]
  ds_read_b64_tr_b16 v[206:207], v144 offset:36864
  v_mfma_f32_16x16x32_bf16 v[36:39], v[228:231], v[248:251], v[36:39]
  ds_read_b128 v[212:215], v140 offset:34816
  v_mfma_f32_16x16x32_bf16 v[40:43], v[232:235], v[248:251], v[40:43]
  ds_read_b128 v[216:219], v140 offset:36864
  v_mfma_f32_16x16x32_bf16 v[44:47], v[236:239], v[248:251], v[44:47]
  ds_read_b128 v[220:223], v140 offset:38912
  v_mfma_f32_16x16x32_bf16 v[60:63], v[236:239], v[252:255], v[60:63]
  v_mfma_f32_16x16x32_bf16 v[56:59], v[232:235], v[252:255], v[56:59]
  v_mfma_f32_16x16x32_bf16 v[52:55], v[228:231], v[252:255], v[52:55]
  v_mfma_f32_16x16x32_bf16 v[48:51], v[224:227], v[252:255], v[48:51]
  s_waitcnt lgkmcnt(0)
  v_mfma_f32_16x16x32_bf16 v[0:3], v[192:195], v[208:211], v[0:3]
  ds_read_b128 v[240:243], v140 offset:33792
  v_mfma_f32_16x16x32_bf16 v[4:7], v[196:199], v[208:211], v[4:7]
  ds_read_b64_tr_b16 v[224:225], v141 offset:40960
  v_mfma_f32_16x16x32_bf16 v[8:11], v[200:203], v[208:211], v[8:11]
  ds_read_b64_tr_b16 v[226:227], v141 offset:45056
  v_mfma_f32_16x16x32_bf16 v[12:15], v[204:207], v[208:211], v[12:15]
  ds_read_b64_tr_b16 v[228:229], v142 offset:40960
  v_mfma_f32_16x16x32_bf16 v[28:31], v[204:207], v[212:215], v[28:31]
  ds_read_b64_tr_b16 v[230:231], v142 offset:45056
  v_mfma_f32_16x16x32_bf16 v[24:27], v[200:203], v[212:215], v[24:27]
  ds_read_b64_tr_b16 v[232:233], v143 offset:40960
  v_mfma_f32_16x16x32_bf16 v[20:23], v[196:199], v[212:215], v[20:23]
  ds_read_b64_tr_b16 v[234:235], v143 offset:45056
  v_mfma_f32_16x16x32_bf16 v[16:19], v[192:195], v[212:215], v[16:19]
  ds_read_b64_tr_b16 v[236:237], v144 offset:40960
  v_mfma_f32_16x16x32_bf16 v[32:35], v[192:195], v[216:219], v[32:35]
  ds_read_b64_tr_b16 v[238:239], v144 offset:45056
  v_mfma_f32_16x16x32_bf16 v[36:39], v[196:199], v[216:219], v[36:39]
  ds_read_b128 v[244:247], v140 offset:35840
  v_mfma_f32_16x16x32_bf16 v[40:43], v[200:203], v[216:219], v[40:43]
  ds_read_b128 v[248:251], v140 offset:37888
  v_mfma_f32_16x16x32_bf16 v[44:47], v[204:207], v[216:219], v[44:47]
  ds_read_b128 v[252:255], v140 offset:39936
  v_mfma_f32_16x16x32_bf16 v[60:63], v[204:207], v[220:223], v[60:63]
  v_mfma_f32_16x16x32_bf16 v[56:59], v[200:203], v[220:223], v[56:59]
  v_mfma_f32_16x16x32_bf16 v[52:55], v[196:199], v[220:223], v[52:55]
  v_mfma_f32_16x16x32_bf16 v[48:51], v[192:195], v[220:223], v[48:51]
  s_waitcnt lgkmcnt(0)
  s_barrier
  v_mfma_f32_16x16x32_bf16 v[0:3], v[224:227], v[240:243], v[0:3]
  ds_read_b128 v[208:211], v140 offset:49152
  v_mfma_f32_16x16x32_bf16 v[4:7], v[228:231], v[240:243], v[4:7]
  ds_read_b64_tr_b16 v[192:193], v141 offset:49152
  v_mfma_f32_16x16x32_bf16 v[8:11], v[232:235], v[240:243], v[8:11]
  ds_read_b64_tr_b16 v[194:195], v141 offset:53248
  v_mfma_f32_16x16x32_bf16 v[12:15], v[236:239], v[240:243], v[12:15]
  ds_read_b64_tr_b16 v[196:197], v142 offset:49152
  v_mfma_f32_16x16x32_bf16 v[28:31], v[236:239], v[244:247], v[28:31]
  ds_read_b64_tr_b16 v[198:199], v142 offset:53248
  v_mfma_f32_16x16x32_bf16 v[24:27], v[232:235], v[244:247], v[24:27]
  ds_read_b64_tr_b16 v[200:201], v143 offset:49152
  v_mfma_f32_16x16x32_bf16 v[20:23], v[228:231], v[244:247], v[20:23]
  ds_read_b64_tr_b16 v[202:203], v143 offset:53248
  v_mfma_f32_16x16x32_bf16 v[16:19], v[224:227], v[244:247], v[16:19]
  ds_read_b64_tr_b16 v[204:205], v144 offset:49152
  v_mfma_f32_16x16x32_bf16 v[32:35], v[224:227], v[248:251], v[32:35]
  ds_read_b64_tr_b16 v[206:207], v144 offset:53248
  v_mfma_f32_16x16x32_bf16 v[36:39], v[228:231], v[248:251], v[36:39]
  ds_read_b128 v[212:215], v140 offset:51200
  v_mfma_f32_16x16x32_bf16 v[40:43], v[232:235], v[248:251], v[40:43]
  ds_read_b128 v[216:219], v140 offset:53248
  v_mfma_f32_16x16x32_bf16 v[44:47], v[236:239], v[248:251], v[44:47]
  ds_read_b128 v[220:223], v140 offset:55296
  v_mfma_f32_16x16x32_bf16 v[60:63], v[236:239], v[252:255], v[60:63]
  v_mfma_f32_16x16x32_bf16 v[56:59], v[232:235], v[252:255], v[56:59]
  v_mfma_f32_16x16x32_bf16 v[52:55], v[228:231], v[252:255], v[52:55]
  v_mfma_f32_16x16x32_bf16 v[48:51], v[224:227], v[252:255], v[48:51]
  s_waitcnt lgkmcnt(0)
  v_mfma_f32_16x16x32_bf16 v[0:3], v[192:195], v[208:211], v[0:3]
  ds_read_b128 v[240:243], v140 offset:50176
  v_mfma_f32_16x16x32_bf16 v[4:7], v[196:199], v[208:211], v[4:7]
  ds_read_b64_tr_b16 v[224:225], v141 offset:57344
  v_mfma_f32_16x16x32_bf16 v[8:11], v[200:203], v[208:211], v[8:11]
  ds_read_b64_tr_b16 v[226:227], v141 offset:61440
  v_mfma_f32_16x16x32_bf16 v[12:15], v[204:207], v[208:211], v[12:15]
  ds_read_b64_tr_b16 v[228:229], v142 offset:57344
  v_mfma_f32_16x16x32_bf16 v[28:31], v[204:207], v[212:215], v[28:31]
  ds_read_b64_tr_b16 v[230:231], v142 offset:61440
  v_mfma_f32_16x16x32_bf16 v[24:27], v[200:203], v[212:215], v[24:27]
  ds_read_b64_tr_b16 v[232:233], v143 offset:57344
  v_mfma_f32_16x16x32_bf16 v[20:23], v[196:199], v[212:215], v[20:23]
  ds_read_b64_tr_b16 v[234:235], v143 offset:61440
  v_mfma_f32_16x16x32_bf16 v[16:19], v[192:195], v[212:215], v[16:19]
  ds_read_b64_tr_b16 v[236:237], v144 offset:57344
  v_mfma_f32_16x16x32_bf16 v[32:35], v[192:195], v[216:219], v[32:35]
  ds_read_b64_tr_b16 v[238:239], v144 offset:61440
  v_mfma_f32_16x16x32_bf16 v[36:39], v[196:199], v[216:219], v[36:39]
  ds_read_b128 v[244:247], v140 offset:52224
  v_mfma_f32_16x16x32_bf16 v[40:43], v[200:203], v[216:219], v[40:43]
  ds_read_b128 v[248:251], v140 offset:54272
  v_mfma_f32_16x16x32_bf16 v[44:47], v[204:207], v[216:219], v[44:47]
  ds_read_b128 v[252:255], v140 offset:56320
  v_mfma_f32_16x16x32_bf16 v[60:63], v[204:207], v[220:223], v[60:63]
  v_mfma_f32_16x16x32_bf16 v[56:59], v[200:203], v[220:223], v[56:59]
  v_mfma_f32_16x16x32_bf16 v[52:55], v[196:199], v[220:223], v[52:55]
  v_mfma_f32_16x16x32_bf16 v[48:51], v[192:195], v[220:223], v[48:51]
  s_waitcnt lgkmcnt(0)
  s_barrier
  v_mfma_f32_16x16x32_bf16 v[0:3], v[224:227], v[240:243], v[0:3]
  ds_read_b128 v[208:211], v140 offset:0
  v_mfma_f32_16x16x32_bf16 v[4:7], v[228:231], v[240:243], v[4:7]
  ds_read_b64_tr_b16 v[192:193], v141 offset:0
  v_mfma_f32_16x16x32_bf16 v[8:11], v[232:235], v[240:243], v[8:11]
  ds_read_b64_tr_b16 v[194:195], v141 offset:4096
  v_mfma_f32_16x16x32_bf16 v[12:15], v[236:239], v[240:243], v[12:15]
  ds_read_b64_tr_b16 v[196:197], v142 offset:0
  v_mfma_f32_16x16x32_bf16 v[28:31], v[236:239], v[244:247], v[28:31]
  ds_read_b64_tr_b16 v[198:199], v142 offset:4096
  v_mfma_f32_16x16x32_bf16 v[24:27], v[232:235], v[244:247], v[24:27]
  ds_read_b64_tr_b16 v[200:201], v143 offset:0
  v_mfma_f32_16x16x32_bf16 v[20:23], v[228:231], v[244:247], v[20:23]
  ds_read_b64_tr_b16 v[202:203], v143 offset:4096
  v_mfma_f32_16x16x32_bf16 v[16:19], v[224:227], v[244:247], v[16:19]
  ds_read_b64_tr_b16 v[204:205], v144 offset:0
  v_mfma_f32_16x16x32_bf16 v[32:35], v[224:227], v[248:251], v[32:35]
  ds_read_b64_tr_b16 v[206:207], v144 offset:4096
  v_mfma_f32_16x16x32_bf16 v[36:39], v[228:231], v[248:251], v[36:39]
  ds_read_b128 v[212:215], v140 offset:2048
  v_mfma_f32_16x16x32_bf16 v[40:43], v[232:235], v[248:251], v[40:43]
  ds_read_b128 v[216:219], v140 offset:4096
  v_mfma_f32_16x16x32_bf16 v[44:47], v[236:239], v[248:251], v[44:47]
  ds_read_b128 v[220:223], v140 offset:6144
  v_mfma_f32_16x16x32_bf16 v[60:63], v[236:239], v[252:255], v[60:63]
  v_mfma_f32_16x16x32_bf16 v[56:59], v[232:235], v[252:255], v[56:59]
  v_mfma_f32_16x16x32_bf16 v[52:55], v[228:231], v[252:255], v[52:55]
  v_mfma_f32_16x16x32_bf16 v[48:51], v[224:227], v[252:255], v[48:51]
  s_waitcnt lgkmcnt(0)
  v_mfma_f32_16x16x32_bf16 v[0:3], v[192:195], v[208:211], v[0:3]
  ds_read_b128 v[240:243], v140 offset:1024
  v_mfma_f32_16x16x32_bf16 v[4:7], v[196:199], v[208:211], v[4:7]
  ds_read_b64_tr_b16 v[224:225], v141 offset:8192
  v_mfma_f32_16x16x32_bf16 v[8:11], v[200:203], v[208:211], v[8:11]
  ds_read_b64_tr_b16 v[226:227], v141 offset:12288
  v_mfma_f32_16x16x32_bf16 v[12:15], v[204:207], v[208:211], v[12:15]
  ds_read_b64_tr_b16 v[228:229], v142 offset:8192
  v_mfma_f32_16x16x32_bf16 v[28:31], v[204:207], v[212:215], v[28:31]
  ds_read_b64_tr_b16 v[230:231], v142 offset:12288
  v_mfma_f32_16x16x32_bf16 v[24:27], v[200:203], v[212:215], v[24:27]
  ds_read_b64_tr_b16 v[232:233], v143 offset:8192
  v_mfma_f32_16x16x32_bf16 v[20:23], v[196:199], v[212:215], v[20:23]
  ds_read_b64_tr_b16 v[234:235], v143 offset:12288
  v_mfma_f32_16x16x32_bf16 v[16:19], v[192:195], v[212:215], v[16:19]
  ds_read_b64_tr_b16 v[236:237], v144 offset:8192
  v_mfma_f32_16x16x32_bf16 v[32:35], v[192:195], v[216:219], v[32:35]
  ds_read_b64_tr_b16 v[238:239], v144 offset:12288
  v_mfma_f32_16x16x32_bf16 v[36:39], v[196:199], v[216:219], v[36:39]
  ds_read_b128 v[244:247], v140 offset:3072
  v_mfma_f32_16x16x32_bf16 v[40:43], v[200:203], v[216:219], v[40:43]
  ds_read_b128 v[248:251], v140 offset:5120
  v_mfma_f32_16x16x32_bf16 v[44:47], v[204:207], v[216:219], v[44:47]
  ds_read_b128 v[252:255], v140 offset:7168
  v_mfma_f32_16x16x32_bf16 v[60:63], v[204:207], v[220:223], v[60:63]
  v_mfma_f32_16x16x32_bf16 v[56:59], v[200:203], v[220:223], v[56:59]
  v_mfma_f32_16x16x32_bf16 v[52:55], v[196:199], v[220:223], v[52:55]
  v_mfma_f32_16x16x32_bf16 v[48:51], v[192:195], v[220:223], v[48:51]
  s_waitcnt lgkmcnt(0)
  s_barrier
  v_mfma_f32_16x16x32_bf16 v[0:3], v[224:227], v[240:243], v[0:3]
  ds_read_b128 v[208:211], v140 offset:16384
  v_mfma_f32_16x16x32_bf16 v[4:7], v[228:231], v[240:243], v[4:7]
  ds_read_b64_tr_b16 v[192:193], v141 offset:16384
  v_mfma_f32_16x16x32_bf16 v[8:11], v[232:235], v[240:243], v[8:11]
  ds_read_b64_tr_b16 v[194:195], v141 offset:20480
  v_mfma_f32_16x16x32_bf16 v[12:15], v[236:239], v[240:243], v[12:15]
  ds_read_b64_tr_b16 v[196:197], v142 offset:16384
  v_mfma_f32_16x16x32_bf16 v[28:31], v[236:239], v[244:247], v[28:31]
  ds_read_b64_tr_b16 v[198:199], v142 offset:20480
  v_mfma_f32_16x16x32_bf16 v[24:27], v[232:235], v[244:247], v[24:27]
  ds_read_b64_tr_b16 v[200:201], v143 offset:16384
  v_mfma_f32_16x16x32_bf16 v[20:23], v[228:231], v[244:247], v[20:23]
  ds_read_b64_tr_b16 v[202:203], v143 offset:20480
  v_mfma_f32_16x16x32_bf16 v[16:19], v[224:227], v[244:247], v[16:19]
  ds_read_b64_tr_b16 v[204:205], v144 offset:16384
  v_mfma_f32_16x16x32_bf16 v[32:35], v[224:227], v[248:251], v[32:35]
  ds_read_b64_tr_b16 v[206:207], v144 offset:20480
  v_mfma_f32_16x16x32_bf16 v[36:39], v[228:231], v[248:251], v[36:39]
  ds_read_b128 v[212:215], v140 offset:18432
  v_mfma_f32_16x16x32_bf16 v[40:43], v[232:235], v[248:251], v[40:43]
  ds_read_b128 v[216:219], v140 offset:20480
  v_mfma_f32_16x16x32_bf16 v[44:47], v[236:239], v[248:251], v[44:47]
  ds_read_b128 v[220:223], v140 offset:22528
  v_mfma_f32_16x16x32_bf16 v[60:63], v[236:239], v[252:255], v[60:63]
  v_mfma_f32_16x16x32_bf16 v[56:59], v[232:235], v[252:255], v[56:59]
  v_mfma_f32_16x16x32_bf16 v[52:55], v[228:231], v[252:255], v[52:55]
  v_mfma_f32_16x16x32_bf16 v[48:51], v[224:227], v[252:255], v[48:51]
  s_waitcnt lgkmcnt(0)
  v_mfma_f32_16x16x32_bf16 v[0:3], v[192:195], v[208:211], v[0:3]
  ds_read_b128 v[240:243], v140 offset:17408
  v_mfma_f32_16x16x32_bf16 v[4:7], v[196:199], v[208:211], v[4:7]
  ds_read_b64_tr_b16 v[224:225], v141 offset:24576
  v_mfma_f32_16x16x32_bf16 v[8:11], v[200:203], v[208:211], v[8:11]
  ds_read_b64_tr_b16 v[226:227], v141 offset:28672
  v_mfma_f32_16x16x32_bf16 v[12:15], v[204:207], v[208:211], v[12:15]
  ds_read_b64_tr_b16 v[228:229], v142 offset:24576
  v_mfma_f32_16x16x32_bf16 v[28:31], v[204:207], v[212:215], v[28:31]
  ds_read_b64_tr_b16 v[230:231], v142 offset:28672
  v_mfma_f32_16x16x32_bf16 v[24:27], v[200:203], v[212:215], v[24:27]
  ds_read_b64_tr_b16 v[232:233], v143 offset:24576
  v_mfma_f32_16x16x32_bf16 v[20:23], v[196:199], v[212:215], v[20:23]
  ds_read_b64_tr_b16 v[234:235], v143 offset:28672
  v_mfma_f32_16x16x32_bf16 v[16:19], v[192:195], v[212:215], v[16:19]
  ds_read_b64_tr_b16 v[236:237], v144 offset:24576
  v_mfma_f32_16x16x32_bf16 v[32:35], v[192:195], v[216:219], v[32:35]
  ds_read_b64_tr_b16 v[238:239], v144 offset:28672
  v_mfma_f32_16x16x32_bf16 v[36:39], v[196:199], v[216:219], v[36:39]
  ds_read_b128 v[244:247], v140 offset:19456
  v_mfma_f32_16x16x32_bf16 v[40:43], v[200:203], v[216:219], v[40:43]
  ds_read_b128 v[248:251], v140 offset:21504
  v_mfma_f32_16x16x32_bf16 v[44:47], v[204:207], v[216:219], v[44:47]
  ds_read_b128 v[252:255], v140 offset:23552
  v_mfma_f32_16x16x32_bf16 v[60:63], v[204:207], v[220:223], v[60:63]
  v_mfma_f32_16x16x32_bf16 v[56:59], v[200:203], v[220:223], v[56:59]
  v_mfma_f32_16x16x32_bf16 v[52:55], v[196:199], v[220:223], v[52:55]
  v_mfma_f32_16x16x32_bf16 v[48:51], v[192:195], v[220:223], v[48:51]
  s_waitcnt lgkmcnt(0)
  s_barrier
  v_mfma_f32_16x16x32_bf16 v[0:3], v[224:227], v[240:243], v[0:3]
  ds_read_b128 v[208:211], v140 offset:32768
  v_mfma_f32_16x16x32_bf16 v[4:7], v[228:231], v[240:243], v[4:7]
  ds_read_b64_tr_b16 v[192:193], v141 offset:32768
  v_mfma_f32_16x16x32_bf16 v[8:11], v[232:235], v[240:243], v[8:11]
  ds_read_b64_tr_b16 v[194:195], v141 offset:36864
  v_mfma_f32_16x16x32_bf16 v[12:15], v[236:239], v[240:243], v[12:15]
  ds_read_b64_tr_b16 v[196:197], v142 offset:32768
  v_mfma_f32_16x16x32_bf16 v[28:31], v[236:239], v[244:247], v[28:31]
  ds_read_b64_tr_b16 v[198:199], v142 offset:36864
  v_mfma_f32_16x16x32_bf16 v[24:27], v[232:235], v[244:247], v[24:27]
  ds_read_b64_tr_b16 v[200:201], v143 offset:32768
  v_mfma_f32_16x16x32_bf16 v[20:23], v[228:231], v[244:247], v[20:23]
  ds_read_b64_tr_b16 v[202:203], v143 offset:36864
  v_mfma_f32_16x16x32_bf16 v[16:19], v[224:227], v[244:247], v[16:19]
  ds_read_b64_tr_b16 v[204:205], v144 offset:32768
  v_mfma_f32_16x16x32_bf16 v[32:35], v[224:227], v[248:251], v[32:35]
  ds_read_b64_tr_b16 v[206:207], v144 offset:36864
  v_mfma_f32_16x16x32_bf16 v[36:39], v[228:231], v[248:251], v[36:39]
  ds_read_b128 v[212:215], v140 offset:34816
  v_mfma_f32_16x16x32_bf16 v[40:43], v[232:235], v[248:251], v[40:43]
  ds_read_b128 v[216:219], v140 offset:36864
  v_mfma_f32_16x16x32_bf16 v[44:47], v[236:239], v[248:251], v[44:47]
  ds_read_b128 v[220:223], v140 offset:38912
  v_mfma_f32_16x16x32_bf16 v[60:63], v[236:239], v[252:255], v[60:63]
  v_mfma_f32_16x16x32_bf16 v[56:59], v[232:235], v[252:255], v[56:59]
  v_mfma_f32_16x16x32_bf16 v[52:55], v[228:231], v[252:255], v[52:55]
  v_mfma_f32_16x16x32_bf16 v[48:51], v[224:227], v[252:255], v[48:51]
  s_waitcnt lgkmcnt(0)
  v_mfma_f32_16x16x32_bf16 v[0:3], v[192:195], v[208:211], v[0:3]
  ds_read_b128 v[240:243], v140 offset:33792
  v_mfma_f32_16x16x32_bf16 v[4:7], v[196:199], v[208:211], v[4:7]
  ds_read_b64_tr_b16 v[224:225], v141 offset:40960
  v_mfma_f32_16x16x32_bf16 v[8:11], v[200:203], v[208:211], v[8:11]
  ds_read_b64_tr_b16 v[226:227], v141 offset:45056
  v_mfma_f32_16x16x32_bf16 v[12:15], v[204:207], v[208:211], v[12:15]
  ds_read_b64_tr_b16 v[228:229], v142 offset:40960
  v_mfma_f32_16x16x32_bf16 v[28:31], v[204:207], v[212:215], v[28:31]
  ds_read_b64_tr_b16 v[230:231], v142 offset:45056
  v_mfma_f32_16x16x32_bf16 v[24:27], v[200:203], v[212:215], v[24:27]
  ds_read_b64_tr_b16 v[232:233], v143 offset:40960
  v_mfma_f32_16x16x32_bf16 v[20:23], v[196:199], v[212:215], v[20:23]
  ds_read_b64_tr_b16 v[234:235], v143 offset:45056
  v_mfma_f32_16x16x32_bf16 v[16:19], v[192:195], v[212:215], v[16:19]
  ds_read_b64_tr_b16 v[236:237], v144 offset:40960
  v_mfma_f32_16x16x32_bf16 v[32:35], v[192:195], v[216:219], v[32:35]
  ds_read_b64_tr_b16 v[238:239], v144 offset:45056
  v_mfma_f32_16x16x32_bf16 v[36:39], v[196:199], v[216:219], v[36:39]
  ds_read_b128 v[244:247], v140 offset:35840
  v_mfma_f32_16x16x32_bf16 v[40:43], v[200:203], v[216:219], v[40:43]
  ds_read_b128 v[248:251], v140 offset:37888
  v_mfma_f32_16x16x32_bf16 v[44:47], v[204:207], v[216:219], v[44:47]
  ds_read_b128 v[252:255], v140 offset:39936
  v_mfma_f32_16x16x32_bf16 v[60:63], v[204:207], v[220:223], v[60:63]
  v_mfma_f32_16x16x32_bf16 v[56:59], v[200:203], v[220:223], v[56:59]
  v_mfma_f32_16x16x32_bf16 v[52:55], v[196:199], v[220:223], v[52:55]
  v_mfma_f32_16x16x32_bf16 v[48:51], v[192:195], v[220:223], v[48:51]
  s_waitcnt lgkmcnt(0)
  s_barrier
  v_mfma_f32_16x16x32_bf16 v[0:3], v[224:227], v[240:243], v[0:3]
  ds_read_b128 v[208:211], v140 offset:49152
  v_mfma_f32_16x16x32_bf16 v[4:7], v[228:231], v[240:243], v[4:7]
  ds_read_b64_tr_b16 v[192:193], v141 offset:49152
  v_mfma_f32_16x16x32_bf16 v[8:11], v[232:235], v[240:243], v[8:11]
  ds_read_b64_tr_b16 v[194:195], v141 offset:53248
  v_mfma_f32_16x16x32_bf16 v[12:15], v[236:239], v[240:243], v[12:15]
  ds_read_b64_tr_b16 v[196:197], v142 offset:49152
  v_mfma_f32_16x16x32_bf16 v[28:31], v[236:239], v[244:247], v[28:31]
  ds_read_b64_tr_b16 v[198:199], v142 offset:53248
  v_mfma_f32_16x16x32_bf16 v[24:27], v[232:235], v[244:247], v[24:27]
  ds_read_b64_tr_b16 v[200:201], v143 offset:49152
  v_mfma_f32_16x16x32_bf16 v[20:23], v[228:231], v[244:247], v[20:23]
  ds_read_b64_tr_b16 v[202:203], v143 offset:53248
  v_mfma_f32_16x16x32_bf16 v[16:19], v[224:227], v[244:247], v[16:19]
  ds_read_b64_tr_b16 v[204:205], v144 offset:49152
  v_mfma_f32_16x16x32_bf16 v[32:35], v[224:227], v[248:251], v[32:35]
  ds_read_b64_tr_b16 v[206:207], v144 offset:53248
  v_mfma_f32_16x16x32_bf16 v[36:39], v[228:231], v[248:251], v[36:39]
  ds_read_b128 v[212:215], v140 offset:51200
  v_mfma_f32_16x16x32_bf16 v[40:43], v[232:235], v[248:251], v[40:43]
  ds_read_b128 v[216:219], v140 offset:53248
  v_mfma_f32_16x16x32_bf16 v[44:47], v[236:239], v[248:251], v[44:47]
  ds_read_b128 v[220:223], v140 offset:55296
  v_mfma_f32_16x16x32_bf16 v[60:63], v[236:239], v[252:255], v[60:63]
  v_mfma_f32_16x16x32_bf16 v[56:59], v[232:235], v[252:255], v[56:59]
  v_mfma_f32_16x16x32_bf16 v[52:55], v[228:231], v[252:255], v[52:55]
  v_mfma_f32_16x16x32_bf16 v[48:51], v[224:227], v[252:255], v[48:51]
  s_waitcnt lgkmcnt(0)
  v_mfma_f32_16x16x32_bf16 v[0:3], v[192:195], v[208:211], v[0:3]
  ds_read_b128 v[240:243], v140 offset:50176
  v_mfma_f32_16x16x32_bf16 v[4:7], v[196:199], v[208:211], v[4:7]
  ds_read_b64_tr_b16 v[224:225], v141 offset:57344
  v_mfma_f32_16x16x32_bf16 v[8:11], v[200:203], v[208:211], v[8:11]
  ds_read_b64_tr_b16 v[226:227], v141 offset:61440
  v_mfma_f32_16x16x32_bf16 v[12:15], v[204:207], v[208:211], v[12:15]
  ds_read_b64_tr_b16 v[228:229], v142 offset:57344
  v_mfma_f32_16x16x32_bf16 v[28:31], v[204:207], v[212:215], v[28:31]
  ds_read_b64_tr_b16 v[230:231], v142 offset:61440
  v_mfma_f32_16x16x32_bf16 v[24:27], v[200:203], v[212:215], v[24:27]
  ds_read_b64_tr_b16 v[232:233], v143 offset:57344
  v_mfma_f32_16x16x32_bf16 v[20:23], v[196:199], v[212:215], v[20:23]
  ds_read_b64_tr_b16 v[234:235], v143 offset:61440
  v_mfma_f32_16x16x32_bf16 v[16:19], v[192:195], v[212:215], v[16:19]
  ds_read_b64_tr_b16 v[236:237], v144 offset:57344
  v_mfma_f32_16x16x32_bf16 v[32:35], v[192:195], v[216:219], v[32:35]
  ds_read_b64_tr_b16 v[238:239], v144 offset:61440
  v_mfma_f32_16x16x32_bf16 v[36:39], v[196:199], v[216:219], v[36:39]
  ds_read_b128 v[244:247], v140 offset:52224
  v_mfma_f32_16x16x32_bf16 v[40:43], v[200:203], v[216:219], v[40:43]
  ds_read_b128 v[248:251], v140 offset:54272
  v_mfma_f32_16x16x32_bf16 v[44:47], v[204:207], v[216:219], v[44:47]
  ds_read_b128 v[252:255], v140 offset:56320
  v_mfma_f32_16x16x32_bf16 v[60:63], v[204:207], v[220:223], v[60:63]
  v_mfma_f32_16x16x32_bf16 v[56:59], v[200:203], v[220:223], v[56:59]
  v_mfma_f32_16x16x32_bf16 v[52:55], v[196:199], v[220:223], v[52:55]
  v_mfma_f32_16x16x32_bf16 v[48:51], v[192:195], v[220:223], v[48:51]
  s_waitcnt lgkmcnt(0)
  s_barrier
  v_mfma_f32_16x16x32_bf16 v[0:3], v[224:227], v[240:243], v[0:3]
  ds_read_b128 v[208:211], v140 offset:0
  v_mfma_f32_16x16x32_bf16 v[4:7], v[228:231], v[240:243], v[4:7]
  ds_read_b64_tr_b16 v[192:193], v141 offset:0
  v_mfma_f32_16x16x32_bf16 v[8:11], v[232:235], v[240:243], v[8:11]
  ds_read_b64_tr_b16 v[194:195], v141 offset:4096
  v_mfma_f32_16x16x32_bf16 v[12:15], v[236:239], v[240:243], v[12:15]
  ds_read_b64_tr_b16 v[196:197], v142 offset:0
  v_mfma_f32_16x16x32_bf16 v[28:31], v[236:239], v[244:247], v[28:31]
  ds_read_b64_tr_b16 v[198:199], v142 offset:4096
  v_mfma_f32_16x16x32_bf16 v[24:27], v[232:235], v[244:247], v[24:27]
  ds_read_b64_tr_b16 v[200:201], v143 offset:0
  v_mfma_f32_16x16x32_bf16 v[20:23], v[228:231], v[244:247], v[20:23]
  ds_read_b64_tr_b16 v[202:203], v143 offset:4096
  v_mfma_f32_16x16x32_bf16 v[16:19], v[224:227], v[244:247], v[16:19]
  ds_read_b64_tr_b16 v[204:205], v144 offset:0
  v_mfma_f32_16x16x32_bf16 v[32:35], v[224:227], v[248:251], v[32:35]
  ds_read_b64_tr_b16 v[206:207], v144 offset:4096
  v_mfma_f32_16x16x32_bf16 v[36:39], v[228:231], v[248:251], v[36:39]
  ds_read_b128 v[212:215], v140 offset:2048
  v_mfma_f32_16x16x32_bf16 v[40:43], v[232:235], v[248:251], v[40:43]
  ds_read_b128 v[216:219], v140 offset:4096
  v_mfma_f32_16x16x32_bf16 v[44:47], v[236:239], v[248:251], v[44:47]
  ds_read_b128 v[220:223], v140 offset:6144
  v_mfma_f32_16x16x32_bf16 v[60:63], v[236:239], v[252:255], v[60:63]
  v_mfma_f32_16x16x32_bf16 v[56:59], v[232:235], v[252:255], v[56:59]
  v_mfma_f32_16x16x32_bf16 v[52:55], v[228:231], v[252:255], v[52:55]
  v_mfma_f32_16x16x32_bf16 v[48:51], v[224:227], v[252:255], v[48:51]
  s_waitcnt lgkmcnt(0)
  v_mfma_f32_16x16x32_bf16 v[0:3], v[192:195], v[208:211], v[0:3]
  ds_read_b128 v[240:243], v140 offset:1024
  v_mfma_f32_16x16x32_bf16 v[4:7], v[196:199], v[208:211], v[4:7]
  ds_read_b64_tr_b16 v[224:225], v141 offset:8192
  v_mfma_f32_16x16x32_bf16 v[8:11], v[200:203], v[208:211], v[8:11]
  ds_read_b64_tr_b16 v[226:227], v141 offset:12288
  v_mfma_f32_16x16x32_bf16 v[12:15], v[204:207], v[208:211], v[12:15]
  ds_read_b64_tr_b16 v[228:229], v142 offset:8192
  v_mfma_f32_16x16x32_bf16 v[28:31], v[204:207], v[212:215], v[28:31]
  ds_read_b64_tr_b16 v[230:231], v142 offset:12288
  v_mfma_f32_16x16x32_bf16 v[24:27], v[200:203], v[212:215], v[24:27]
  ds_read_b64_tr_b16 v[232:233], v143 offset:8192
  v_mfma_f32_16x16x32_bf16 v[20:23], v[196:199], v[212:215], v[20:23]
  ds_read_b64_tr_b16 v[234:235], v143 offset:12288
  v_mfma_f32_16x16x32_bf16 v[16:19], v[192:195], v[212:215], v[16:19]
  ds_read_b64_tr_b16 v[236:237], v144 offset:8192
  v_mfma_f32_16x16x32_bf16 v[32:35], v[192:195], v[216:219], v[32:35]
  ds_read_b64_tr_b16 v[238:239], v144 offset:12288
  v_mfma_f32_16x16x32_bf16 v[36:39], v[196:199], v[216:219], v[36:39]
  ds_read_b128 v[244:247], v140 offset:3072
  v_mfma_f32_16x16x32_bf16 v[40:43], v[200:203], v[216:219], v[40:43]
  ds_read_b128 v[248:251], v140 offset:5120
  v_mfma_f32_16x16x32_bf16 v[44:47], v[204:207], v[216:219], v[44:47]
  ds_read_b128 v[252:255], v140 offset:7168
  v_mfma_f32_16x16x32_bf16 v[60:63], v[204:207], v[220:223], v[60:63]
  v_mfma_f32_16x16x32_bf16 v[56:59], v[200:203], v[220:223], v[56:59]
  v_mfma_f32_16x16x32_bf16 v[52:55], v[196:199], v[220:223], v[52:55]
  v_mfma_f32_16x16x32_bf16 v[48:51], v[192:195], v[220:223], v[48:51]
  s_waitcnt lgkmcnt(0)
  s_barrier
  v_mfma_f32_16x16x32_bf16 v[0:3], v[224:227], v[240:243], v[0:3]
  ds_read_b128 v[208:211], v140 offset:16384
  v_mfma_f32_16x16x32_bf16 v[4:7], v[228:231], v[240:243], v[4:7]
  ds_read_b64_tr_b16 v[192:193], v141 offset:16384
  v_mfma_f32_16x16x32_bf16 v[8:11], v[232:235], v[240:243], v[8:11]
  ds_read_b64_tr_b16 v[194:195], v141 offset:20480
  v_mfma_f32_16x16x32_bf16 v[12:15], v[236:239], v[240:243], v[12:15]
  ds_read_b64_tr_b16 v[196:197], v142 offset:16384
  v_mfma_f32_16x16x32_bf16 v[28:31], v[236:239], v[244:247], v[28:31]
  ds_read_b64_tr_b16 v[198:199], v142 offset:20480
  v_mfma_f32_16x16x32_bf16 v[24:27], v[232:235], v[244:247], v[24:27]
  ds_read_b64_tr_b16 v[200:201], v143 offset:16384
  v_mfma_f32_16x16x32_bf16 v[20:23], v[228:231], v[244:247], v[20:23]
  ds_read_b64_tr_b16 v[202:203], v143 offset:20480
  v_mfma_f32_16x16x32_bf16 v[16:19], v[224:227], v[244:247], v[16:19]
  ds_read_b64_tr_b16 v[204:205], v144 offset:16384
  v_mfma_f32_16x16x32_bf16 v[32:35], v[224:227], v[248:251], v[32:35]
  ds_read_b64_tr_b16 v[206:207], v144 offset:20480
  v_mfma_f32_16x16x32_bf16 v[36:39], v[228:231], v[248:251], v[36:39]
  ds_read_b128 v[212:215], v140 offset:18432
  v_mfma_f32_16x16x32_bf16 v[40:43], v[232:235], v[248:251], v[40:43]
  ds_read_b128 v[216:219], v140 offset:20480
  v_mfma_f32_16x16x32_bf16 v[44:47], v[236:239], v[248:251], v[44:47]
  ds_read_b128 v[220:223], v140 offset:22528
  v_mfma_f32_16x16x32_bf16 v[60:63], v[236:239], v[252:255], v[60:63]
  v_mfma_f32_16x16x32_bf16 v[56:59], v[232:235], v[252:255], v[56:59]
  v_mfma_f32_16x16x32_bf16 v[52:55], v[228:231], v[252:255], v[52:55]
  v_mfma_f32_16x16x32_bf16 v[48:51], v[224:227], v[252:255], v[48:51]
  s_waitcnt lgkmcnt(0)
  v_mfma_f32_16x16x32_bf16 v[0:3], v[192:195], v[208:211], v[0:3]
  ds_read_b128 v[240:243], v140 offset:17408
  v_mfma_f32_16x16x32_bf16 v[4:7], v[196:199], v[208:211], v[4:7]
  ds_read_b64_tr_b16 v[224:225], v141 offset:24576
  v_mfma_f32_16x16x32_bf16 v[8:11], v[200:203], v[208:211], v[8:11]
  ds_read_b64_tr_b16 v[226:227], v141 offset:28672
  v_mfma_f32_16x16x32_bf16 v[12:15], v[204:207], v[208:211], v[12:15]
  ds_read_b64_tr_b16 v[228:229], v142 offset:24576
  v_mfma_f32_16x16x32_bf16 v[28:31], v[204:207], v[212:215], v[28:31]
  ds_read_b64_tr_b16 v[230:231], v142 offset:28672
  v_mfma_f32_16x16x32_bf16 v[24:27], v[200:203], v[212:215], v[24:27]
  ds_read_b64_tr_b16 v[232:233], v143 offset:24576
  v_mfma_f32_16x16x32_bf16 v[20:23], v[196:199], v[212:215], v[20:23]
  ds_read_b64_tr_b16 v[234:235], v143 offset:28672
  v_mfma_f32_16x16x32_bf16 v[16:19], v[192:195], v[212:215], v[16:19]
  ds_read_b64_tr_b16 v[236:237], v144 offset:24576
  v_mfma_f32_16x16x32_bf16 v[32:35], v[192:195], v[216:219], v[32:35]
  ds_read_b64_tr_b16 v[238:239], v144 offset:28672
  v_mfma_f32_16x16x32_bf16 v[36:39], v[196:199], v[216:219], v[36:39]
  ds_read_b128 v[244:247], v140 offset:19456
  v_mfma_f32_16x16x32_bf16 v[40:43], v[200:203], v[216:219], v[40:43]
  ds_read_b128 v[248:251], v140 offset:21504
  v_mfma_f32_16x16x32_bf16 v[44:47], v[204:207], v[216:219], v[44:47]
  ds_read_b128 v[252:255], v140 offset:23552
  v_mfma_f32_16x16x32_bf16 v[60:63], v[204:207], v[220:223], v[60:63]
  v_mfma_f32_16x16x32_bf16 v[56:59], v[200:203], v[220:223], v[56:59]
  v_mfma_f32_16x16x32_bf16 v[52:55], v[196:199], v[220:223], v[52:55]
  v_mfma_f32_16x16x32_bf16 v[48:51], v[192:195], v[220:223], v[48:51]
  s_waitcnt lgkmcnt(0)
  s_barrier
  v_mfma_f32_16x16x32_bf16 v[0:3], v[224:227], v[240:243], v[0:3]
  ds_read_b128 v[208:211], v140 offset:32768
  v_mfma_f32_16x16x32_bf16 v[4:7], v[228:231], v[240:243], v[4:7]
  ds_read_b64_tr_b16 v[192:193], v141 offset:32768
  v_mfma_f32_16x16x32_bf16 v[8:11], v[232:235], v[240:243], v[8:11]
  ds_read_b64_tr_b16 v[194:195], v141 offset:36864
  v_mfma_f32_16x16x32_bf16 v[12:15], v[236:239], v[240:243], v[12:15]
  ds_read_b64_tr_b16 v[196:197], v142 offset:32768
  v_mfma_f32_16x16x32_bf16 v[28:31], v[236:239], v[244:247], v[28:31]
  ds_read_b64_tr_b16 v[198:199], v142 offset:36864
  v_mfma_f32_16x16x32_bf16 v[24:27], v[232:235], v[244:247], v[24:27]
  ds_read_b64_tr_b16 v[200:201], v143 offset:32768
  v_mfma_f32_16x16x32_bf16 v[20:23], v[228:231], v[244:247], v[20:23]
  ds_read_b64_tr_b16 v[202:203], v143 offset:36864
  v_mfma_f32_16x16x32_bf16 v[16:19], v[224:227], v[244:247], v[16:19]
  ds_read_b64_tr_b16 v[204:205], v144 offset:32768
  v_mfma_f32_16x16x32_bf16 v[32:35], v[224:227], v[248:251], v[32:35]
  ds_read_b64_tr_b16 v[206:207], v144 offset:36864
  v_mfma_f32_16x16x32_bf16 v[36:39], v[228:231], v[248:251], v[36:39]
  ds_read_b128 v[212:215], v140 offset:34816
  v_mfma_f32_16x16x32_bf16 v[40:43], v[232:235], v[248:251], v[40:43]
  ds_read_b128 v[216:219], v140 offset:36864
  v_mfma_f32_16x16x32_bf16 v[44:47], v[236:239], v[248:251], v[44:47]
  ds_read_b128 v[220:223], v140 offset:38912
  v_mfma_f32_16x16x32_bf16 v[60:63], v[236:239], v[252:255], v[60:63]
  v_mfma_f32_16x16x32_bf16 v[56:59], v[232:235], v[252:255], v[56:59]
  v_mfma_f32_16x16x32_bf16 v[52:55], v[228:231], v[252:255], v[52:55]
  v_mfma_f32_16x16x32_bf16 v[48:51], v[224:227], v[252:255], v[48:51]
  s_waitcnt lgkmcnt(0)
  v_mfma_f32_16x16x32_bf16 v[0:3], v[192:195], v[208:211], v[0:3]
  ds_read_b128 v[240:243], v140 offset:33792
  v_mfma_f32_16x16x32_bf16 v[4:7], v[196:199], v[208:211], v[4:7]
  ds_read_b64_tr_b16 v[224:225], v141 offset:40960
  v_mfma_f32_16x16x32_bf16 v[8:11], v[200:203], v[208:211], v[8:11]
  ds_read_b64_tr_b16 v[226:227], v141 offset:45056
  v_mfma_f32_16x16x32_bf16 v[12:15], v[204:207], v[208:211], v[12:15]
  ds_read_b64_tr_b16 v[228:229], v142 offset:40960
  v_mfma_f32_16x16x32_bf16 v[28:31], v[204:207], v[212:215], v[28:31]
  ds_read_b64_tr_b16 v[230:231], v142 offset:45056
  v_mfma_f32_16x16x32_bf16 v[24:27], v[200:203], v[212:215], v[24:27]
  ds_read_b64_tr_b16 v[232:233], v143 offset:40960
  v_mfma_f32_16x16x32_bf16 v[20:23], v[196:199], v[212:215], v[20:23]
  ds_read_b64_tr_b16 v[234:235], v143 offset:45056
  v_mfma_f32_16x16x32_bf16 v[16:19], v[192:195], v[212:215], v[16:19]
  ds_read_b64_tr_b16 v[236:237], v144 offset:40960
  v_mfma_f32_16x16x32_bf16 v[32:35], v[192:195], v[216:219], v[32:35]
  ds_read_b64_tr_b16 v[238:239], v144 offset:45056
  v_mfma_f32_16x16x32_bf16 v[36:39], v[196:199], v[216:219], v[36:39]
  ds_read_b128 v[244:247], v140 offset:35840
  v_mfma_f32_16x16x32_bf16 v[40:43], v[200:203], v[216:219], v[40:43]
  ds_read_b128 v[248:251], v140 offset:37888
  v_mfma_f32_16x16x32_bf16 v[44:47], v[204:207], v[216:219], v[44:47]
  ds_read_b128 v[252:255], v140 offset:39936
  v_mfma_f32_16x16x32_bf16 v[60:63], v[204:207], v[220:223], v[60:63]
  v_mfma_f32_16x16x32_bf16 v[56:59], v[200:203], v[220:223], v[56:59]
  v_mfma_f32_16x16x32_bf16 v[52:55], v[196:199], v[220:223], v[52:55]
  v_mfma_f32_16x16x32_bf16 v[48:51], v[192:195], v[220:223], v[48:51]
  s_waitcnt lgkmcnt(0)
  s_barrier
  v_mfma_f32_16x16x32_bf16 v[0:3], v[224:227], v[240:243], v[0:3]
  ds_read_b128 v[208:211], v140 offset:49152
  v_mfma_f32_16x16x32_bf16 v[4:7], v[228:231], v[240:243], v[4:7]
  ds_read_b64_tr_b16 v[192:193], v141 offset:49152
  v_mfma_f32_16x16x32_bf16 v[8:11], v[232:235], v[240:243], v[8:11]
  ds_read_b64_tr_b16 v[194:195], v141 offset:53248
  v_mfma_f32_16x16x32_bf16 v[12:15], v[236:239], v[240:243], v[12:15]
  ds_read_b64_tr_b16 v[196:197], v142 offset:49152
  v_mfma_f32_16x16x32_bf16 v[28:31], v[236:239], v[244:247], v[28:31]
  ds_read_b64_tr_b16 v[198:199], v142 offset:53248
  v_mfma_f32_16x16x32_bf16 v[24:27], v[232:235], v[244:247], v[24:27]
  ds_read_b64_tr_b16 v[200:201], v143 offset:49152
  v_mfma_f32_16x16x32_bf16 v[20:23], v[228:231], v[244:247], v[20:23]
  ds_read_b64_tr_b16 v[202:203], v143 offset:53248
  v_mfma_f32_16x16x32_bf16 v[16:19], v[224:227], v[244:247], v[16:19]
  ds_read_b64_tr_b16 v[204:205], v144 offset:49152
  v_mfma_f32_16x16x32_bf16 v[32:35], v[224:227], v[248:251], v[32:35]
  ds_read_b64_tr_b16 v[206:207], v144 offset:53248
  v_mfma_f32_16x16x32_bf16 v[36:39], v[228:231], v[248:251], v[36:39]
  ds_read_b128 v[212:215], v140 offset:51200
  v_mfma_f32_16x16x32_bf16 v[40:43], v[232:235], v[248:251], v[40:43]
  ds_read_b128 v[216:219], v140 offset:53248
  v_mfma_f32_16x16x32_bf16 v[44:47], v[236:239], v[248:251], v[44:47]
  ds_read_b128 v[220:223], v140 offset:55296
  v_mfma_f32_16x16x32_bf16 v[60:63], v[236:239], v[252:255], v[60:63]
  v_mfma_f32_16x16x32_bf16 v[56:59], v[232:235], v[252:255], v[56:59]
  v_mfma_f32_16x16x32_bf16 v[52:55], v[228:231], v[252:255], v[52:55]
  v_mfma_f32_16x16x32_bf16 v[48:51], v[224:227], v[252:255], v[48:51]
  s_waitcnt lgkmcnt(0)
  v_mfma_f32_16x16x32_bf16 v[0:3], v[192:195], v[208:211], v[0:3]
  ds_read_b128 v[240:243], v140 offset:50176
  v_mfma_f32_16x16x32_bf16 v[4:7], v[196:199], v[208:211], v[4:7]
  ds_read_b64_tr_b16 v[224:225], v141 offset:57344
  v_mfma_f32_16x16x32_bf16 v[8:11], v[200:203], v[208:211], v[8:11]
  ds_read_b64_tr_b16 v[226:227], v141 offset:61440
  v_mfma_f32_16x16x32_bf16 v[12:15], v[204:207], v[208:211], v[12:15]
  ds_read_b64_tr_b16 v[228:229], v142 offset:57344
  v_mfma_f32_16x16x32_bf16 v[28:31], v[204:207], v[212:215], v[28:31]
  ds_read_b64_tr_b16 v[230:231], v142 offset:61440
  v_mfma_f32_16x16x32_bf16 v[24:27], v[200:203], v[212:215], v[24:27]
  ds_read_b64_tr_b16 v[232:233], v143 offset:57344
  v_mfma_f32_16x16x32_bf16 v[20:23], v[196:199], v[212:215], v[20:23]
  ds_read_b64_tr_b16 v[234:235], v143 offset:61440
  v_mfma_f32_16x16x32_bf16 v[16:19], v[192:195], v[212:215], v[16:19]
  ds_read_b64_tr_b16 v[236:237], v144 offset:57344
  v_mfma_f32_16x16x32_bf16 v[32:35], v[192:195], v[216:219], v[32:35]
  ds_read_b64_tr_b16 v[238:239], v144 offset:61440
  v_mfma_f32_16x16x32_bf16 v[36:39], v[196:199], v[216:219], v[36:39]
  ds_read_b128 v[244:247], v140 offset:52224
  v_mfma_f32_16x16x32_bf16 v[40:43], v[200:203], v[216:219], v[40:43]
  ds_read_b128 v[248:251], v140 offset:54272
  v_mfma_f32_16x16x32_bf16 v[44:47], v[204:207], v[216:219], v[44:47]
  ds_read_b128 v[252:255], v140 offset:56320
  v_mfma_f32_16x16x32_bf16 v[60:63], v[204:207], v[220:223], v[60:63]
  v_mfma_f32_16x16x32_bf16 v[56:59], v[200:203], v[220:223], v[56:59]
  v_mfma_f32_16x16x32_bf16 v[52:55], v[196:199], v[220:223], v[52:55]
  v_mfma_f32_16x16x32_bf16 v[48:51], v[192:195], v[220:223], v[48:51]
  s_waitcnt lgkmcnt(0)
  s_barrier
  v_mfma_f32_16x16x32_bf16 v[0:3], v[224:227], v[240:243], v[0:3]
  ds_read_b128 v[208:211], v140 offset:0
  v_mfma_f32_16x16x32_bf16 v[4:7], v[228:231], v[240:243], v[4:7]
  ds_read_b64_tr_b16 v[192:193], v141 offset:0
  v_mfma_f32_16x16x32_bf16 v[8:11], v[232:235], v[240:243], v[8:11]
  ds_read_b64_tr_b16 v[194:195], v141 offset:4096
  v_mfma_f32_16x16x32_bf16 v[12:15], v[236:239], v[240:243], v[12:15]
  ds_read_b64_tr_b16 v[196:197], v142 offset:0
  v_mfma_f32_16x16x32_bf16 v[28:31], v[236:239], v[244:247], v[28:31]
  ds_read_b64_tr_b16 v[198:199], v142 offset:4096
  v_mfma_f32_16x16x32_bf16 v[24:27], v[232:235], v[244:247], v[24:27]
  ds_read_b64_tr_b16 v[200:201], v143 offset:0
  v_mfma_f32_16x16x32_bf16 v[20:23], v[228:231], v[244:247], v[20:23]
  ds_read_b64_tr_b16 v[202:203], v143 offset:4096
  v_mfma_f32_16x16x32_bf16 v[16:19], v[224:227], v[244:247], v[16:19]
  ds_read_b64_tr_b16 v[204:205], v144 offset:0
  v_mfma_f32_16x16x32_bf16 v[32:35], v[224:227], v[248:251], v[32:35]
  ds_read_b64_tr_b16 v[206:207], v144 offset:4096
  v_mfma_f32_16x16x32_bf16 v[36:39], v[228:231], v[248:251], v[36:39]
  ds_read_b128 v[212:215], v140 offset:2048
  v_mfma_f32_16x16x32_bf16 v[40:43], v[232:235], v[248:251], v[40:43]
  ds_read_b128 v[216:219], v140 offset:4096
  v_mfma_f32_16x16x32_bf16 v[44:47], v[236:239], v[248:251], v[44:47]
  ds_read_b128 v[220:223], v140 offset:6144
  v_mfma_f32_16x16x32_bf16 v[60:63], v[236:239], v[252:255], v[60:63]
  v_mfma_f32_16x16x32_bf16 v[56:59], v[232:235], v[252:255], v[56:59]
  v_mfma_f32_16x16x32_bf16 v[52:55], v[228:231], v[252:255], v[52:55]
  v_mfma_f32_16x16x32_bf16 v[48:51], v[224:227], v[252:255], v[48:51]
  s_waitcnt lgkmcnt(0)
  v_mfma_f32_16x16x32_bf16 v[0:3], v[192:195], v[208:211], v[0:3]
  ds_read_b128 v[240:243], v140 offset:1024
  v_mfma_f32_16x16x32_bf16 v[4:7], v[196:199], v[208:211], v[4:7]
  ds_read_b64_tr_b16 v[224:225], v141 offset:8192
  v_mfma_f32_16x16x32_bf16 v[8:11], v[200:203], v[208:211], v[8:11]
  ds_read_b64_tr_b16 v[226:227], v141 offset:12288
  v_mfma_f32_16x16x32_bf16 v[12:15], v[204:207], v[208:211], v[12:15]
  ds_read_b64_tr_b16 v[228:229], v142 offset:8192
  v_mfma_f32_16x16x32_bf16 v[28:31], v[204:207], v[212:215], v[28:31]
  ds_read_b64_tr_b16 v[230:231], v142 offset:12288
  v_mfma_f32_16x16x32_bf16 v[24:27], v[200:203], v[212:215], v[24:27]
  ds_read_b64_tr_b16 v[232:233], v143 offset:8192
  v_mfma_f32_16x16x32_bf16 v[20:23], v[196:199], v[212:215], v[20:23]
  ds_read_b64_tr_b16 v[234:235], v143 offset:12288
  v_mfma_f32_16x16x32_bf16 v[16:19], v[192:195], v[212:215], v[16:19]
  ds_read_b64_tr_b16 v[236:237], v144 offset:8192
  v_mfma_f32_16x16x32_bf16 v[32:35], v[192:195], v[216:219], v[32:35]
  ds_read_b64_tr_b16 v[238:239], v144 offset:12288
  v_mfma_f32_16x16x32_bf16 v[36:39], v[196:199], v[216:219], v[36:39]
  ds_read_b128 v[244:247], v140 offset:3072
  v_mfma_f32_16x16x32_bf16 v[40:43], v[200:203], v[216:219], v[40:43]
  ds_read_b128 v[248:251], v140 offset:5120
  v_mfma_f32_16x16x32_bf16 v[44:47], v[204:207], v[216:219], v[44:47]
  ds_read_b128 v[252:255], v140 offset:7168
  v_mfma_f32_16x16x32_bf16 v[60:63], v[204:207], v[220:223], v[60:63]
  v_mfma_f32_16x16x32_bf16 v[56:59], v[200:203], v[220:223], v[56:59]
  v_mfma_f32_16x16x32_bf16 v[52:55], v[196:199], v[220:223], v[52:55]
  v_mfma_f32_16x16x32_bf16 v[48:51], v[192:195], v[220:223], v[48:51]
  s_waitcnt lgkmcnt(0)
  s_barrier
  v_mfma_f32_16x16x32_bf16 v[0:3], v[224:227], v[240:243], v[0:3]
  ds_read_b128 v[208:211], v140 offset:16384
  v_mfma_f32_16x16x32_bf16 v[4:7], v[228:231], v[240:243], v[4:7]
  ds_read_b64_tr_b16 v[192:193], v141 offset:16384
  v_mfma_f32_16x16x32_bf16 v[8:11], v[232:235], v[240:243], v[8:11]
  ds_read_b64_tr_b16 v[194:195], v141 offset:20480
  v_mfma_f32_16x16x32_bf16 v[12:15], v[236:239], v[240:243], v[12:15]
  ds_read_b64_tr_b16 v[196:197], v142 offset:16384
  v_mfma_f32_16x16x32_bf16 v[28:31], v[236:239], v[244:247], v[28:31]
  ds_read_b64_tr_b16 v[198:199], v142 offset:20480
  v_mfma_f32_16x16x32_bf16 v[24:27], v[232:235], v[244:247], v[24:27]
  ds_read_b64_tr_b16 v[200:201], v143 offset:16384
  v_mfma_f32_16x16x32_bf16 v[20:23], v[228:231], v[244:247], v[20:23]
  ds_read_b64_tr_b16 v[202:203], v143 offset:20480
  v_mfma_f32_16x16x32_bf16 v[16:19], v[224:227], v[244:247], v[16:19]
  ds_read_b64_tr_b16 v[204:205], v144 offset:16384
  v_mfma_f32_16x16x32_bf16 v[32:35], v[224:227], v[248:251], v[32:35]
  ds_read_b64_tr_b16 v[206:207], v144 offset:20480
  v_mfma_f32_16x16x32_bf16 v[36:39], v[228:231], v[248:251], v[36:39]
  ds_read_b128 v[212:215], v140 offset:18432
  v_mfma_f32_16x16x32_bf16 v[40:43], v[232:235], v[248:251], v[40:43]
  ds_read_b128 v[216:219], v140 offset:20480
  v_mfma_f32_16x16x32_bf16 v[44:47], v[236:239], v[248:251], v[44:47]
  ds_read_b128 v[220:223], v140 offset:22528
  v_mfma_f32_16x16x32_bf16 v[60:63], v[236:239], v[252:255], v[60:63]
  v_mfma_f32_16x16x32_bf16 v[56:59], v[232:235], v[252:255], v[56:59]
  v_mfma_f32_16x16x32_bf16 v[52:55], v[228:231], v[252:255], v[52:55]
  v_mfma_f32_16x16x32_bf16 v[48:51], v[224:227], v[252:255], v[48:51]
  s_waitcnt lgkmcnt(0)
  v_mfma_f32_16x16x32_bf16 v[0:3], v[192:195], v[208:211], v[0:3]
  ds_read_b128 v[240:243], v140 offset:17408
  v_mfma_f32_16x16x32_bf16 v[4:7], v[196:199], v[208:211], v[4:7]
  ds_read_b64_tr_b16 v[224:225], v141 offset:24576
  v_mfma_f32_16x16x32_bf16 v[8:11], v[200:203], v[208:211], v[8:11]
  ds_read_b64_tr_b16 v[226:227], v141 offset:28672
  v_mfma_f32_16x16x32_bf16 v[12:15], v[204:207], v[208:211], v[12:15]
  ds_read_b64_tr_b16 v[228:229], v142 offset:24576
  v_mfma_f32_16x16x32_bf16 v[28:31], v[204:207], v[212:215], v[28:31]
  ds_read_b64_tr_b16 v[230:231], v142 offset:28672
  v_mfma_f32_16x16x32_bf16 v[24:27], v[200:203], v[212:215], v[24:27]
  ds_read_b64_tr_b16 v[232:233], v143 offset:24576
  v_mfma_f32_16x16x32_bf16 v[20:23], v[196:199], v[212:215], v[20:23]
  ds_read_b64_tr_b16 v[234:235], v143 offset:28672
  v_mfma_f32_16x16x32_bf16 v[16:19], v[192:195], v[212:215], v[16:19]
  ds_read_b64_tr_b16 v[236:237], v144 offset:24576
  v_mfma_f32_16x16x32_bf16 v[32:35], v[192:195], v[216:219], v[32:35]
  ds_read_b64_tr_b16 v[238:239], v144 offset:28672
  v_mfma_f32_16x16x32_bf16 v[36:39], v[196:199], v[216:219], v[36:39]
  ds_read_b128 v[244:247], v140 offset:19456
  v_mfma_f32_16x16x32_bf16 v[40:43], v[200:203], v[216:219], v[40:43]
  ds_read_b128 v[248:251], v140 offset:21504
  v_mfma_f32_16x16x32_bf16 v[44:47], v[204:207], v[216:219], v[44:47]
  ds_read_b128 v[252:255], v140 offset:23552
  v_mfma_f32_16x16x32_bf16 v[60:63], v[204:207], v[220:223], v[60:63]
  v_mfma_f32_16x16x32_bf16 v[56:59], v[200:203], v[220:223], v[56:59]
  v_mfma_f32_16x16x32_bf16 v[52:55], v[196:199], v[220:223], v[52:55]
  v_mfma_f32_16x16x32_bf16 v[48:51], v[192:195], v[220:223], v[48:51]
  s_waitcnt lgkmcnt(0)
  s_barrier
  v_mfma_f32_16x16x32_bf16 v[0:3], v[224:227], v[240:243], v[0:3]
  ds_read_b128 v[208:211], v140 offset:32768
  v_mfma_f32_16x16x32_bf16 v[4:7], v[228:231], v[240:243], v[4:7]
  ds_read_b64_tr_b16 v[192:193], v141 offset:32768
  v_mfma_f32_16x16x32_bf16 v[8:11], v[232:235], v[240:243], v[8:11]
  ds_read_b64_tr_b16 v[194:195], v141 offset:36864
  v_mfma_f32_16x16x32_bf16 v[12:15], v[236:239], v[240:243], v[12:15]
  ds_read_b64_tr_b16 v[196:197], v142 offset:32768
  v_mfma_f32_16x16x32_bf16 v[28:31], v[236:239], v[244:247], v[28:31]
  ds_read_b64_tr_b16 v[198:199], v142 offset:36864
  v_mfma_f32_16x16x32_bf16 v[24:27], v[232:235], v[244:247], v[24:27]
  ds_read_b64_tr_b16 v[200:201], v143 offset:32768
  v_mfma_f32_16x16x32_bf16 v[20:23], v[228:231], v[244:247], v[20:23]
  ds_read_b64_tr_b16 v[202:203], v143 offset:36864
  v_mfma_f32_16x16x32_bf16 v[16:19], v[224:227], v[244:247], v[16:19]
  ds_read_b64_tr_b16 v[204:205], v144 offset:32768
  v_mfma_f32_16x16x32_bf16 v[32:35], v[224:227], v[248:251], v[32:35]
  ds_read_b64_tr_b16 v[206:207], v144 offset:36864
  v_mfma_f32_16x16x32_bf16 v[36:39], v[228:231], v[248:251], v[36:39]
  ds_read_b128 v[212:215], v140 offset:34816
  v_mfma_f32_16x16x32_bf16 v[40:43], v[232:235], v[248:251], v[40:43]
  ds_read_b128 v[216:219], v140 offset:36864
  v_mfma_f32_16x16x32_bf16 v[44:47], v[236:239], v[248:251], v[44:47]
  ds_read_b128 v[220:223], v140 offset:38912
  v_mfma_f32_16x16x32_bf16 v[60:63], v[236:239], v[252:255], v[60:63]
  v_mfma_f32_16x16x32_bf16 v[56:59], v[232:235], v[252:255], v[56:59]
  v_mfma_f32_16x16x32_bf16 v[52:55], v[228:231], v[252:255], v[52:55]
  v_mfma_f32_16x16x32_bf16 v[48:51], v[224:227], v[252:255], v[48:51]
  s_waitcnt lgkmcnt(0)
  v_mfma_f32_16x16x32_bf16 v[0:3], v[192:195], v[208:211], v[0:3]
  ds_read_b128 v[240:243], v140 offset:33792
  v_mfma_f32_16x16x32_bf16 v[4:7], v[196:199], v[208:211], v[4:7]
  ds_read_b64_tr_b16 v[224:225], v141 offset:40960
  v_mfma_f32_16x16x32_bf16 v[8:11], v[200:203], v[208:211], v[8:11]
  ds_read_b64_tr_b16 v[226:227], v141 offset:45056
  v_mfma_f32_16x16x32_bf16 v[12:15], v[204:207], v[208:211], v[12:15]
  ds_read_b64_tr_b16 v[228:229], v142 offset:40960
  v_mfma_f32_16x16x32_bf16 v[28:31], v[204:207], v[212:215], v[28:31]
  ds_read_b64_tr_b16 v[230:231], v142 offset:45056
  v_mfma_f32_16x16x32_bf16 v[24:27], v[200:203], v[212:215], v[24:27]
  ds_read_b64_tr_b16 v[232:233], v143 offset:40960
  v_mfma_f32_16x16x32_bf16 v[20:23], v[196:199], v[212:215], v[20:23]
  ds_read_b64_tr_b16 v[234:235], v143 offset:45056
  v_mfma_f32_16x16x32_bf16 v[16:19], v[192:195], v[212:215], v[16:19]
  ds_read_b64_tr_b16 v[236:237], v144 offset:40960
  v_mfma_f32_16x16x32_bf16 v[32:35], v[192:195], v[216:219], v[32:35]
  ds_read_b64_tr_b16 v[238:239], v144 offset:45056
  v_mfma_f32_16x16x32_bf16 v[36:39], v[196:199], v[216:219], v[36:39]
  ds_read_b128 v[244:247], v140 offset:35840
  v_mfma_f32_16x16x32_bf16 v[40:43], v[200:203], v[216:219], v[40:43]
  ds_read_b128 v[248:251], v140 offset:37888
  v_mfma_f32_16x16x32_bf16 v[44:47], v[204:207], v[216:219], v[44:47]
  ds_read_b128 v[252:255], v140 offset:39936
  v_mfma_f32_16x16x32_bf16 v[60:63], v[204:207], v[220:223], v[60:63]
  v_mfma_f32_16x16x32_bf16 v[56:59], v[200:203], v[220:223], v[56:59]
  v_mfma_f32_16x16x32_bf16 v[52:55], v[196:199], v[220:223], v[52:55]
  v_mfma_f32_16x16x32_bf16 v[48:51], v[192:195], v[220:223], v[48:51]
  s_waitcnt lgkmcnt(0)
  s_barrier
  v_mfma_f32_16x16x32_bf16 v[0:3], v[224:227], v[240:243], v[0:3]
  ds_read_b128 v[208:211], v140 offset:49152
  v_mfma_f32_16x16x32_bf16 v[4:7], v[228:231], v[240:243], v[4:7]
  ds_read_b64_tr_b16 v[192:193], v141 offset:49152
  v_mfma_f32_16x16x32_bf16 v[8:11], v[232:235], v[240:243], v[8:11]
  ds_read_b64_tr_b16 v[194:195], v141 offset:53248
  v_mfma_f32_16x16x32_bf16 v[12:15], v[236:239], v[240:243], v[12:15]
  ds_read_b64_tr_b16 v[196:197], v142 offset:49152
  v_mfma_f32_16x16x32_bf16 v[28:31], v[236:239], v[244:247], v[28:31]
  ds_read_b64_tr_b16 v[198:199], v142 offset:53248
  v_mfma_f32_16x16x32_bf16 v[24:27], v[232:235], v[244:247], v[24:27]
  ds_read_b64_tr_b16 v[200:201], v143 offset:49152
  v_mfma_f32_16x16x32_bf16 v[20:23], v[228:231], v[244:247], v[20:23]
  ds_read_b64_tr_b16 v[202:203], v143 offset:53248
  v_mfma_f32_16x16x32_bf16 v[16:19], v[224:227], v[244:247], v[16:19]
  ds_read_b64_tr_b16 v[204:205], v144 offset:49152
  v_mfma_f32_16x16x32_bf16 v[32:35], v[224:227], v[248:251], v[32:35]
  ds_read_b64_tr_b16 v[206:207], v144 offset:53248
  v_mfma_f32_16x16x32_bf16 v[36:39], v[228:231], v[248:251], v[36:39]
  ds_read_b128 v[212:215], v140 offset:51200
  v_mfma_f32_16x16x32_bf16 v[40:43], v[232:235], v[248:251], v[40:43]
  ds_read_b128 v[216:219], v140 offset:53248
  v_mfma_f32_16x16x32_bf16 v[44:47], v[236:239], v[248:251], v[44:47]
  ds_read_b128 v[220:223], v140 offset:55296
  v_mfma_f32_16x16x32_bf16 v[60:63], v[236:239], v[252:255], v[60:63]
  v_mfma_f32_16x16x32_bf16 v[56:59], v[232:235], v[252:255], v[56:59]
  v_mfma_f32_16x16x32_bf16 v[52:55], v[228:231], v[252:255], v[52:55]
  v_mfma_f32_16x16x32_bf16 v[48:51], v[224:227], v[252:255], v[48:51]
  s_waitcnt lgkmcnt(0)
  v_mfma_f32_16x16x32_bf16 v[0:3], v[192:195], v[208:211], v[0:3]
  ds_read_b128 v[240:243], v140 offset:50176
  v_mfma_f32_16x16x32_bf16 v[4:7], v[196:199], v[208:211], v[4:7]
  ds_read_b64_tr_b16 v[224:225], v141 offset:57344
  v_mfma_f32_16x16x32_bf16 v[8:11], v[200:203], v[208:211], v[8:11]
  ds_read_b64_tr_b16 v[226:227], v141 offset:61440
  v_mfma_f32_16x16x32_bf16 v[12:15], v[204:207], v[208:211], v[12:15]
  ds_read_b64_tr_b16 v[228:229], v142 offset:57344
  v_mfma_f32_16x16x32_bf16 v[28:31], v[204:207], v[212:215], v[28:31]
  ds_read_b64_tr_b16 v[230:231], v142 offset:61440
  v_mfma_f32_16x16x32_bf16 v[24:27], v[200:203], v[212:215], v[24:27]
  ds_read_b64_tr_b16 v[232:233], v143 offset:57344
  v_mfma_f32_16x16x32_bf16 v[20:23], v[196:199], v[212:215], v[20:23]
  ds_read_b64_tr_b16 v[234:235], v143 offset:61440
  v_mfma_f32_16x16x32_bf16 v[16:19], v[192:195], v[212:215], v[16:19]
  ds_read_b64_tr_b16 v[236:237], v144 offset:57344
  v_mfma_f32_16x16x32_bf16 v[32:35], v[192:195], v[216:219], v[32:35]
  ds_read_b64_tr_b16 v[238:239], v144 offset:61440
  v_mfma_f32_16x16x32_bf16 v[36:39], v[196:199], v[216:219], v[36:39]
  ds_read_b128 v[244:247], v140 offset:52224
  v_mfma_f32_16x16x32_bf16 v[40:43], v[200:203], v[216:219], v[40:43]
  ds_read_b128 v[248:251], v140 offset:54272
  v_mfma_f32_16x16x32_bf16 v[44:47], v[204:207], v[216:219], v[44:47]
  ds_read_b128 v[252:255], v140 offset:56320
  v_mfma_f32_16x16x32_bf16 v[60:63], v[204:207], v[220:223], v[60:63]
  v_mfma_f32_16x16x32_bf16 v[56:59], v[200:203], v[220:223], v[56:59]
  v_mfma_f32_16x16x32_bf16 v[52:55], v[196:199], v[220:223], v[52:55]
  v_mfma_f32_16x16x32_bf16 v[48:51], v[192:195], v[220:223], v[48:51]
  s_waitcnt lgkmcnt(0)
  s_barrier
  v_mfma_f32_16x16x32_bf16 v[0:3], v[224:227], v[240:243], v[0:3]
  ds_read_b128 v[208:211], v140 offset:0
  v_mfma_f32_16x16x32_bf16 v[4:7], v[228:231], v[240:243], v[4:7]
  ds_read_b64_tr_b16 v[192:193], v141 offset:0
  v_mfma_f32_16x16x32_bf16 v[8:11], v[232:235], v[240:243], v[8:11]
  ds_read_b64_tr_b16 v[194:195], v141 offset:4096
  v_mfma_f32_16x16x32_bf16 v[12:15], v[236:239], v[240:243], v[12:15]
  ds_read_b64_tr_b16 v[196:197], v142 offset:0
  v_mfma_f32_16x16x32_bf16 v[28:31], v[236:239], v[244:247], v[28:31]
  ds_read_b64_tr_b16 v[198:199], v142 offset:4096
  v_mfma_f32_16x16x32_bf16 v[24:27], v[232:235], v[244:247], v[24:27]
  ds_read_b64_tr_b16 v[200:201], v143 offset:0
  v_mfma_f32_16x16x32_bf16 v[20:23], v[228:231], v[244:247], v[20:23]
  ds_read_b64_tr_b16 v[202:203], v143 offset:4096
  v_mfma_f32_16x16x32_bf16 v[16:19], v[224:227], v[244:247], v[16:19]
  ds_read_b64_tr_b16 v[204:205], v144 offset:0
  v_mfma_f32_16x16x32_bf16 v[32:35], v[224:227], v[248:251], v[32:35]
  ds_read_b64_tr_b16 v[206:207], v144 offset:4096
  v_mfma_f32_16x16x32_bf16 v[36:39], v[228:231], v[248:251], v[36:39]
  ds_read_b128 v[212:215], v140 offset:2048
  v_mfma_f32_16x16x32_bf16 v[40:43], v[232:235], v[248:251], v[40:43]
  ds_read_b128 v[216:219], v140 offset:4096
  v_mfma_f32_16x16x32_bf16 v[44:47], v[236:239], v[248:251], v[44:47]
  ds_read_b128 v[220:223], v140 offset:6144
  v_mfma_f32_16x16x32_bf16 v[60:63], v[236:239], v[252:255], v[60:63]
  v_mfma_f32_16x16x32_bf16 v[56:59], v[232:235], v[252:255], v[56:59]
  v_mfma_f32_16x16x32_bf16 v[52:55], v[228:231], v[252:255], v[52:55]
  v_mfma_f32_16x16x32_bf16 v[48:51], v[224:227], v[252:255], v[48:51]
  s_waitcnt lgkmcnt(0)
  v_mfma_f32_16x16x32_bf16 v[0:3], v[192:195], v[208:211], v[0:3]
  ds_read_b128 v[240:243], v140 offset:1024
  v_mfma_f32_16x16x32_bf16 v[4:7], v[196:199], v[208:211], v[4:7]
  ds_read_b64_tr_b16 v[224:225], v141 offset:8192
  v_mfma_f32_16x16x32_bf16 v[8:11], v[200:203], v[208:211], v[8:11]
  ds_read_b64_tr_b16 v[226:227], v141 offset:12288
  v_mfma_f32_16x16x32_bf16 v[12:15], v[204:207], v[208:211], v[12:15]
  ds_read_b64_tr_b16 v[228:229], v142 offset:8192
  v_mfma_f32_16x16x32_bf16 v[28:31], v[204:207], v[212:215], v[28:31]
  ds_read_b64_tr_b16 v[230:231], v142 offset:12288
  v_mfma_f32_16x16x32_bf16 v[24:27], v[200:203], v[212:215], v[24:27]
  ds_read_b64_tr_b16 v[232:233], v143 offset:8192
  v_mfma_f32_16x16x32_bf16 v[20:23], v[196:199], v[212:215], v[20:23]
  ds_read_b64_tr_b16 v[234:235], v143 offset:12288
  v_mfma_f32_16x16x32_bf16 v[16:19], v[192:195], v[212:215], v[16:19]
  ds_read_b64_tr_b16 v[236:237], v144 offset:8192
  v_mfma_f32_16x16x32_bf16 v[32:35], v[192:195], v[216:219], v[32:35]
  ds_read_b64_tr_b16 v[238:239], v144 offset:12288
  v_mfma_f32_16x16x32_bf16 v[36:39], v[196:199], v[216:219], v[36:39]
  ds_read_b128 v[244:247], v140 offset:3072
  v_mfma_f32_16x16x32_bf16 v[40:43], v[200:203], v[216:219], v[40:43]
  ds_read_b128 v[248:251], v140 offset:5120
  v_mfma_f32_16x16x32_bf16 v[44:47], v[204:207], v[216:219], v[44:47]
  ds_read_b128 v[252:255], v140 offset:7168
  v_mfma_f32_16x16x32_bf16 v[60:63], v[204:207], v[220:223], v[60:63]
  v_mfma_f32_16x16x32_bf16 v[56:59], v[200:203], v[220:223], v[56:59]
  v_mfma_f32_16x16x32_bf16 v[52:55], v[196:199], v[220:223], v[52:55]
  v_mfma_f32_16x16x32_bf16 v[48:51], v[192:195], v[220:223], v[48:51]
  s_waitcnt lgkmcnt(0)
  s_barrier
  v_mfma_f32_16x16x32_bf16 v[0:3], v[224:227], v[240:243], v[0:3]
  ds_read_b128 v[208:211], v140 offset:16384
  v_mfma_f32_16x16x32_bf16 v[4:7], v[228:231], v[240:243], v[4:7]
  ds_read_b64_tr_b16 v[192:193], v141 offset:16384
  v_mfma_f32_16x16x32_bf16 v[8:11], v[232:235], v[240:243], v[8:11]
  ds_read_b64_tr_b16 v[194:195], v141 offset:20480
  v_mfma_f32_16x16x32_bf16 v[12:15], v[236:239], v[240:243], v[12:15]
  ds_read_b64_tr_b16 v[196:197], v142 offset:16384
  v_mfma_f32_16x16x32_bf16 v[28:31], v[236:239], v[244:247], v[28:31]
  ds_read_b64_tr_b16 v[198:199], v142 offset:20480
  v_mfma_f32_16x16x32_bf16 v[24:27], v[232:235], v[244:247], v[24:27]
  ds_read_b64_tr_b16 v[200:201], v143 offset:16384
  v_mfma_f32_16x16x32_bf16 v[20:23], v[228:231], v[244:247], v[20:23]
  ds_read_b64_tr_b16 v[202:203], v143 offset:20480
  v_mfma_f32_16x16x32_bf16 v[16:19], v[224:227], v[244:247], v[16:19]
  ds_read_b64_tr_b16 v[204:205], v144 offset:16384
  v_mfma_f32_16x16x32_bf16 v[32:35], v[224:227], v[248:251], v[32:35]
  ds_read_b64_tr_b16 v[206:207], v144 offset:20480
  v_mfma_f32_16x16x32_bf16 v[36:39], v[228:231], v[248:251], v[36:39]
  ds_read_b128 v[212:215], v140 offset:18432
  v_mfma_f32_16x16x32_bf16 v[40:43], v[232:235], v[248:251], v[40:43]
  ds_read_b128 v[216:219], v140 offset:20480
  v_mfma_f32_16x16x32_bf16 v[44:47], v[236:239], v[248:251], v[44:47]
  ds_read_b128 v[220:223], v140 offset:22528
  v_mfma_f32_16x16x32_bf16 v[60:63], v[236:239], v[252:255], v[60:63]
  v_mfma_f32_16x16x32_bf16 v[56:59], v[232:235], v[252:255], v[56:59]
  v_mfma_f32_16x16x32_bf16 v[52:55], v[228:231], v[252:255], v[52:55]
  v_mfma_f32_16x16x32_bf16 v[48:51], v[224:227], v[252:255], v[48:51]
  s_waitcnt lgkmcnt(0)
  v_mfma_f32_16x16x32_bf16 v[0:3], v[192:195], v[208:211], v[0:3]
  ds_read_b128 v[240:243], v140 offset:17408
  v_mfma_f32_16x16x32_bf16 v[4:7], v[196:199], v[208:211], v[4:7]
  ds_read_b64_tr_b16 v[224:225], v141 offset:24576
  v_mfma_f32_16x16x32_bf16 v[8:11], v[200:203], v[208:211], v[8:11]
  ds_read_b64_tr_b16 v[226:227], v141 offset:28672
  v_mfma_f32_16x16x32_bf16 v[12:15], v[204:207], v[208:211], v[12:15]
  ds_read_b64_tr_b16 v[228:229], v142 offset:24576
  v_mfma_f32_16x16x32_bf16 v[28:31], v[204:207], v[212:215], v[28:31]
  ds_read_b64_tr_b16 v[230:231], v142 offset:28672
  v_mfma_f32_16x16x32_bf16 v[24:27], v[200:203], v[212:215], v[24:27]
  ds_read_b64_tr_b16 v[232:233], v143 offset:24576
  v_mfma_f32_16x16x32_bf16 v[20:23], v[196:199], v[212:215], v[20:23]
  ds_read_b64_tr_b16 v[234:235], v143 offset:28672
  v_mfma_f32_16x16x32_bf16 v[16:19], v[192:195], v[212:215], v[16:19]
  ds_read_b64_tr_b16 v[236:237], v144 offset:24576
  v_mfma_f32_16x16x32_bf16 v[32:35], v[192:195], v[216:219], v[32:35]
  ds_read_b64_tr_b16 v[238:239], v144 offset:28672
  v_mfma_f32_16x16x32_bf16 v[36:39], v[196:199], v[216:219], v[36:39]
  ds_read_b128 v[244:247], v140 offset:19456
  v_mfma_f32_16x16x32_bf16 v[40:43], v[200:203], v[216:219], v[40:43]
  ds_read_b128 v[248:251], v140 offset:21504
  v_mfma_f32_16x16x32_bf16 v[44:47], v[204:207], v[216:219], v[44:47]
  ds_read_b128 v[252:255], v140 offset:23552
  v_mfma_f32_16x16x32_bf16 v[60:63], v[204:207], v[220:223], v[60:63]
  v_mfma_f32_16x16x32_bf16 v[56:59], v[200:203], v[220:223], v[56:59]
  v_mfma_f32_16x16x32_bf16 v[52:55], v[196:199], v[220:223], v[52:55]
  v_mfma_f32_16x16x32_bf16 v[48:51], v[192:195], v[220:223], v[48:51]
  s_waitcnt lgkmcnt(0)
  s_barrier
  v_mfma_f32_16x16x32_bf16 v[0:3], v[224:227], v[240:243], v[0:3]
  ds_read_b128 v[208:211], v140 offset:32768
  v_mfma_f32_16x16x32_bf16 v[4:7], v[228:231], v[240:243], v[4:7]
  ds_read_b64_tr_b16 v[192:193], v141 offset:32768
  v_mfma_f32_16x16x32_bf16 v[8:11], v[232:235], v[240:243], v[8:11]
  ds_read_b64_tr_b16 v[194:195], v141 offset:36864
  v_mfma_f32_16x16x32_bf16 v[12:15], v[236:239], v[240:243], v[12:15]
  ds_read_b64_tr_b16 v[196:197], v142 offset:32768
  v_mfma_f32_16x16x32_bf16 v[28:31], v[236:239], v[244:247], v[28:31]
  ds_read_b64_tr_b16 v[198:199], v142 offset:36864
  v_mfma_f32_16x16x32_bf16 v[24:27], v[232:235], v[244:247], v[24:27]
  ds_read_b64_tr_b16 v[200:201], v143 offset:32768
  v_mfma_f32_16x16x32_bf16 v[20:23], v[228:231], v[244:247], v[20:23]
  ds_read_b64_tr_b16 v[202:203], v143 offset:36864
  v_mfma_f32_16x16x32_bf16 v[16:19], v[224:227], v[244:247], v[16:19]
  ds_read_b64_tr_b16 v[204:205], v144 offset:32768
  v_mfma_f32_16x16x32_bf16 v[32:35], v[224:227], v[248:251], v[32:35]
  ds_read_b64_tr_b16 v[206:207], v144 offset:36864
  v_mfma_f32_16x16x32_bf16 v[36:39], v[228:231], v[248:251], v[36:39]
  ds_read_b128 v[212:215], v140 offset:34816
  v_mfma_f32_16x16x32_bf16 v[40:43], v[232:235], v[248:251], v[40:43]
  ds_read_b128 v[216:219], v140 offset:36864
  v_mfma_f32_16x16x32_bf16 v[44:47], v[236:239], v[248:251], v[44:47]
  ds_read_b128 v[220:223], v140 offset:38912
  v_mfma_f32_16x16x32_bf16 v[60:63], v[236:239], v[252:255], v[60:63]
  v_mfma_f32_16x16x32_bf16 v[56:59], v[232:235], v[252:255], v[56:59]
  v_mfma_f32_16x16x32_bf16 v[52:55], v[228:231], v[252:255], v[52:55]
  v_mfma_f32_16x16x32_bf16 v[48:51], v[224:227], v[252:255], v[48:51]
  s_waitcnt lgkmcnt(0)
  v_mfma_f32_16x16x32_bf16 v[0:3], v[192:195], v[208:211], v[0:3]
  ds_read_b128 v[240:243], v140 offset:33792
  v_mfma_f32_16x16x32_bf16 v[4:7], v[196:199], v[208:211], v[4:7]
  ds_read_b64_tr_b16 v[224:225], v141 offset:40960
  v_mfma_f32_16x16x32_bf16 v[8:11], v[200:203], v[208:211], v[8:11]
  ds_read_b64_tr_b16 v[226:227], v141 offset:45056
  v_mfma_f32_16x16x32_bf16 v[12:15], v[204:207], v[208:211], v[12:15]
  ds_read_b64_tr_b16 v[228:229], v142 offset:40960
  v_mfma_f32_16x16x32_bf16 v[28:31], v[204:207], v[212:215], v[28:31]
  ds_read_b64_tr_b16 v[230:231], v142 offset:45056
  v_mfma_f32_16x16x32_bf16 v[24:27], v[200:203], v[212:215], v[24:27]
  ds_read_b64_tr_b16 v[232:233], v143 offset:40960
  v_mfma_f32_16x16x32_bf16 v[20:23], v[196:199], v[212:215], v[20:23]
  ds_read_b64_tr_b16 v[234:235], v143 offset:45056
  v_mfma_f32_16x16x32_bf16 v[16:19], v[192:195], v[212:215], v[16:19]
  ds_read_b64_tr_b16 v[236:237], v144 offset:40960
  v_mfma_f32_16x16x32_bf16 v[32:35], v[192:195], v[216:219], v[32:35]
  ds_read_b64_tr_b16 v[238:239], v144 offset:45056
  v_mfma_f32_16x16x32_bf16 v[36:39], v[196:199], v[216:219], v[36:39]
  ds_read_b128 v[244:247], v140 offset:35840
  v_mfma_f32_16x16x32_bf16 v[40:43], v[200:203], v[216:219], v[40:43]
  ds_read_b128 v[248:251], v140 offset:37888
  v_mfma_f32_16x16x32_bf16 v[44:47], v[204:207], v[216:219], v[44:47]
  ds_read_b128 v[252:255], v140 offset:39936
  v_mfma_f32_16x16x32_bf16 v[60:63], v[204:207], v[220:223], v[60:63]
  v_mfma_f32_16x16x32_bf16 v[56:59], v[200:203], v[220:223], v[56:59]
  v_mfma_f32_16x16x32_bf16 v[52:55], v[196:199], v[220:223], v[52:55]
  v_mfma_f32_16x16x32_bf16 v[48:51], v[192:195], v[220:223], v[48:51]
  s_waitcnt lgkmcnt(0)
  s_barrier
  v_mfma_f32_16x16x32_bf16 v[0:3], v[224:227], v[240:243], v[0:3]
  ds_read_b128 v[208:211], v140 offset:49152
  v_mfma_f32_16x16x32_bf16 v[4:7], v[228:231], v[240:243], v[4:7]
  ds_read_b64_tr_b16 v[192:193], v141 offset:49152
  v_mfma_f32_16x16x32_bf16 v[8:11], v[232:235], v[240:243], v[8:11]
  ds_read_b64_tr_b16 v[194:195], v141 offset:53248
  v_mfma_f32_16x16x32_bf16 v[12:15], v[236:239], v[240:243], v[12:15]
  ds_read_b64_tr_b16 v[196:197], v142 offset:49152
  v_mfma_f32_16x16x32_bf16 v[28:31], v[236:239], v[244:247], v[28:31]
  ds_read_b64_tr_b16 v[198:199], v142 offset:53248
  v_mfma_f32_16x16x32_bf16 v[24:27], v[232:235], v[244:247], v[24:27]
  ds_read_b64_tr_b16 v[200:201], v143 offset:49152
  v_mfma_f32_16x16x32_bf16 v[20:23], v[228:231], v[244:247], v[20:23]
  ds_read_b64_tr_b16 v[202:203], v143 offset:53248
  v_mfma_f32_16x16x32_bf16 v[16:19], v[224:227], v[244:247], v[16:19]
  ds_read_b64_tr_b16 v[204:205], v144 offset:49152
  v_mfma_f32_16x16x32_bf16 v[32:35], v[224:227], v[248:251], v[32:35]
  ds_read_b64_tr_b16 v[206:207], v144 offset:53248
  v_mfma_f32_16x16x32_bf16 v[36:39], v[228:231], v[248:251], v[36:39]
  ds_read_b128 v[212:215], v140 offset:51200
  v_mfma_f32_16x16x32_bf16 v[40:43], v[232:235], v[248:251], v[40:43]
  ds_read_b128 v[216:219], v140 offset:53248
  v_mfma_f32_16x16x32_bf16 v[44:47], v[236:239], v[248:251], v[44:47]
  ds_read_b128 v[220:223], v140 offset:55296
  v_mfma_f32_16x16x32_bf16 v[60:63], v[236:239], v[252:255], v[60:63]
  v_mfma_f32_16x16x32_bf16 v[56:59], v[232:235], v[252:255], v[56:59]
  v_mfma_f32_16x16x32_bf16 v[52:55], v[228:231], v[252:255], v[52:55]
  v_mfma_f32_16x16x32_bf16 v[48:51], v[224:227], v[252:255], v[48:51]
  s_waitcnt lgkmcnt(0)
  v_mfma_f32_16x16x32_bf16 v[0:3], v[192:195], v[208:211], v[0:3]
  ds_read_b128 v[240:243], v140 offset:50176
  v_mfma_f32_16x16x32_bf16 v[4:7], v[196:199], v[208:211], v[4:7]
  ds_read_b64_tr_b16 v[224:225], v141 offset:57344
  v_mfma_f32_16x16x32_bf16 v[8:11], v[200:203], v[208:211], v[8:11]
  ds_read_b64_tr_b16 v[226:227], v141 offset:61440
  v_mfma_f32_16x16x32_bf16 v[12:15], v[204:207], v[208:211], v[12:15]
  ds_read_b64_tr_b16 v[228:229], v142 offset:57344
  v_mfma_f32_16x16x32_bf16 v[28:31], v[204:207], v[212:215], v[28:31]
  ds_read_b64_tr_b16 v[230:231], v142 offset:61440
  v_mfma_f32_16x16x32_bf16 v[24:27], v[200:203], v[212:215], v[24:27]
  ds_read_b64_tr_b16 v[232:233], v143 offset:57344
  v_mfma_f32_16x16x32_bf16 v[20:23], v[196:199], v[212:215], v[20:23]
  ds_read_b64_tr_b16 v[234:235], v143 offset:61440
  v_mfma_f32_16x16x32_bf16 v[16:19], v[192:195], v[212:215], v[16:19]
  ds_read_b64_tr_b16 v[236:237], v144 offset:57344
  v_mfma_f32_16x16x32_bf16 v[32:35], v[192:195], v[216:219], v[32:35]
  ds_read_b64_tr_b16 v[238:239], v144 offset:61440
  v_mfma_f32_16x16x32_bf16 v[36:39], v[196:199], v[216:219], v[36:39]
  ds_read_b128 v[244:247], v140 offset:52224
  v_mfma_f32_16x16x32_bf16 v[40:43], v[200:203], v[216:219], v[40:43]
  ds_read_b128 v[248:251], v140 offset:54272
  v_mfma_f32_16x16x32_bf16 v[44:47], v[204:207], v[216:219], v[44:47]
  ds_read_b128 v[252:255], v140 offset:56320
  v_mfma_f32_16x16x32_bf16 v[60:63], v[204:207], v[220:223], v[60:63]
  v_mfma_f32_16x16x32_bf16 v[56:59], v[200:203], v[220:223], v[56:59]
  v_mfma_f32_16x16x32_bf16 v[52:55], v[196:199], v[220:223], v[52:55]
  v_mfma_f32_16x16x32_bf16 v[48:51], v[192:195], v[220:223], v[48:51]
  s_waitcnt lgkmcnt(0)
  s_barrier
  v_mfma_f32_16x16x32_bf16 v[0:3], v[224:227], v[240:243], v[0:3]
  ds_read_b128 v[208:211], v140 offset:0
  v_mfma_f32_16x16x32_bf16 v[4:7], v[228:231], v[240:243], v[4:7]
  ds_read_b64_tr_b16 v[192:193], v141 offset:0
  v_mfma_f32_16x16x32_bf16 v[8:11], v[232:235], v[240:243], v[8:11]
  ds_read_b64_tr_b16 v[194:195], v141 offset:4096
  v_mfma_f32_16x16x32_bf16 v[12:15], v[236:239], v[240:243], v[12:15]
  ds_read_b64_tr_b16 v[196:197], v142 offset:0
  v_mfma_f32_16x16x32_bf16 v[28:31], v[236:239], v[244:247], v[28:31]
  ds_read_b64_tr_b16 v[198:199], v142 offset:4096
  v_mfma_f32_16x16x32_bf16 v[24:27], v[232:235], v[244:247], v[24:27]
  ds_read_b64_tr_b16 v[200:201], v143 offset:0
  v_mfma_f32_16x16x32_bf16 v[20:23], v[228:231], v[244:247], v[20:23]
  ds_read_b64_tr_b16 v[202:203], v143 offset:4096
  v_mfma_f32_16x16x32_bf16 v[16:19], v[224:227], v[244:247], v[16:19]
  ds_read_b64_tr_b16 v[204:205], v144 offset:0
  v_mfma_f32_16x16x32_bf16 v[32:35], v[224:227], v[248:251], v[32:35]
  ds_read_b64_tr_b16 v[206:207], v144 offset:4096
  v_mfma_f32_16x16x32_bf16 v[36:39], v[228:231], v[248:251], v[36:39]
  ds_read_b128 v[212:215], v140 offset:2048
  v_mfma_f32_16x16x32_bf16 v[40:43], v[232:235], v[248:251], v[40:43]
  ds_read_b128 v[216:219], v140 offset:4096
  v_mfma_f32_16x16x32_bf16 v[44:47], v[236:239], v[248:251], v[44:47]
  ds_read_b128 v[220:223], v140 offset:6144
  v_mfma_f32_16x16x32_bf16 v[60:63], v[236:239], v[252:255], v[60:63]
  v_mfma_f32_16x16x32_bf16 v[56:59], v[232:235], v[252:255], v[56:59]
  v_mfma_f32_16x16x32_bf16 v[52:55], v[228:231], v[252:255], v[52:55]
  v_mfma_f32_16x16x32_bf16 v[48:51], v[224:227], v[252:255], v[48:51]
  s_waitcnt lgkmcnt(0)
  v_mfma_f32_16x16x32_bf16 v[0:3], v[192:195], v[208:211], v[0:3]
  ds_read_b128 v[240:243], v140 offset:1024
  v_mfma_f32_16x16x32_bf16 v[4:7], v[196:199], v[208:211], v[4:7]
  ds_read_b64_tr_b16 v[224:225], v141 offset:8192
  v_mfma_f32_16x16x32_bf16 v[8:11], v[200:203], v[208:211], v[8:11]
  ds_read_b64_tr_b16 v[226:227], v141 offset:12288
  v_mfma_f32_16x16x32_bf16 v[12:15], v[204:207], v[208:211], v[12:15]
  ds_read_b64_tr_b16 v[228:229], v142 offset:8192
  v_mfma_f32_16x16x32_bf16 v[28:31], v[204:207], v[212:215], v[28:31]
  ds_read_b64_tr_b16 v[230:231], v142 offset:12288
  v_mfma_f32_16x16x32_bf16 v[24:27], v[200:203], v[212:215], v[24:27]
  ds_read_b64_tr_b16 v[232:233], v143 offset:8192
  v_mfma_f32_16x16x32_bf16 v[20:23], v[196:199], v[212:215], v[20:23]
  ds_read_b64_tr_b16 v[234:235], v143 offset:12288
  v_mfma_f32_16x16x32_bf16 v[16:19], v[192:195], v[212:215], v[16:19]
  ds_read_b64_tr_b16 v[236:237], v144 offset:8192
  v_mfma_f32_16x16x32_bf16 v[32:35], v[192:195], v[216:219], v[32:35]
  ds_read_b64_tr_b16 v[238:239], v144 offset:12288
  v_mfma_f32_16x16x32_bf16 v[36:39], v[196:199], v[216:219], v[36:39]
  ds_read_b128 v[244:247], v140 offset:3072
  v_mfma_f32_16x16x32_bf16 v[40:43], v[200:203], v[216:219], v[40:43]
  ds_read_b128 v[248:251], v140 offset:5120
  v_mfma_f32_16x16x32_bf16 v[44:47], v[204:207], v[216:219], v[44:47]
  ds_read_b128 v[252:255], v140 offset:7168
  v_mfma_f32_16x16x32_bf16 v[60:63], v[204:207], v[220:223], v[60:63]
  v_mfma_f32_16x16x32_bf16 v[56:59], v[200:203], v[220:223], v[56:59]
  v_mfma_f32_16x16x32_bf16 v[52:55], v[196:199], v[220:223], v[52:55]
  v_mfma_f32_16x16x32_bf16 v[48:51], v[192:195], v[220:223], v[48:51]
  s_waitcnt lgkmcnt(0)
  s_barrier
  v_mfma_f32_16x16x32_bf16 v[0:3], v[224:227], v[240:243], v[0:3]
  ds_read_b128 v[208:211], v140 offset:16384
  v_mfma_f32_16x16x32_bf16 v[4:7], v[228:231], v[240:243], v[4:7]
  ds_read_b64_tr_b16 v[192:193], v141 offset:16384
  v_mfma_f32_16x16x32_bf16 v[8:11], v[232:235], v[240:243], v[8:11]
  ds_read_b64_tr_b16 v[194:195], v141 offset:20480
  v_mfma_f32_16x16x32_bf16 v[12:15], v[236:239], v[240:243], v[12:15]
  ds_read_b64_tr_b16 v[196:197], v142 offset:16384
  v_mfma_f32_16x16x32_bf16 v[28:31], v[236:239], v[244:247], v[28:31]
  ds_read_b64_tr_b16 v[198:199], v142 offset:20480
  v_mfma_f32_16x16x32_bf16 v[24:27], v[232:235], v[244:247], v[24:27]
  ds_read_b64_tr_b16 v[200:201], v143 offset:16384
  v_mfma_f32_16x16x32_bf16 v[20:23], v[228:231], v[244:247], v[20:23]
  ds_read_b64_tr_b16 v[202:203], v143 offset:20480
  v_mfma_f32_16x16x32_bf16 v[16:19], v[224:227], v[244:247], v[16:19]
  ds_read_b64_tr_b16 v[204:205], v144 offset:16384
  v_mfma_f32_16x16x32_bf16 v[32:35], v[224:227], v[248:251], v[32:35]
  ds_read_b64_tr_b16 v[206:207], v144 offset:20480
  v_mfma_f32_16x16x32_bf16 v[36:39], v[228:231], v[248:251], v[36:39]
  ds_read_b128 v[212:215], v140 offset:18432
  v_mfma_f32_16x16x32_bf16 v[40:43], v[232:235], v[248:251], v[40:43]
  ds_read_b128 v[216:219], v140 offset:20480
  v_mfma_f32_16x16x32_bf16 v[44:47], v[236:239], v[248:251], v[44:47]
  ds_read_b128 v[220:223], v140 offset:22528
  v_mfma_f32_16x16x32_bf16 v[60:63], v[236:239], v[252:255], v[60:63]
  v_mfma_f32_16x16x32_bf16 v[56:59], v[232:235], v[252:255], v[56:59]
  v_mfma_f32_16x16x32_bf16 v[52:55], v[228:231], v[252:255], v[52:55]
  v_mfma_f32_16x16x32_bf16 v[48:51], v[224:227], v[252:255], v[48:51]
  s_waitcnt lgkmcnt(0)
  v_mfma_f32_16x16x32_bf16 v[0:3], v[192:195], v[208:211], v[0:3]
  ds_read_b128 v[240:243], v140 offset:17408
  v_mfma_f32_16x16x32_bf16 v[4:7], v[196:199], v[208:211], v[4:7]
  ds_read_b64_tr_b16 v[224:225], v141 offset:24576
  v_mfma_f32_16x16x32_bf16 v[8:11], v[200:203], v[208:211], v[8:11]
  ds_read_b64_tr_b16 v[226:227], v141 offset:28672
  v_mfma_f32_16x16x32_bf16 v[12:15], v[204:207], v[208:211], v[12:15]
  ds_read_b64_tr_b16 v[228:229], v142 offset:24576
  v_mfma_f32_16x16x32_bf16 v[28:31], v[204:207], v[212:215], v[28:31]
  ds_read_b64_tr_b16 v[230:231], v142 offset:28672
  v_mfma_f32_16x16x32_bf16 v[24:27], v[200:203], v[212:215], v[24:27]
  ds_read_b64_tr_b16 v[232:233], v143 offset:24576
  v_mfma_f32_16x16x32_bf16 v[20:23], v[196:199], v[212:215], v[20:23]
  ds_read_b64_tr_b16 v[234:235], v143 offset:28672
  v_mfma_f32_16x16x32_bf16 v[16:19], v[192:195], v[212:215], v[16:19]
  ds_read_b64_tr_b16 v[236:237], v144 offset:24576
  v_mfma_f32_16x16x32_bf16 v[32:35], v[192:195], v[216:219], v[32:35]
  ds_read_b64_tr_b16 v[238:239], v144 offset:28672
  v_mfma_f32_16x16x32_bf16 v[36:39], v[196:199], v[216:219], v[36:39]
  ds_read_b128 v[244:247], v140 offset:19456
  v_mfma_f32_16x16x32_bf16 v[40:43], v[200:203], v[216:219], v[40:43]
  ds_read_b128 v[248:251], v140 offset:21504
  v_mfma_f32_16x16x32_bf16 v[44:47], v[204:207], v[216:219], v[44:47]
  ds_read_b128 v[252:255], v140 offset:23552
  v_mfma_f32_16x16x32_bf16 v[60:63], v[204:207], v[220:223], v[60:63]
  v_mfma_f32_16x16x32_bf16 v[56:59], v[200:203], v[220:223], v[56:59]
  v_mfma_f32_16x16x32_bf16 v[52:55], v[196:199], v[220:223], v[52:55]
  v_mfma_f32_16x16x32_bf16 v[48:51], v[192:195], v[220:223], v[48:51]
  s_waitcnt lgkmcnt(0)
  s_barrier
  v_mfma_f32_16x16x32_bf16 v[0:3], v[224:227], v[240:243], v[0:3]
  ds_read_b128 v[208:211], v140 offset:32768
  v_mfma_f32_16x16x32_bf16 v[4:7], v[228:231], v[240:243], v[4:7]
  ds_read_b64_tr_b16 v[192:193], v141 offset:32768
  v_mfma_f32_16x16x32_bf16 v[8:11], v[232:235], v[240:243], v[8:11]
  ds_read_b64_tr_b16 v[194:195], v141 offset:36864
  v_mfma_f32_16x16x32_bf16 v[12:15], v[236:239], v[240:243], v[12:15]
  ds_read_b64_tr_b16 v[196:197], v142 offset:32768
  v_mfma_f32_16x16x32_bf16 v[28:31], v[236:239], v[244:247], v[28:31]
  ds_read_b64_tr_b16 v[198:199], v142 offset:36864
  v_mfma_f32_16x16x32_bf16 v[24:27], v[232:235], v[244:247], v[24:27]
  ds_read_b64_tr_b16 v[200:201], v143 offset:32768
  v_mfma_f32_16x16x32_bf16 v[20:23], v[228:231], v[244:247], v[20:23]
  ds_read_b64_tr_b16 v[202:203], v143 offset:36864
  v_mfma_f32_16x16x32_bf16 v[16:19], v[224:227], v[244:247], v[16:19]
  ds_read_b64_tr_b16 v[204:205], v144 offset:32768
  v_mfma_f32_16x16x32_bf16 v[32:35], v[224:227], v[248:251], v[32:35]
  ds_read_b64_tr_b16 v[206:207], v144 offset:36864
  v_mfma_f32_16x16x32_bf16 v[36:39], v[228:231], v[248:251], v[36:39]
  ds_read_b128 v[212:215], v140 offset:34816
  v_mfma_f32_16x16x32_bf16 v[40:43], v[232:235], v[248:251], v[40:43]
  ds_read_b128 v[216:219], v140 offset:36864
  v_mfma_f32_16x16x32_bf16 v[44:47], v[236:239], v[248:251], v[44:47]
  ds_read_b128 v[220:223], v140 offset:38912
  v_mfma_f32_16x16x32_bf16 v[60:63], v[236:239], v[252:255], v[60:63]
  v_mfma_f32_16x16x32_bf16 v[56:59], v[232:235], v[252:255], v[56:59]
  v_mfma_f32_16x16x32_bf16 v[52:55], v[228:231], v[252:255], v[52:55]
  v_mfma_f32_16x16x32_bf16 v[48:51], v[224:227], v[252:255], v[48:51]
  s_waitcnt lgkmcnt(0)
  v_mfma_f32_16x16x32_bf16 v[0:3], v[192:195], v[208:211], v[0:3]
  ds_read_b128 v[240:243], v140 offset:33792
  v_mfma_f32_16x16x32_bf16 v[4:7], v[196:199], v[208:211], v[4:7]
  ds_read_b64_tr_b16 v[224:225], v141 offset:40960
  v_mfma_f32_16x16x32_bf16 v[8:11], v[200:203], v[208:211], v[8:11]
  ds_read_b64_tr_b16 v[226:227], v141 offset:45056
  v_mfma_f32_16x16x32_bf16 v[12:15], v[204:207], v[208:211], v[12:15]
  ds_read_b64_tr_b16 v[228:229], v142 offset:40960
  v_mfma_f32_16x16x32_bf16 v[28:31], v[204:207], v[212:215], v[28:31]
  ds_read_b64_tr_b16 v[230:231], v142 offset:45056
  v_mfma_f32_16x16x32_bf16 v[24:27], v[200:203], v[212:215], v[24:27]
  ds_read_b64_tr_b16 v[232:233], v143 offset:40960
  v_mfma_f32_16x16x32_bf16 v[20:23], v[196:199], v[212:215], v[20:23]
  ds_read_b64_tr_b16 v[234:235], v143 offset:45056
  v_mfma_f32_16x16x32_bf16 v[16:19], v[192:195], v[212:215], v[16:19]
  ds_read_b64_tr_b16 v[236:237], v144 offset:40960
  v_mfma_f32_16x16x32_bf16 v[32:35], v[192:195], v[216:219], v[32:35]
  ds_read_b64_tr_b16 v[238:239], v144 offset:45056
  v_mfma_f32_16x16x32_bf16 v[36:39], v[196:199], v[216:219], v[36:39]
  ds_read_b128 v[244:247], v140 offset:35840
  v_mfma_f32_16x16x32_bf16 v[40:43], v[200:203], v[216:219], v[40:43]
  ds_read_b128 v[248:251], v140 offset:37888
  v_mfma_f32_16x16x32_bf16 v[44:47], v[204:207], v[216:219], v[44:47]
  ds_read_b128 v[252:255], v140 offset:39936
  v_mfma_f32_16x16x32_bf16 v[60:63], v[204:207], v[220:223], v[60:63]
  v_mfma_f32_16x16x32_bf16 v[56:59], v[200:203], v[220:223], v[56:59]
  v_mfma_f32_16x16x32_bf16 v[52:55], v[196:199], v[220:223], v[52:55]
  v_mfma_f32_16x16x32_bf16 v[48:51], v[192:195], v[220:223], v[48:51]
  s_waitcnt lgkmcnt(0)
  s_barrier
  v_mfma_f32_16x16x32_bf16 v[0:3], v[224:227], v[240:243], v[0:3]
  ds_read_b128 v[208:211], v140 offset:49152
  v_mfma_f32_16x16x32_bf16 v[4:7], v[228:231], v[240:243], v[4:7]
  ds_read_b64_tr_b16 v[192:193], v141 offset:49152
  v_mfma_f32_16x16x32_bf16 v[8:11], v[232:235], v[240:243], v[8:11]
  ds_read_b64_tr_b16 v[194:195], v141 offset:53248
  v_mfma_f32_16x16x32_bf16 v[12:15], v[236:239], v[240:243], v[12:15]
  ds_read_b64_tr_b16 v[196:197], v142 offset:49152
  v_mfma_f32_16x16x32_bf16 v[28:31], v[236:239], v[244:247], v[28:31]
  ds_read_b64_tr_b16 v[198:199], v142 offset:53248
  v_mfma_f32_16x16x32_bf16 v[24:27], v[232:235], v[244:247], v[24:27]
  ds_read_b64_tr_b16 v[200:201], v143 offset:49152
  v_mfma_f32_16x16x32_bf16 v[20:23], v[228:231], v[244:247], v[20:23]
  ds_read_b64_tr_b16 v[202:203], v143 offset:53248
  v_mfma_f32_16x16x32_bf16 v[16:19], v[224:227], v[244:247], v[16:19]
  ds_read_b64_tr_b16 v[204:205], v144 offset:49152
  v_mfma_f32_16x16x32_bf16 v[32:35], v[224:227], v[248:251], v[32:35]
  ds_read_b64_tr_b16 v[206:207], v144 offset:53248
  v_mfma_f32_16x16x32_bf16 v[36:39], v[228:231], v[248:251], v[36:39]
  ds_read_b128 v[212:215], v140 offset:51200
  v_mfma_f32_16x16x32_bf16 v[40:43], v[232:235], v[248:251], v[40:43]
  ds_read_b128 v[216:219], v140 offset:53248
  v_mfma_f32_16x16x32_bf16 v[44:47], v[236:239], v[248:251], v[44:47]
  ds_read_b128 v[220:223], v140 offset:55296
  v_mfma_f32_16x16x32_bf16 v[60:63], v[236:239], v[252:255], v[60:63]
  v_mfma_f32_16x16x32_bf16 v[56:59], v[232:235], v[252:255], v[56:59]
  v_mfma_f32_16x16x32_bf16 v[52:55], v[228:231], v[252:255], v[52:55]
  v_mfma_f32_16x16x32_bf16 v[48:51], v[224:227], v[252:255], v[48:51]
  s_waitcnt lgkmcnt(0)
  v_mfma_f32_16x16x32_bf16 v[0:3], v[192:195], v[208:211], v[0:3]
  ds_read_b128 v[240:243], v140 offset:50176
  v_mfma_f32_16x16x32_bf16 v[4:7], v[196:199], v[208:211], v[4:7]
  ds_read_b64_tr_b16 v[224:225], v141 offset:57344
  v_mfma_f32_16x16x32_bf16 v[8:11], v[200:203], v[208:211], v[8:11]
  ds_read_b64_tr_b16 v[226:227], v141 offset:61440
  v_mfma_f32_16x16x32_bf16 v[12:15], v[204:207], v[208:211], v[12:15]
  ds_read_b64_tr_b16 v[228:229], v142 offset:57344
  v_mfma_f32_16x16x32_bf16 v[28:31], v[204:207], v[212:215], v[28:31]
  ds_read_b64_tr_b16 v[230:231], v142 offset:61440
  v_mfma_f32_16x16x32_bf16 v[24:27], v[200:203], v[212:215], v[24:27]
  ds_read_b64_tr_b16 v[232:233], v143 offset:57344
  v_mfma_f32_16x16x32_bf16 v[20:23], v[196:199], v[212:215], v[20:23]
  ds_read_b64_tr_b16 v[234:235], v143 offset:61440
  v_mfma_f32_16x16x32_bf16 v[16:19], v[192:195], v[212:215], v[16:19]
  ds_read_b64_tr_b16 v[236:237], v144 offset:57344
  v_mfma_f32_16x16x32_bf16 v[32:35], v[192:195], v[216:219], v[32:35]
  ds_read_b64_tr_b16 v[238:239], v144 offset:61440
  v_mfma_f32_16x16x32_bf16 v[36:39], v[196:199], v[216:219], v[36:39]
  ds_read_b128 v[244:247], v140 offset:52224
  v_mfma_f32_16x16x32_bf16 v[40:43], v[200:203], v[216:219], v[40:43]
  ds_read_b128 v[248:251], v140 offset:54272
  v_mfma_f32_16x16x32_bf16 v[44:47], v[204:207], v[216:219], v[44:47]
  ds_read_b128 v[252:255], v140 offset:56320
  v_mfma_f32_16x16x32_bf16 v[60:63], v[204:207], v[220:223], v[60:63]
  v_mfma_f32_16x16x32_bf16 v[56:59], v[200:203], v[220:223], v[56:59]
  v_mfma_f32_16x16x32_bf16 v[52:55], v[196:199], v[220:223], v[52:55]
  v_mfma_f32_16x16x32_bf16 v[48:51], v[192:195], v[220:223], v[48:51]
  s_waitcnt lgkmcnt(0)
  v_mfma_f32_16x16x32_bf16 v[0:3], v[224:227], v[240:243], v[0:3]
  v_mfma_f32_16x16x32_bf16 v[4:7], v[228:231], v[240:243], v[4:7]
  v_mfma_f32_16x16x32_bf16 v[8:11], v[232:235], v[240:243], v[8:11]
  v_mfma_f32_16x16x32_bf16 v[12:15], v[236:239], v[240:243], v[12:15]
  v_mfma_f32_16x16x32_bf16 v[16:19], v[224:227], v[244:247], v[16:19]
  v_mfma_f32_16x16x32_bf16 v[20:23], v[228:231], v[244:247], v[20:23]
  v_mfma_f32_16x16x32_bf16 v[24:27], v[232:235], v[244:247], v[24:27]
  v_mfma_f32_16x16x32_bf16 v[28:31], v[236:239], v[244:247], v[28:31]
  v_mfma_f32_16x16x32_bf16 v[32:35], v[224:227], v[248:251], v[32:35]
  v_cvt_pk_bf16_f32 v0, v0, v1
  v_cvt_pk_bf16_f32 v1, v2, v3
  v_cvt_pk_bf16_f32 v2, v4, v5
  v_mfma_f32_16x16x32_bf16 v[36:39], v[228:231], v[248:251], v[36:39]
  v_cvt_pk_bf16_f32 v3, v6, v7
  v_permlane16_swap_b32 v0, v2
  s_nop 0
  v_permlane16_swap_b32 v1, v3
  v_mfma_f32_16x16x32_bf16 v[40:43], v[232:235], v[248:251], v[40:43]
  ds_write_b128 v145, v[0:3] offset:0
  v_cvt_pk_bf16_f32 v4, v8, v9
  v_cvt_pk_bf16_f32 v5, v10, v11
  v_mfma_f32_16x16x32_bf16 v[44:47], v[236:239], v[248:251], v[44:47]
  v_cvt_pk_bf16_f32 v6, v12, v13
  v_cvt_pk_bf16_f32 v7, v14, v15
  s_nop 0
  v_permlane16_swap_b32 v4, v6
  v_permlane16_swap_b32 v5, v7
  ds_write_b128 v146, v[4:7] offset:0
  v_mfma_f32_16x16x32_bf16 v[48:51], v[224:227], v[252:255], v[48:51]
  v_cvt_pk_bf16_f32 v8, v16, v17
  v_cvt_pk_bf16_f32 v9, v18, v19
  v_cvt_pk_bf16_f32 v10, v20, v21
  v_mfma_f32_16x16x32_bf16 v[52:55], v[228:231], v[252:255], v[52:55]
  v_cvt_pk_bf16_f32 v11, v22, v23
  v_permlane16_swap_b32 v8, v10
  s_nop 0
  v_permlane16_swap_b32 v9, v11
  v_mfma_f32_16x16x32_bf16 v[56:59], v[232:235], v[252:255], v[56:59]
  ds_write_b128 v145, v[8:11] offset:4096
  v_cvt_pk_bf16_f32 v12, v24, v25
  v_cvt_pk_bf16_f32 v13, v26, v27
  v_mfma_f32_16x16x32_bf16 v[60:63], v[236:239], v[252:255], v[60:63]
  v_cvt_pk_bf16_f32 v14, v28, v29
  v_cvt_pk_bf16_f32 v15, v30, v31
  s_nop 0
  v_permlane16_swap_b32 v12, v14
  v_permlane16_swap_b32 v13, v15
  ds_write_b128 v146, v[12:15] offset:4096
  v_cvt_pk_bf16_f32 v16, v32, v33
  v_cvt_pk_bf16_f32 v17, v34, v35
  v_cvt_pk_bf16_f32 v18, v36, v37
  v_cvt_pk_bf16_f32 v19, v38, v39
  s_nop 0
  v_permlane16_swap_b32 v16, v18
  v_permlane16_swap_b32 v17, v19
  ds_write_b128 v145, v[16:19] offset:8192
  v_cvt_pk_bf16_f32 v20, v40, v41
  v_cvt_pk_bf16_f32 v21, v42, v43
  v_cvt_pk_bf16_f32 v22, v44, v45
  v_cvt_pk_bf16_f32 v23, v46, v47
  s_nop 0
  v_permlane16_swap_b32 v20, v22
  v_permlane16_swap_b32 v21, v23
  ds_write_b128 v146, v[20:23] offset:8192
  v_cvt_pk_bf16_f32 v24, v48, v49
  v_cvt_pk_bf16_f32 v25, v50, v51
  v_cvt_pk_bf16_f32 v26, v52, v53
  v_cvt_pk_bf16_f32 v27, v54, v55
  s_nop 0
  v_permlane16_swap_b32 v24, v26
  v_permlane16_swap_b32 v25, v27
  ds_write_b128 v145, v[24:27] offset:12288
  v_cvt_pk_bf16_f32 v28, v56, v57
  v_cvt_pk_bf16_f32 v29, v58, v59
  v_cvt_pk_bf16_f32 v30, v60, v61
  v_cvt_pk_bf16_f32 v31, v62, v63
  s_nop 0
  v_permlane16_swap_b32 v28, v30
  v_permlane16_swap_b32 v29, v31
  ds_write_b128 v146, v[28:31] offset:12288
  s_mov_b32 s24, s52
  s_and_b32 s25, s53, 0xffff
  s_mov_b32 s26, 0x400000
  s_mov_b32 s27, 0x20000
  s_lshl_b32 s12, s5, 8
  s_add_u32 s12, s12, s2
  s_lshl_b32 s12, s12, 11
  s_add_u32 s13, s12, 2097152
  s_lshl_b32 s40, s2, 7
  s_add_u32 s42, s40, 33570816
  s_lshl_b32 s38, s2, 15
  s_lshl_b32 s39, s5, 11
  s_add_u32 s38, s38, s39
  s_add_u32 s28, s38, 41943040
  s_add_u32 s29, s28, 16384
  s_add_u32 s30, s28, 8192
  s_add_u32 s31, s28, 24576
  s_waitcnt lgkmcnt(0)
  s_barrier
  ds_read_b128 v[192:195], v178 offset:0
  ds_read_b128 v[196:199], v178 offset:2048
  ds_read_b128 v[200:203], v179 offset:0
  ds_read_b128 v[204:207], v179 offset:2048
  v_mov_b32 v208, 0
  v_mov_b32 v209, 0
  s_waitcnt lgkmcnt(2)
  v_pk_mov_b32 v[32:33], v[192:193], v[196:197] op_sel:[0,0]
  v_pk_mov_b32 v[34:35], v[192:193], v[196:197] op_sel:[1,1]
  v_pk_mov_b32 v[36:37], v[194:195], v[198:199] op_sel:[0,0]
  v_pk_mov_b32 v[38:39], v[194:195], v[198:199] op_sel:[1,1]
  v_mfma_f32_16x16x16_bf16 v[0:3], v[32:33], v[120:121], 0
  v_mfma_f32_16x16x16_bf16 v[4:7], v[34:35], v[120:121], 0
  v_mfma_f32_16x16x16_bf16 v[8:11], v[36:37], v[120:121], 0
  v_mfma_f32_16x16x16_bf16 v[12:15], v[38:39], v[120:121], 0
  s_waitcnt lgkmcnt(0)
  v_pk_mov_b32 v[48:49], v[200:201], v[204:205] op_sel:[0,0]
  v_pk_mov_b32 v[50:51], v[200:201], v[204:205] op_sel:[1,1]
  v_pk_mov_b32 v[52:53], v[202:203], v[206:207] op_sel:[0,0]
  v_pk_mov_b32 v[54:55], v[202:203], v[206:207] op_sel:[1,1]
  v_mfma_f32_16x16x16_bf16 v[16:19], v[48:49], v[120:121], 0
  v_mfma_f32_16x16x16_bf16 v[20:23], v[50:51], v[120:121], 0
  v_mfma_f32_16x16x16_bf16 v[24:27], v[52:53], v[120:121], 0
  v_mfma_f32_16x16x16_bf16 v[28:31], v[54:55], v[120:121], 0
  v_cvt_pk_bf16_f32 v40, v0, v1
  v_cvt_pk_bf16_f32 v41, v2, v3
  ds_write_b64 v136, v[40:41] offset:0
  v_cvt_pk_bf16_f32 v42, v4, v5
  v_cvt_pk_bf16_f32 v43, v6, v7
  ds_write_b64 v137, v[42:43] offset:0
  v_cvt_pk_bf16_f32 v44, v8, v9
  v_cvt_pk_bf16_f32 v45, v10, v11
  ds_write_b64 v138, v[44:45] offset:0
  v_cvt_pk_bf16_f32 v46, v12, v13
  v_cvt_pk_bf16_f32 v47, v14, v15
  ds_write_b64 v139, v[46:47] offset:0
  v_cvt_pk_bf16_f32 v56, v16, v17
  v_cvt_pk_bf16_f32 v57, v18, v19
  ds_write_b64 v136, v[56:57] offset:128
  v_cvt_pk_bf16_f32 v58, v20, v21
  v_cvt_pk_bf16_f32 v59, v22, v23
  ds_write_b64 v137, v[58:59] offset:128
  v_cvt_pk_bf16_f32 v60, v24, v25
  v_cvt_pk_bf16_f32 v61, v26, v27
  ds_write_b64 v138, v[60:61] offset:128
  v_cvt_pk_bf16_f32 v62, v28, v29
  v_cvt_pk_bf16_f32 v63, v30, v31
  ds_write_b64 v139, v[62:63] offset:128
  v_lshlrev_b32 v146, 2, v147
  s_mov_b32 s18, 0
  s_mov_b64 exec, 0xffff
  buffer_load_dword v145, v146, s[56:59], s42 offen sc1
  s_mov_b64 exec, -1
  s_waitcnt lgkmcnt(0)
  s_barrier
  ds_read_b128 v[192:195], v176 offset:0
  ds_read_b128 v[196:199], v177 offset:1024
  ds_read_u16_d16_hi v208, v123 offset:1024
  ds_read_b128 v[200:203], v176 offset:8192
  ds_read_b128 v[204:207], v177 offset:9216
  ds_read_u16_d16_hi v209, v123 offset:9216
  s_waitcnt lgkmcnt(4)
  v_mfma_f32_32x32x16_bf16 v[0:15], v[192:195], v[124:127], 0
  v_mfma_f32_32x32x16_bf16 v[32:47], v[192:195], v[128:131], 0
  v_mfma_f32_32x32x16_bf16 v[0:15], v[196:199], v[132:135], v[0:15]
  v_mfma_f32_32x32x16_bf16 v[32:47], v[196:199], v[124:127], v[32:47]
  s_waitcnt lgkmcnt(1)
  v_mfma_f32_32x32x16_bf16 v[16:31], v[200:203], v[124:127], 0
  v_mfma_f32_32x32x16_bf16 v[48:63], v[200:203], v[128:131], 0
  v_mfma_f32_32x32x16_bf16 v[16:31], v[204:207], v[132:135], v[16:31]
  v_mfma_f32_32x32x16_bf16 v[48:63], v[204:207], v[124:127], v[48:63]
  s_waitcnt lgkmcnt(0)
  s_lshl_b32 s32, s5, 11
  v_lshlrev_b32 v140, 4, v147
  v_add_u32 v141, s32, v140
  ds_read_b128 v[96:99], v141 offset:0
  ds_read_b128 v[100:103], v141 offset:1024
  ds_read_b128 v[104:107], v141 offset:8192
  ds_read_b128 v[108:111], v141 offset:9216
  ds_read_b128 v[112:115], v140 offset:16384
  ds_read_b128 v[116:119], v140 offset:17408
  v_fmac_f32 v0, v208, v122
  v_pk_mul_f32 v[164:165], v[0:1], v[64:65]
  v_pk_mul_f32 v[0:1], v[0:1], v[80:81]
  v_pk_fma_f32 v[164:165], v[32:33], v[80:81], v[164:165] neg_lo:[1,0,0] neg_hi:[1,0,0]
  v_pk_fma_f32 v[0:1], v[32:33], v[64:65], v[0:1]
  v_cvt_pk_bf16_f32 v192, v164, v165
  v_cvt_pk_bf16_f32 v200, v0, v1
  v_pk_mul_f32 v[166:167], v[2:3], v[66:67]
  v_pk_mul_f32 v[2:3], v[2:3], v[82:83]
  v_pk_fma_f32 v[166:167], v[34:35], v[82:83], v[166:167] neg_lo:[1,0,0] neg_hi:[1,0,0]
  v_pk_fma_f32 v[2:3], v[34:35], v[66:67], v[2:3]
  v_cvt_pk_bf16_f32 v193, v166, v167
  v_cvt_pk_bf16_f32 v201, v2, v3
  v_pk_mul_f32 v[164:165], v[4:5], v[68:69]
  v_pk_mul_f32 v[4:5], v[4:5], v[84:85]
  v_pk_fma_f32 v[164:165], v[36:37], v[84:85], v[164:165] neg_lo:[1,0,0] neg_hi:[1,0,0]
  v_pk_fma_f32 v[4:5], v[36:37], v[68:69], v[4:5]
  v_cvt_pk_bf16_f32 v194, v164, v165
  v_cvt_pk_bf16_f32 v202, v4, v5
  v_pk_mul_f32 v[166:167], v[6:7], v[70:71]
  v_pk_mul_f32 v[6:7], v[6:7], v[86:87]
  v_pk_fma_f32 v[166:167], v[38:39], v[86:87], v[166:167] neg_lo:[1,0,0] neg_hi:[1,0,0]
  v_pk_fma_f32 v[6:7], v[38:39], v[70:71], v[6:7]
  v_cvt_pk_bf16_f32 v195, v166, v167
  v_cvt_pk_bf16_f32 v203, v6, v7
  v_pk_mul_f32 v[164:165], v[8:9], v[72:73]
  v_pk_mul_f32 v[8:9], v[8:9], v[88:89]
  v_pk_fma_f32 v[164:165], v[40:41], v[88:89], v[164:165] neg_lo:[1,0,0] neg_hi:[1,0,0]
  v_pk_fma_f32 v[8:9], v[40:41], v[72:73], v[8:9]
  v_cvt_pk_bf16_f32 v196, v164, v165
  v_cvt_pk_bf16_f32 v204, v8, v9
  v_pk_mul_f32 v[166:167], v[10:11], v[74:75]
  v_pk_mul_f32 v[10:11], v[10:11], v[90:91]
  v_pk_fma_f32 v[166:167], v[42:43], v[90:91], v[166:167] neg_lo:[1,0,0] neg_hi:[1,0,0]
  v_pk_fma_f32 v[10:11], v[42:43], v[74:75], v[10:11]
  v_cvt_pk_bf16_f32 v197, v166, v167
  v_cvt_pk_bf16_f32 v205, v10, v11
  v_pk_mul_f32 v[164:165], v[12:13], v[76:77]
  v_pk_mul_f32 v[12:13], v[12:13], v[92:93]
  v_pk_fma_f32 v[164:165], v[44:45], v[92:93], v[164:165] neg_lo:[1,0,0] neg_hi:[1,0,0]
  v_pk_fma_f32 v[12:13], v[44:45], v[76:77], v[12:13]
  v_cvt_pk_bf16_f32 v198, v164, v165
  v_cvt_pk_bf16_f32 v206, v12, v13
  v_pk_mul_f32 v[166:167], v[14:15], v[78:79]
  v_pk_mul_f32 v[14:15], v[14:15], v[94:95]
  v_pk_fma_f32 v[166:167], v[46:47], v[94:95], v[166:167] neg_lo:[1,0,0] neg_hi:[1,0,0]
  v_pk_fma_f32 v[14:15], v[46:47], v[78:79], v[14:15]
  v_cvt_pk_bf16_f32 v199, v166, v167
  v_cvt_pk_bf16_f32 v207, v14, v15
  v_mfma_f32_32x32x16_bf16 v[32:47], v[192:195], v[148:151], 0
  v_mfma_f32_32x32x16_bf16 v[32:47], v[200:203], v[156:159], v[32:47]
  v_mfma_f32_32x32x16_bf16 v[32:47], v[196:199], v[152:155], v[32:47]
  v_mfma_f32_32x32x16_bf16 v[32:47], v[204:207], v[160:163], v[32:47]
  s_waitcnt vmcnt(0)
  v_cmp_gt_u32 vcc, 1, v145
  s_nop 1
  s_mov_b32 s19, vcc_lo
  s_bitcmp1_b32 s18, 0
  s_cbranch_scc1 x_w_12
  s_and_b32 s34, s19, 0xff
  s_cbranch_scc1 x_w_12
  buffer_load_dwordx4 v[228:231], v180, s[56:59], s28 offen offset:0 sc1
  buffer_load_dwordx4 v[232:235], v180, s[56:59], s29 offen offset:0 sc1
  buffer_load_dwordx4 v[236:239], v180, s[56:59], s30 offen offset:0 sc1
  buffer_load_dwordx4 v[240:243], v180, s[56:59], s31 offen offset:0 sc1
  s_bitset1_b32 s18, 0
x_w_12:
  s_bitcmp1_b32 s18, 1
  s_cbranch_scc1 x_w_14
  s_and_b32 s34, s19, 0x3f00
  s_cbranch_scc1 x_w_14
  buffer_load_dwordx4 v[244:247], v180, s[56:59], s28 offen offset:1024 sc1
  buffer_load_dwordx4 v[248:251], v180, s[56:59], s29 offen offset:1024 sc1
  buffer_load_dwordx4 v[252:255], v180, s[56:59], s30 offen offset:1024 sc1
  buffer_load_dwordx4 v[184:187], v180, s[56:59], s31 offen offset:1024 sc1
  s_bitset1_b32 s18, 1
x_w_14:
  s_and_b32 s34, s18, 3
  s_cmp_eq_u32 s34, 3
  s_cbranch_scc1 x_g_15
  s_mov_b64 exec, 0xffff
  buffer_load_dword v145, v146, s[56:59], s42 offen sc1
  s_mov_b64 exec, -1
x_g_15:
  v_fmac_f32 v16, v209, v122
  v_pk_mul_f32 v[164:165], v[16:17], v[64:65]
  v_pk_mul_f32 v[16:17], v[16:17], v[80:81]
  v_pk_fma_f32 v[164:165], v[48:49], v[80:81], v[164:165] neg_lo:[1,0,0] neg_hi:[1,0,0]
  v_pk_fma_f32 v[16:17], v[48:49], v[64:65], v[16:17]
  v_cvt_pk_bf16_f32 v212, v164, v165
  v_cvt_pk_bf16_f32 v220, v16, v17
  v_pk_mul_f32 v[166:167], v[18:19], v[66:67]
  v_pk_mul_f32 v[18:19], v[18:19], v[82:83]
  v_pk_fma_f32 v[166:167], v[50:51], v[82:83], v[166:167] neg_lo:[1,0,0] neg_hi:[1,0,0]
  v_pk_fma_f32 v[18:19], v[50:51], v[66:67], v[18:19]
  v_cvt_pk_bf16_f32 v213, v166, v167
  v_cvt_pk_bf16_f32 v221, v18, v19
  v_pk_mul_f32 v[164:165], v[20:21], v[68:69]
  v_pk_mul_f32 v[20:21], v[20:21], v[84:85]
  v_pk_fma_f32 v[164:165], v[52:53], v[84:85], v[164:165] neg_lo:[1,0,0] neg_hi:[1,0,0]
  v_pk_fma_f32 v[20:21], v[52:53], v[68:69], v[20:21]
  v_cvt_pk_bf16_f32 v214, v164, v165
  v_cvt_pk_bf16_f32 v222, v20, v21
  v_pk_mul_f32 v[166:167], v[22:23], v[70:71]
  v_pk_mul_f32 v[22:23], v[22:23], v[86:87]
  v_pk_fma_f32 v[166:167], v[54:55], v[86:87], v[166:167] neg_lo:[1,0,0] neg_hi:[1,0,0]
  v_pk_fma_f32 v[22:23], v[54:55], v[70:71], v[22:23]
  v_cvt_pk_bf16_f32 v215, v166, v167
  v_cvt_pk_bf16_f32 v223, v22, v23
  v_pk_mul_f32 v[164:165], v[24:25], v[72:73]
  v_pk_mul_f32 v[24:25], v[24:25], v[88:89]
  v_pk_fma_f32 v[164:165], v[56:57], v[88:89], v[164:165] neg_lo:[1,0,0] neg_hi:[1,0,0]
  v_pk_fma_f32 v[24:25], v[56:57], v[72:73], v[24:25]
  v_cvt_pk_bf16_f32 v216, v164, v165
  v_cvt_pk_bf16_f32 v224, v24, v25
  v_pk_mul_f32 v[166:167], v[26:27], v[74:75]
  v_pk_mul_f32 v[26:27], v[26:27], v[90:91]
  v_pk_fma_f32 v[166:167], v[58:59], v[90:91], v[166:167] neg_lo:[1,0,0] neg_hi:[1,0,0]
  v_pk_fma_f32 v[26:27], v[58:59], v[74:75], v[26:27]
  v_cvt_pk_bf16_f32 v217, v166, v167
  v_cvt_pk_bf16_f32 v225, v26, v27
  v_pk_mul_f32 v[164:165], v[28:29], v[76:77]
  v_pk_mul_f32 v[28:29], v[28:29], v[92:93]
  v_pk_fma_f32 v[164:165], v[60:61], v[92:93], v[164:165] neg_lo:[1,0,0] neg_hi:[1,0,0]
  v_pk_fma_f32 v[28:29], v[60:61], v[76:77], v[28:29]
  v_cvt_pk_bf16_f32 v218, v164, v165
  v_cvt_pk_bf16_f32 v226, v28, v29
  v_pk_mul_f32 v[166:167], v[30:31], v[78:79]
  v_pk_mul_f32 v[30:31], v[30:31], v[94:95]
  v_pk_fma_f32 v[166:167], v[62:63], v[94:95], v[166:167] neg_lo:[1,0,0] neg_hi:[1,0,0]
  v_pk_fma_f32 v[30:31], v[62:63], v[78:79], v[30:31]
  v_cvt_pk_bf16_f32 v219, v166, v167
  v_cvt_pk_bf16_f32 v227, v30, v31
  v_mfma_f32_32x32x16_bf16 v[48:63], v[212:215], v[148:151], 0
  v_mfma_f32_32x32x16_bf16 v[48:63], v[220:223], v[156:159], v[48:63]
  v_mfma_f32_32x32x16_bf16 v[48:63], v[216:219], v[152:155], v[48:63]
  v_mfma_f32_32x32x16_bf16 v[48:63], v[224:227], v[160:163], v[48:63]
  v_permlane16_swap_b32 v32, v40
  v_permlane16_swap_b32 v33, v41
  v_permlane16_swap_b32 v34, v42
  v_permlane16_swap_b32 v35, v43
  v_permlane16_swap_b32 v36, v44
  v_permlane16_swap_b32 v37, v45
  v_permlane16_swap_b32 v38, v46
  v_permlane16_swap_b32 v39, v47
  s_nop 3
  v_permlane16_swap_b32 v48, v56
  v_permlane16_swap_b32 v49, v57
  v_permlane16_swap_b32 v50, v58
  v_permlane16_swap_b32 v51, v59
  v_permlane16_swap_b32 v52, v60
  v_permlane16_swap_b32 v53, v61
  v_permlane16_swap_b32 v54, v62
  v_permlane16_swap_b32 v55, v63
  s_mov_b32 s35, 0xffff0000
  s_mov_b32 s36, 0x00003f80
  s_mov_b32 s37, 0x3f800000
  v_mov_b32 v120, s48
  v_rcp_f32 v122, v120
  v_mov_b32 v124, s49
  v_rcp_f32 v126, v124
  s_waitcnt lgkmcnt(0)
  v_lshlrev_b32 v0, 16, v112
  v_and_b32 v1, s35, v112
  v_lshlrev_b32 v2, 16, v113
  v_and_b32 v3, s35, v113
  v_lshlrev_b32 v4, 16, v114
  v_and_b32 v5, s35, v114
  v_lshlrev_b32 v6, 16, v115
  v_and_b32 v7, s35, v115
  v_lshlrev_b32 v8, 16, v116
  v_and_b32 v9, s35, v116
  v_lshlrev_b32 v10, 16, v117
  v_and_b32 v11, s35, v117
  v_lshlrev_b32 v12, 16, v118
  v_and_b32 v13, s35, v118
  v_lshlrev_b32 v14, 16, v119
  v_and_b32 v15, s35, v119
  v_pk_mul_f32 v[148:149], v[0:1], v[122:123] op_sel_hi:[1,0]
  v_pk_mul_f32 v[32:33], v[32:33], v[120:121] op_sel_hi:[1,0]
  v_pk_mul_f32 v[150:151], v[2:3], v[122:123] op_sel_hi:[1,0]
  v_pk_mul_f32 v[34:35], v[34:35], v[120:121] op_sel_hi:[1,0]
  v_pk_mul_f32 v[152:153], v[4:5], v[122:123] op_sel_hi:[1,0]
  v_pk_mul_f32 v[36:37], v[36:37], v[120:121] op_sel_hi:[1,0]
  v_pk_mul_f32 v[154:155], v[6:7], v[122:123] op_sel_hi:[1,0]
  v_pk_mul_f32 v[38:39], v[38:39], v[120:121] op_sel_hi:[1,0]
  v_pk_mul_f32 v[156:157], v[8:9], v[122:123] op_sel_hi:[1,0]
  v_pk_mul_f32 v[40:41], v[40:41], v[120:121] op_sel_hi:[1,0]
  v_pk_mul_f32 v[158:159], v[10:11], v[122:123] op_sel_hi:[1,0]
  v_pk_mul_f32 v[42:43], v[42:43], v[120:121] op_sel_hi:[1,0]
  v_pk_mul_f32 v[160:161], v[12:13], v[122:123] op_sel_hi:[1,0]
  v_pk_mul_f32 v[44:45], v[44:45], v[120:121] op_sel_hi:[1,0]
  v_pk_mul_f32 v[162:163], v[14:15], v[122:123] op_sel_hi:[1,0]
  v_pk_mul_f32 v[46:47], v[46:47], v[120:121] op_sel_hi:[1,0]
  v_mul_f32 v120, 0xbfb8aa3b, v120
  v_pk_mul_f32 v[164:165], v[0:1], v[126:127] op_sel_hi:[1,0]
  v_pk_mul_f32 v[48:49], v[48:49], v[124:125] op_sel_hi:[1,0]
  v_pk_mul_f32 v[166:167], v[2:3], v[126:127] op_sel_hi:[1,0]
  v_pk_mul_f32 v[50:51], v[50:51], v[124:125] op_sel_hi:[1,0]
  v_pk_mul_f32 v[168:169], v[4:5], v[126:127] op_sel_hi:[1,0]
  v_pk_mul_f32 v[52:53], v[52:53], v[124:125] op_sel_hi:[1,0]
  v_pk_mul_f32 v[170:171], v[6:7], v[126:127] op_sel_hi:[1,0]
  v_pk_mul_f32 v[54:55], v[54:55], v[124:125] op_sel_hi:[1,0]
  v_pk_mul_f32 v[172:173], v[8:9], v[126:127] op_sel_hi:[1,0]
  v_pk_mul_f32 v[56:57], v[56:57], v[124:125] op_sel_hi:[1,0]
  v_pk_mul_f32 v[174:175], v[10:11], v[126:127] op_sel_hi:[1,0]
  v_pk_mul_f32 v[58:59], v[58:59], v[124:125] op_sel_hi:[1,0]
  v_pk_mul_f32 v[176:177], v[12:13], v[126:127] op_sel_hi:[1,0]
  v_pk_mul_f32 v[60:61], v[60:61], v[124:125] op_sel_hi:[1,0]
  v_pk_mul_f32 v[178:179], v[14:15], v[126:127] op_sel_hi:[1,0]
  v_pk_mul_f32 v[62:63], v[62:63], v[124:125] op_sel_hi:[1,0]
  v_mul_f32 v124, 0xbfb8aa3b, v124
  v_lshlrev_b32 v64, 16, v96
  v_and_b32 v65, s35, v96
  v_lshlrev_b32 v66, 16, v97
  v_and_b32 v67, s35, v97
  v_lshlrev_b32 v68, 16, v98
  v_and_b32 v69, s35, v98
  v_lshlrev_b32 v70, 16, v99
  v_and_b32 v71, s35, v99
  v_lshlrev_b32 v72, 16, v100
  v_and_b32 v73, s35, v100
  v_lshlrev_b32 v74, 16, v101
  v_and_b32 v75, s35, v101
  v_lshlrev_b32 v76, 16, v102
  v_and_b32 v77, s35, v102
  v_lshlrev_b32 v78, 16, v103
  v_and_b32 v79, s35, v103
  v_lshlrev_b32 v80, 16, v104
  v_and_b32 v81, s35, v104
  v_lshlrev_b32 v82, 16, v105
  v_and_b32 v83, s35, v105
  v_lshlrev_b32 v84, 16, v106
  v_and_b32 v85, s35, v106
  v_lshlrev_b32 v86, 16, v107
  v_and_b32 v87, s35, v107
  v_lshlrev_b32 v88, 16, v108
  v_and_b32 v89, s35, v108
  v_lshlrev_b32 v90, 16, v109
  v_and_b32 v91, s35, v109
  v_lshlrev_b32 v92, 16, v110
  v_and_b32 v93, s35, v110
  v_lshlrev_b32 v94, 16, v111
  v_and_b32 v95, s35, v111
  s_mov_b32 s33, 0
x_p_16:
  s_waitcnt vmcnt(0)
  v_cmp_gt_u32 vcc, 1, v145
  s_nop 1
  s_mov_b32 s19, vcc_lo
  s_bitcmp1_b32 s18, 0
  s_cbranch_scc1 x_v_20
  s_and_b32 s34, s19, 0xff
  s_cbranch_scc1 x_w_21
  buffer_load_dwordx4 v[228:231], v180, s[56:59], s28 offen offset:0 sc1
  buffer_load_dwordx4 v[232:235], v180, s[56:59], s29 offen offset:0 sc1
  buffer_load_dwordx4 v[236:239], v180, s[56:59], s30 offen offset:0 sc1
  buffer_load_dwordx4 v[240:243], v180, s[56:59], s31 offen offset:0 sc1
  s_bitset1_b32 s18, 0
  s_branch x_w_21
x_v_20:
  s_bitset1_b32 s18, 2
x_w_21:
  s_bitcmp1_b32 s18, 1
  s_cbranch_scc1 x_v_22
  s_and_b32 s34, s19, 0x3f00
  s_cbranch_scc1 x_w_23
  buffer_load_dwordx4 v[244:247], v180, s[56:59], s28 offen offset:1024 sc1
  buffer_load_dwordx4 v[248:251], v180, s[56:59], s29 offen offset:1024 sc1
  buffer_load_dwordx4 v[252:255], v180, s[56:59], s30 offen offset:1024 sc1
  buffer_load_dwordx4 v[184:187], v180, s[56:59], s31 offen offset:1024 sc1
  s_bitset1_b32 s18, 1
  s_branch x_w_23
x_v_22:
  v_max3_u32 v189, v244, v245, v246
  v_max3_u32 v189, v189, v247, v248
  v_max3_u32 v189, v189, v249, v250
  v_max3_u32 v189, v189, v251, v252
  v_max3_u32 v189, v189, v253, v254
  v_max3_u32 v189, v189, v255, v184
  v_max3_u32 v189, v189, v185, v186
  v_max_u32 v189, v189, v187
  v_cmp_eq_u32 s[16:17], -1, v189
  s_bitset1_b32 s18, 3
  s_nop 0
  s_cmp_eq_u64 s[16:17], 0
  s_cbranch_scc1 x_w_23
  s_bitset0_b32 s18, 3
  s_mov_b64 exec, s[16:17]
  buffer_load_dwordx4 v[244:247], v180, s[56:59], s28 offen offset:1024 sc1
  buffer_load_dwordx4 v[248:251], v180, s[56:59], s29 offen offset:1024 sc1
  buffer_load_dwordx4 v[252:255], v180, s[56:59], s30 offen offset:1024 sc1
  buffer_load_dwordx4 v[184:187], v180, s[56:59], s31 offen offset:1024 sc1
  s_mov_b64 exec, -1
x_w_23:
  s_and_b32 s34, s18, 3
  s_cmp_eq_u32 s34, 3
  s_cbranch_scc1 x_g_24
  s_mov_b64 exec, 0xffff
  buffer_load_dword v145, v146, s[56:59], s42 offen sc1
  s_mov_b64 exec, -1
x_g_24:
  s_bitcmp1_b32 s18, 2
  s_cbranch_scc1 x_0_17
  s_bitcmp1_b32 s18, 3
  s_cbranch_scc1 x_1_18
  s_add_u32 s33, s33, 1
  s_cmp_lt_u32 s33, 65536
  s_cbranch_scc1 x_p_16
  s_waitcnt vmcnt(0)
x_0_17:
  s_bitcmp1_b32 s18, 5
  s_cbranch_scc0 x_b_25
  buffer_store_dwordx4 v[244:247], v180, s[24:27], s12 offen offset:1024 sc1
  buffer_store_dwordx4 v[252:255], v180, s[24:27], s13 offen offset:1024 sc1
x_b_25:
  v_dot2_f32_bf16 v148, v228, s36, v148
  v_dot2_f32_bf16 v149, v228, s37, v149
  v_dot2_f32_bf16 v150, v229, s36, v150
  v_dot2_f32_bf16 v151, v229, s37, v151
  v_dot2_f32_bf16 v152, v230, s36, v152
  v_dot2_f32_bf16 v153, v230, s37, v153
  v_dot2_f32_bf16 v154, v231, s36, v154
  v_dot2_f32_bf16 v155, v231, s37, v155
  v_dot2_f32_bf16 v148, v232, s36, v148
  v_dot2_f32_bf16 v149, v232, s37, v149
  v_dot2_f32_bf16 v150, v233, s36, v150
  v_dot2_f32_bf16 v151, v233, s37, v151
  v_dot2_f32_bf16 v152, v234, s36, v152
  v_dot2_f32_bf16 v153, v234, s37, v153
  v_dot2_f32_bf16 v154, v235, s36, v154
  v_dot2_f32_bf16 v155, v235, s37, v155
  v_pk_mul_f32 v[0:1], v[148:149], v[120:121] op_sel_hi:[1,0]
  v_pk_mul_f32 v[2:3], v[150:151], v[120:121] op_sel_hi:[1,0]
  v_pk_mul_f32 v[4:5], v[152:153], v[120:121] op_sel_hi:[1,0]
  v_pk_mul_f32 v[6:7], v[154:155], v[120:121] op_sel_hi:[1,0]
  v_exp_f32 v0, v0
  v_exp_f32 v1, v1
  v_exp_f32 v2, v2
  v_exp_f32 v3, v3
  v_exp_f32 v4, v4
  v_exp_f32 v5, v5
  v_exp_f32 v6, v6
  v_exp_f32 v7, v7
  v_pk_mul_f32 v[32:33], v[32:33], v[148:149]
  v_pk_mul_f32 v[34:35], v[34:35], v[150:151]
  v_pk_mul_f32 v[36:37], v[36:37], v[152:153]
  v_pk_mul_f32 v[38:39], v[38:39], v[154:155]
  v_pk_add_f32 v[0:1], v[0:1], 1.0 op_sel_hi:[1,0]
  v_pk_add_f32 v[2:3], v[2:3], 1.0 op_sel_hi:[1,0]
  v_pk_add_f32 v[4:5], v[4:5], 1.0 op_sel_hi:[1,0]
  v_pk_add_f32 v[6:7], v[6:7], 1.0 op_sel_hi:[1,0]
  v_rcp_f32 v0, v0
  v_rcp_f32 v1, v1
  v_rcp_f32 v2, v2
  v_rcp_f32 v3, v3
  v_rcp_f32 v4, v4
  v_rcp_f32 v5, v5
  v_rcp_f32 v6, v6
  v_rcp_f32 v7, v7
  v_pk_fma_f32 v[64:65], v[0:1], v[32:33], v[64:65]
  v_pk_fma_f32 v[66:67], v[2:3], v[34:35], v[66:67]
  v_pk_fma_f32 v[68:69], v[4:5], v[36:37], v[68:69]
  v_pk_fma_f32 v[70:71], v[6:7], v[38:39], v[70:71]
  v_cvt_pk_bf16_f32 v228, v64, v65
  v_cvt_pk_bf16_f32 v229, v66, v67
  v_cvt_pk_bf16_f32 v230, v68, v69
  v_cvt_pk_bf16_f32 v231, v70, v71
  s_bitcmp1_b32 s18, 5
  s_cbranch_scc0 x_f_27
  buffer_store_dwordx4 v[228:231], v180, s[24:27], s12 offen offset:0 sc1
x_f_27:
  v_dot2_f32_bf16 v164, v236, s36, v164
  v_dot2_f32_bf16 v165, v236, s37, v165
  v_dot2_f32_bf16 v166, v237, s36, v166
  v_dot2_f32_bf16 v167, v237, s37, v167
  v_dot2_f32_bf16 v168, v238, s36, v168
  v_dot2_f32_bf16 v169, v238, s37, v169
  v_dot2_f32_bf16 v170, v239, s36, v170
  v_dot2_f32_bf16 v171, v239, s37, v171
  v_dot2_f32_bf16 v164, v240, s36, v164
  v_dot2_f32_bf16 v165, v240, s37, v165
  v_dot2_f32_bf16 v166, v241, s36, v166
  v_dot2_f32_bf16 v167, v241, s37, v167
  v_dot2_f32_bf16 v168, v242, s36, v168
  v_dot2_f32_bf16 v169, v242, s37, v169
  v_dot2_f32_bf16 v170, v243, s36, v170
  v_dot2_f32_bf16 v171, v243, s37, v171
  v_pk_mul_f32 v[8:9], v[164:165], v[124:125] op_sel_hi:[1,0]
  v_pk_mul_f32 v[10:11], v[166:167], v[124:125] op_sel_hi:[1,0]
  v_pk_mul_f32 v[12:13], v[168:169], v[124:125] op_sel_hi:[1,0]
  v_pk_mul_f32 v[14:15], v[170:171], v[124:125] op_sel_hi:[1,0]
  v_exp_f32 v8, v8
  v_exp_f32 v9, v9
  v_exp_f32 v10, v10
  v_exp_f32 v11, v11
  v_exp_f32 v12, v12
  v_exp_f32 v13, v13
  v_exp_f32 v14, v14
  v_exp_f32 v15, v15
  v_pk_mul_f32 v[48:49], v[48:49], v[164:165]
  v_pk_mul_f32 v[50:51], v[50:51], v[166:167]
  v_pk_mul_f32 v[52:53], v[52:53], v[168:169]
  v_pk_mul_f32 v[54:55], v[54:55], v[170:171]
  v_pk_add_f32 v[8:9], v[8:9], 1.0 op_sel_hi:[1,0]
  v_pk_add_f32 v[10:11], v[10:11], 1.0 op_sel_hi:[1,0]
  v_pk_add_f32 v[12:13], v[12:13], 1.0 op_sel_hi:[1,0]
  v_pk_add_f32 v[14:15], v[14:15], 1.0 op_sel_hi:[1,0]
  v_rcp_f32 v8, v8
  v_rcp_f32 v9, v9
  v_rcp_f32 v10, v10
  v_rcp_f32 v11, v11
  v_rcp_f32 v12, v12
  v_rcp_f32 v13, v13
  v_rcp_f32 v14, v14
  v_rcp_f32 v15, v15
  v_pk_fma_f32 v[80:81], v[8:9], v[48:49], v[80:81]
  v_pk_fma_f32 v[82:83], v[10:11], v[50:51], v[82:83]
  v_pk_fma_f32 v[84:85], v[12:13], v[52:53], v[84:85]
  v_pk_fma_f32 v[86:87], v[14:15], v[54:55], v[86:87]
  v_cvt_pk_bf16_f32 v236, v80, v81
  v_cvt_pk_bf16_f32 v237, v82, v83
  v_cvt_pk_bf16_f32 v238, v84, v85
  v_cvt_pk_bf16_f32 v239, v86, v87
  s_bitcmp1_b32 s18, 5
  s_cbranch_scc0 x_n_28
  buffer_store_dwordx4 v[236:239], v180, s[24:27], s13 offen offset:0 sc1
  s_branch x_d_19
x_n_28:
  s_bitset1_b32 s18, 4
x_c_26:
  s_bitcmp1_b32 s18, 3
  s_cbranch_scc1 x_1_18
  s_waitcnt vmcnt(0)
  s_add_u32 s33, s33, 1
  s_cmp_ge_u32 s33, 65536
  s_cbranch_scc1 x_1_18
  v_cmp_gt_u32 vcc, 1, v145
  s_nop 1
  s_mov_b32 s19, vcc_lo
  s_bitcmp1_b32 s18, 1
  s_cbranch_scc1 x_v_29
  s_and_b32 s34, s19, 0x3f00
  s_cbranch_scc1 x_w_30
  buffer_load_dwordx4 v[244:247], v180, s[56:59], s28 offen offset:1024 sc1
  buffer_load_dwordx4 v[248:251], v180, s[56:59], s29 offen offset:1024 sc1
  buffer_load_dwordx4 v[252:255], v180, s[56:59], s30 offen offset:1024 sc1
  buffer_load_dwordx4 v[184:187], v180, s[56:59], s31 offen offset:1024 sc1
  s_bitset1_b32 s18, 1
  s_branch x_w_30
x_v_29:
  v_max3_u32 v189, v244, v245, v246
  v_max3_u32 v189, v189, v247, v248
  v_max3_u32 v189, v189, v249, v250
  v_max3_u32 v189, v189, v251, v252
  v_max3_u32 v189, v189, v253, v254
  v_max3_u32 v189, v189, v255, v184
  v_max3_u32 v189, v189, v185, v186
  v_max_u32 v189, v189, v187
  v_cmp_eq_u32 s[16:17], -1, v189
  s_bitset1_b32 s18, 3
  s_nop 0
  s_cmp_eq_u64 s[16:17], 0
  s_cbranch_scc1 x_w_30
  s_bitset0_b32 s18, 3
  s_mov_b64 exec, s[16:17]
  buffer_load_dwordx4 v[244:247], v180, s[56:59], s28 offen offset:1024 sc1
  buffer_load_dwordx4 v[248:251], v180, s[56:59], s29 offen offset:1024 sc1
  buffer_load_dwordx4 v[252:255], v180, s[56:59], s30 offen offset:1024 sc1
  buffer_load_dwordx4 v[184:187], v180, s[56:59], s31 offen offset:1024 sc1
  s_mov_b64 exec, -1
x_w_30:
  s_and_b32 s34, s18, 3
  s_cmp_eq_u32 s34, 3
  s_cbranch_scc1 x_g_31
  s_mov_b64 exec, 0xffff
  buffer_load_dword v145, v146, s[56:59], s42 offen sc1
  s_mov_b64 exec, -1
x_g_31:
  s_branch x_c_26
x_1_18:
  s_bitcmp1_b32 s18, 4
  s_cbranch_scc0 x_b_32
  buffer_store_dwordx4 v[228:231], v180, s[24:27], s12 offen offset:0 sc1
  buffer_store_dwordx4 v[236:239], v180, s[24:27], s13 offen offset:0 sc1
x_b_32:
  v_dot2_f32_bf16 v156, v244, s36, v156
  v_dot2_f32_bf16 v157, v244, s37, v157
  v_dot2_f32_bf16 v158, v245, s36, v158
  v_dot2_f32_bf16 v159, v245, s37, v159
  v_dot2_f32_bf16 v160, v246, s36, v160
  v_dot2_f32_bf16 v161, v246, s37, v161
  v_dot2_f32_bf16 v162, v247, s36, v162
  v_dot2_f32_bf16 v163, v247, s37, v163
  v_dot2_f32_bf16 v156, v248, s36, v156
  v_dot2_f32_bf16 v157, v248, s37, v157
  v_dot2_f32_bf16 v158, v249, s36, v158
  v_dot2_f32_bf16 v159, v249, s37, v159
  v_dot2_f32_bf16 v160, v250, s36, v160
  v_dot2_f32_bf16 v161, v250, s37, v161
  v_dot2_f32_bf16 v162, v251, s36, v162
  v_dot2_f32_bf16 v163, v251, s37, v163
  v_pk_mul_f32 v[0:1], v[156:157], v[120:121] op_sel_hi:[1,0]
  v_pk_mul_f32 v[2:3], v[158:159], v[120:121] op_sel_hi:[1,0]
  v_pk_mul_f32 v[4:5], v[160:161], v[120:121] op_sel_hi:[1,0]
  v_pk_mul_f32 v[6:7], v[162:163], v[120:121] op_sel_hi:[1,0]
  v_exp_f32 v0, v0
  v_exp_f32 v1, v1
  v_exp_f32 v2, v2
  v_exp_f32 v3, v3
  v_exp_f32 v4, v4
  v_exp_f32 v5, v5
  v_exp_f32 v6, v6
  v_exp_f32 v7, v7
  v_pk_mul_f32 v[40:41], v[40:41], v[156:157]
  v_pk_mul_f32 v[42:43], v[42:43], v[158:159]
  v_pk_mul_f32 v[44:45], v[44:45], v[160:161]
  v_pk_mul_f32 v[46:47], v[46:47], v[162:163]
  v_pk_add_f32 v[0:1], v[0:1], 1.0 op_sel_hi:[1,0]
  v_pk_add_f32 v[2:3], v[2:3], 1.0 op_sel_hi:[1,0]
  v_pk_add_f32 v[4:5], v[4:5], 1.0 op_sel_hi:[1,0]
  v_pk_add_f32 v[6:7], v[6:7], 1.0 op_sel_hi:[1,0]
  v_rcp_f32 v0, v0
  v_rcp_f32 v1, v1
  v_rcp_f32 v2, v2
  v_rcp_f32 v3, v3
  v_rcp_f32 v4, v4
  v_rcp_f32 v5, v5
  v_rcp_f32 v6, v6
  v_rcp_f32 v7, v7
  v_pk_fma_f32 v[72:73], v[0:1], v[40:41], v[72:73]
  v_pk_fma_f32 v[74:75], v[2:3], v[42:43], v[74:75]
  v_pk_fma_f32 v[76:77], v[4:5], v[44:45], v[76:77]
  v_pk_fma_f32 v[78:79], v[6:7], v[46:47], v[78:79]
  v_cvt_pk_bf16_f32 v244, v72, v73
  v_cvt_pk_bf16_f32 v245, v74, v75
  v_cvt_pk_bf16_f32 v246, v76, v77
  v_cvt_pk_bf16_f32 v247, v78, v79
  s_bitcmp1_b32 s18, 4
  s_cbranch_scc0 x_f_34
  buffer_store_dwordx4 v[244:247], v180, s[24:27], s12 offen offset:1024 sc1
x_f_34:
  v_dot2_f32_bf16 v172, v252, s36, v172
  v_dot2_f32_bf16 v173, v252, s37, v173
  v_dot2_f32_bf16 v174, v253, s36, v174
  v_dot2_f32_bf16 v175, v253, s37, v175
  v_dot2_f32_bf16 v176, v254, s36, v176
  v_dot2_f32_bf16 v177, v254, s37, v177
  v_dot2_f32_bf16 v178, v255, s36, v178
  v_dot2_f32_bf16 v179, v255, s37, v179
  v_dot2_f32_bf16 v172, v184, s36, v172
  v_dot2_f32_bf16 v173, v184, s37, v173
  v_dot2_f32_bf16 v174, v185, s36, v174
  v_dot2_f32_bf16 v175, v185, s37, v175
  v_dot2_f32_bf16 v176, v186, s36, v176
  v_dot2_f32_bf16 v177, v186, s37, v177
  v_dot2_f32_bf16 v178, v187, s36, v178
  v_dot2_f32_bf16 v179, v187, s37, v179
  v_pk_mul_f32 v[8:9], v[172:173], v[124:125] op_sel_hi:[1,0]
  v_pk_mul_f32 v[10:11], v[174:175], v[124:125] op_sel_hi:[1,0]
  v_pk_mul_f32 v[12:13], v[176:177], v[124:125] op_sel_hi:[1,0]
  v_pk_mul_f32 v[14:15], v[178:179], v[124:125] op_sel_hi:[1,0]
  v_exp_f32 v8, v8
  v_exp_f32 v9, v9
  v_exp_f32 v10, v10
  v_exp_f32 v11, v11
  v_exp_f32 v12, v12
  v_exp_f32 v13, v13
  v_exp_f32 v14, v14
  v_exp_f32 v15, v15
  v_pk_mul_f32 v[56:57], v[56:57], v[172:173]
  v_pk_mul_f32 v[58:59], v[58:59], v[174:175]
  v_pk_mul_f32 v[60:61], v[60:61], v[176:177]
  v_pk_mul_f32 v[62:63], v[62:63], v[178:179]
  v_pk_add_f32 v[8:9], v[8:9], 1.0 op_sel_hi:[1,0]
  v_pk_add_f32 v[10:11], v[10:11], 1.0 op_sel_hi:[1,0]
  v_pk_add_f32 v[12:13], v[12:13], 1.0 op_sel_hi:[1,0]
  v_pk_add_f32 v[14:15], v[14:15], 1.0 op_sel_hi:[1,0]
  v_rcp_f32 v8, v8
  v_rcp_f32 v9, v9
  v_rcp_f32 v10, v10
  v_rcp_f32 v11, v11
  v_rcp_f32 v12, v12
  v_rcp_f32 v13, v13
  v_rcp_f32 v14, v14
  v_rcp_f32 v15, v15
  v_pk_fma_f32 v[88:89], v[8:9], v[56:57], v[88:89]
  v_pk_fma_f32 v[90:91], v[10:11], v[58:59], v[90:91]
  v_pk_fma_f32 v[92:93], v[12:13], v[60:61], v[92:93]
  v_pk_fma_f32 v[94:95], v[14:15], v[62:63], v[94:95]
  v_cvt_pk_bf16_f32 v252, v88, v89
  v_cvt_pk_bf16_f32 v253, v90, v91
  v_cvt_pk_bf16_f32 v254, v92, v93
  v_cvt_pk_bf16_f32 v255, v94, v95
  s_bitcmp1_b32 s18, 4
  s_cbranch_scc0 x_n_35
  buffer_store_dwordx4 v[252:255], v180, s[24:27], s13 offen offset:1024 sc1
  s_branch x_d_19
x_n_35:
  s_bitset1_b32 s18, 5
x_c_33:
  s_bitcmp1_b32 s18, 2
  s_cbranch_scc1 x_0_17
  s_waitcnt vmcnt(0)
  s_add_u32 s33, s33, 1
  s_cmp_ge_u32 s33, 65536
  s_cbranch_scc1 x_0_17
  v_cmp_gt_u32 vcc, 1, v145
  s_nop 1
  s_mov_b32 s19, vcc_lo
  s_bitcmp1_b32 s18, 0
  s_cbranch_scc1 x_v_36
  s_and_b32 s34, s19, 0xff
  s_cbranch_scc1 x_w_37
  buffer_load_dwordx4 v[228:231], v180, s[56:59], s28 offen offset:0 sc1
  buffer_load_dwordx4 v[232:235], v180, s[56:59], s29 offen offset:0 sc1
  buffer_load_dwordx4 v[236:239], v180, s[56:59], s30 offen offset:0 sc1
  buffer_load_dwordx4 v[240:243], v180, s[56:59], s31 offen offset:0 sc1
  s_bitset1_b32 s18, 0
  s_branch x_w_37
x_v_36:
  s_bitset1_b32 s18, 2
x_w_37:
  s_and_b32 s34, s18, 3
  s_cmp_eq_u32 s34, 3
  s_cbranch_scc1 x_g_38
  s_mov_b64 exec, 0xffff
  buffer_load_dword v145, v146, s[56:59], s42 offen sc1
  s_mov_b64 exec, -1
x_g_38:
  s_branch x_c_33
x_d_19:
  s_endpgm
f_hi:
  s_cmp_lg_u32 s47, 0
  s_cbranch_scc1 f_midhi
  s_sub_u32 s5, s5, 4
  v_lshlrev_b32 v1, 4, v0
  s_cmp_eq_u32 s5, 3
  s_cbranch_scc1 g1_misc_39
  s_cmp_lg_u32 s5, 0
  s_cbranch_scc1 g1l_b_40
  v_lshrrev_b32 v20, 3, v0
  v_lshlrev_b32 v21, 19, v20
  v_and_b32 v22, 7, v0
  v_lshrrev_b32 v23, 4, v0
  s_lshl_b32 s28, s3, 15
  v_add_u32 v21, s28, v21
  v_or_b32 v24, 0, v23
  v_xor_b32 v24, v24, v22
  v_lshl_add_u32 v24, v24, 4, v21
  v_add_u32 v2, 0, v24
  v_add_u32 v4, 2048, v24
  v_add_u32 v6, 8192, v24
  v_add_u32 v8, 10240, v24
  v_or_b32 v24, 4, v23
  v_xor_b32 v24, v24, v22
  v_lshl_add_u32 v24, v24, 4, v21
  v_add_u32 v3, 1024, v24
  v_add_u32 v5, 3072, v24
  v_add_u32 v7, 9216, v24
  v_add_u32 v9, 11264, v24
  s_mov_b32 s6, 0
  s_movk_i32 s7, 16384
  s_movk_i32 s12, 128
  s_movk_i32 s13, 16384
  s_waitcnt lgkmcnt(0)
  s_mov_b32 s8, s60
  s_and_b32 s9, s61, 0xffff
  s_mov_b32 s10, 0x400000
  s_mov_b32 s11, 0x20000
  s_branch g1l_e_41
g1l_b_40:
  v_lshrrev_b32 v25, 5, v0
  v_and_b32 v26, 31, v0
  s_sub_u32 s29, s5, 1
  s_mul_i32 s28, s29, 229376
  s_lshl_b32 s6, s29, 14
  s_add_u32 s6, s6, 49152
  s_lshl_b32 s29, s4, 9
  s_add_u32 s28, s28, s29
  v_mul_u32_u24 v27, 7168, v25
  v_add_u32 v27, s28, v27
  v_or_b32 v28, 0, v25
  v_lshlrev_b32 v28, 1, v28
  v_xor_b32 v28, v28, v26
  v_lshl_add_u32 v28, v28, 4, v27
  v_add_u32 v2, 0, v28
  v_add_u32 v4, 26624, v28
  v_or_b32 v28, 2, v25
  v_lshlrev_b32 v28, 1, v28
  v_xor_b32 v28, v28, v26
  v_lshl_add_u32 v28, v28, 4, v27
  v_add_u32 v3, 13312, v28
  v_add_u32 v5, 39936, v28
  v_or_b32 v28, 4, v25
  v_lshlrev_b32 v28, 1, v28
  v_xor_b32 v28, v28, v26
  v_lshl_add_u32 v28, v28, 4, v27
  v_add_u32 v6, 57344, v28
  v_add_u32 v8, 83968, v28
  v_or_b32 v28, 6, v25
  v_lshlrev_b32 v28, 1, v28
  v_xor_b32 v28, v28, v26
  v_lshl_add_u32 v28, v28, 4, v27
  v_add_u32 v7, 70656, v28
  v_add_u32 v9, 97280, v28
  s_mov_b32 s7, 32768
  s_mov_b32 s12, 458752
  s_mov_b32 s13, 114688
  s_waitcnt lgkmcnt(0)
  s_mov_b32 s8, s68
  s_and_b32 s9, s69, 0xffff
  s_mov_b32 s10, 0x700000
  s_mov_b32 s11, 0x20000
g1l_e_41:
  s_and_b32 s14, s3, 12
  s_and_b32 s16, s3, 3
  s_mov_b32 s15, s6
  s_mul_i32 s31, s7, 3
  s_add_u32 s31, s31, s6
  s_xor_b32 s28, s14, s16
  s_mul_i32 s28, s28, s12
  s_add_u32 s29, s28, s13
  s_add_u32 m0, s15, 0
  s_nop 0
  buffer_load_dwordx4 v2, s[8:11], s28 offen offset:0 lds
  buffer_load_dwordx4 v3, s[8:11], s28 offen offset:1024 lds
  buffer_load_dwordx4 v4, s[8:11], s28 offen offset:2048 lds
  buffer_load_dwordx4 v5, s[8:11], s28 offen offset:3072 lds
  s_add_u32 m0, s15, 4096
  s_nop 0
  buffer_load_dwordx4 v6, s[8:11], s28 offen offset:0 lds
  buffer_load_dwordx4 v7, s[8:11], s28 offen offset:1024 lds
  buffer_load_dwordx4 v8, s[8:11], s28 offen offset:2048 lds
  buffer_load_dwordx4 v9, s[8:11], s28 offen offset:3072 lds
  s_add_u32 m0, s15, 8192
  s_nop 0
  buffer_load_dwordx4 v2, s[8:11], s29 offen offset:0 lds
  buffer_load_dwordx4 v3, s[8:11], s29 offen offset:1024 lds
  buffer_load_dwordx4 v4, s[8:11], s29 offen offset:2048 lds
  buffer_load_dwordx4 v5, s[8:11], s29 offen offset:3072 lds
  s_add_u32 m0, s15, 12288
  s_nop 0
  buffer_load_dwordx4 v6, s[8:11], s29 offen offset:0 lds
  buffer_load_dwordx4 v7, s[8:11], s29 offen offset:1024 lds
  buffer_load_dwordx4 v8, s[8:11], s29 offen offset:2048 lds
  buffer_load_dwordx4 v9, s[8:11], s29 offen offset:3072 lds
  s_add_u32 s14, s14, 1
  s_and_b32 s14, s14, 15
  s_add_u32 s15, s15, s7
  s_cmp_eq_u32 s15, s31
  s_cselect_b32 s15, s6, s15
  s_xor_b32 s28, s14, s16
  s_mul_i32 s28, s28, s12
  s_add_u32 s29, s28, s13
  s_add_u32 m0, s15, 0
  s_nop 0
  buffer_load_dwordx4 v2, s[8:11], s28 offen offset:0 lds
  buffer_load_dwordx4 v3, s[8:11], s28 offen offset:1024 lds
  buffer_load_dwordx4 v4, s[8:11], s28 offen offset:2048 lds
  buffer_load_dwordx4 v5, s[8:11], s28 offen offset:3072 lds
  s_barrier
  s_add_u32 m0, s15, 4096
  s_nop 0
  buffer_load_dwordx4 v6, s[8:11], s28 offen offset:0 lds
  buffer_load_dwordx4 v7, s[8:11], s28 offen offset:1024 lds
  buffer_load_dwordx4 v8, s[8:11], s28 offen offset:2048 lds
  buffer_load_dwordx4 v9, s[8:11], s28 offen offset:3072 lds
  s_add_u32 m0, s15, 8192
  s_nop 0
  buffer_load_dwordx4 v2, s[8:11], s29 offen offset:0 lds
  buffer_load_dwordx4 v3, s[8:11], s29 offen offset:1024 lds
  buffer_load_dwordx4 v4, s[8:11], s29 offen offset:2048 lds
  buffer_load_dwordx4 v5, s[8:11], s29 offen offset:3072 lds
  s_add_u32 m0, s15, 12288
  s_nop 0
  buffer_load_dwordx4 v6, s[8:11], s29 offen offset:0 lds
  buffer_load_dwordx4 v7, s[8:11], s29 offen offset:1024 lds
  buffer_load_dwordx4 v8, s[8:11], s29 offen offset:2048 lds
  buffer_load_dwordx4 v9, s[8:11], s29 offen offset:3072 lds
  s_add_u32 s14, s14, 1
  s_and_b32 s14, s14, 15
  s_add_u32 s15, s15, s7
  s_cmp_eq_u32 s15, s31
  s_cselect_b32 s15, s6, s15
  s_mov_b32 s56, s50
  s_and_b32 s57, s51, 0xffff
  s_mov_b32 s58, 0x3800000
  s_mov_b32 s59, 0x20000
  s_mov_b32 s30, 0
  s_waitcnt vmcnt(16)
g1l_loop_42:
  s_barrier
  s_xor_b32 s28, s14, s16
  s_mul_i32 s28, s28, s12
  s_add_u32 s29, s28, s13
  s_add_u32 m0, s15, 0
  s_nop 0
  buffer_load_dwordx4 v2, s[8:11], s28 offen offset:0 lds
  buffer_load_dwordx4 v3, s[8:11], s28 offen offset:1024 lds
  buffer_load_dwordx4 v4, s[8:11], s28 offen offset:2048 lds
  buffer_load_dwordx4 v5, s[8:11], s28 offen offset:3072 lds
  s_add_u32 m0, s15, 4096
  s_nop 0
  buffer_load_dwordx4 v6, s[8:11], s28 offen offset:0 lds
  buffer_load_dwordx4 v7, s[8:11], s28 offen offset:1024 lds
  buffer_load_dwordx4 v8, s[8:11], s28 offen offset:2048 lds
  buffer_load_dwordx4 v9, s[8:11], s28 offen offset:3072 lds
  s_add_u32 m0, s15, 8192
  s_nop 0
  buffer_load_dwordx4 v2, s[8:11], s29 offen offset:0 lds
  buffer_load_dwordx4 v3, s[8:11], s29 offen offset:1024 lds
  buffer_load_dwordx4 v4, s[8:11], s29 offen offset:2048 lds
  buffer_load_dwordx4 v5, s[8:11], s29 offen offset:3072 lds
  s_add_u32 m0, s15, 12288
  s_nop 0
  buffer_load_dwordx4 v6, s[8:11], s29 offen offset:0 lds
  buffer_load_dwordx4 v7, s[8:11], s29 offen offset:1024 lds
  buffer_load_dwordx4 v8, s[8:11], s29 offen offset:2048 lds
  buffer_load_dwordx4 v9, s[8:11], s29 offen offset:3072 lds
  s_add_u32 s14, s14, 1
  s_and_b32 s14, s14, 15
  s_add_u32 s15, s15, s7
  s_cmp_eq_u32 s15, s31
  s_cselect_b32 s15, s6, s15
  s_add_u32 s30, s30, 1
  s_cmp_lt_u32 s30, 14
  s_waitcnt vmcnt(16)
  s_cbranch_scc1 g1l_loop_42
  s_cmp_lg_u32 s5, 0
  s_cbranch_scc1 f_hst
  s_and_b32 s32, s3, 3
  s_mul_i32 s32, s32, 2
  s_cmp_eq_u32 s32, s46
  s_addc_u32 s32, s32, 0
  s_cmp_ge_u32 s32, 7
  s_cselect_b32 s32, 0, s32
  s_mov_b32 s38, s32
  s_mov_b32 s33, 0
  s_mov_b32 s34, 0
  s_mov_b32 s30, 0
  s_mov_b32 s16, s56
  s_mov_b32 s17, s57
  s_mov_b32 s18, s58
  s_mov_b32 s19, 0x20000
  s_mov_b32 s39, 8192
  s_mul_i32 s28, s3, 917504
  s_lshl_b32 s29, s44, 16
  s_add_u32 s28, s28, s29
  s_add_u32 s28, s28, 16777216
  v_add_u32 v40, s28, v1
  v_add_u32 v41, 0, v40
  v_add_u32 v42, 0, v40
  v_add_u32 v43, 0, v40
  v_add_u32 v44, 4096, v40
  v_add_u32 v45, 4096, v40
  v_add_u32 v46, 4096, v40
  v_add_u32 v47, 4096, v40
  s_barrier
  s_waitcnt vmcnt(0)
  s_barrier
  s_branch f_tail0
g1_misc_39:
  s_waitcnt lgkmcnt(0)
  s_mov_b32 s56, s50
  s_and_b32 s57, s51, 0xffff
  s_mov_b32 s58, 0x3800000
  s_mov_b32 s59, 0x20000
  s_mov_b32 s8, s62
  s_and_b32 s9, s63, 0xffff
  s_mov_b32 s10, 0x201000
  s_mov_b32 s11, 0x20000
  s_mov_b32 s12, s64
  s_and_b32 s13, s65, 0xffff
  s_mov_b32 s14, 0x201000
  s_mov_b32 s15, 0x20000
  s_mul_i32 s28, s2, 8208
  v_bfe_u32 v33, v0, 1, 3
  v_and_b32 v34, 16, v0
  v_add_u32 v33, v33, v34
  v_mul_u32_u24 v33, 1026, v33
  v_and_b32 v34, 1, v0
  v_lshl_add_u32 v33, v34, 10, v33
  s_and_b32 s29, s2, 15
  s_cmp_ge_u32 s29, 12
  s_cselect_b32 s31, -1, 0xffff
  s_mov_b32 exec_hi, 0
  s_mov_b32 exec_lo, s31
  buffer_load_ushort v34, v33, s[8:11], s28 offen
  buffer_load_ushort v35, v33, s[12:15], s28 offen
  s_mov_b64 exec, -1
  s_and_b32 s28, s3, 3
  s_mul_i32 s28, s28, 7
  s_add_u32 s28, s28, s45
  s_mul_i32 s28, s28, 92
  s_lshr_b32 s29, s3, 2
  s_sub_u32 s30, 8, s29
  s_cmp_eq_u32 s29, 0
  s_cselect_b32 s30, 4, s30
  s_sub_u32 s30, s30, s29
  s_mul_i32 s30, s30, 1026
  s_mul_i32 s29, s29, 1026
  s_lshl_b32 s32, s44, 9
  s_add_u32 s29, s29, s32
  v_add_u32 v20, s28, v0
  v_mul_u32_u24 v21, 52429, v20
  v_lshrrev_b32 v21, 18, v21
  v_mul_u32_u24 v22, 5, v21
  v_sub_u32 v20, v20, v22
  v_and_b32 v22, 255, v21
  v_mul_u32_u24 v22, 8208, v22
  v_lshl_add_u32 v22, v20, 7, v22
  v_lshrrev_b32 v21, 8, v21
  v_mul_lo_u32 v21, v21, s30
  v_add3_u32 v24, v21, v22, s29
  v_and_b32 v24, -4, v24
  v_add_u32 v20, s28, v0
  v_add_u32 v20, 64, v20
  v_mul_u32_u24 v21, 52429, v20
  v_lshrrev_b32 v21, 18, v21
  v_mul_u32_u24 v22, 5, v21
  v_sub_u32 v20, v20, v22
  v_and_b32 v22, 255, v21
  v_mul_u32_u24 v22, 8208, v22
  v_lshl_add_u32 v22, v20, 7, v22
  v_lshrrev_b32 v21, 8, v21
  v_mul_lo_u32 v21, v21, s30
  v_add3_u32 v25, v21, v22, s29
  v_and_b32 v25, -4, v25
  buffer_load_dword v22, v24, s[8:11], 0 offen
  buffer_load_dword v22, v24, s[12:15], 0 offen
  s_mov_b64 exec, 0xfffffff
  buffer_load_dword v22, v25, s[8:11], 0 offen
  buffer_load_dword v22, v25, s[12:15], 0 offen
  s_mov_b64 exec, -1
  s_mov_b32 s20, s68
  s_and_b32 s21, s69, 0xffff
  s_mov_b32 s22, 0x700000
  s_mov_b32 s23, 0x20000
  v_lshrrev_b32 v19, 2, v0
  s_and_b32 s28, s3, 3
  s_lshl_b32 s28, s28, 4
  v_add_u32 v19, s28, v19
  v_mul_u32_u24 v19, 7168, v19
  v_and_b32 v21, 3, v0
  v_lshl_add_u32 v19, v21, 7, v19
  s_lshl_b32 s28, s4, 9
  v_add_u32 v19, s28, v19
  s_and_b32 s6, s3, 12
  s_barrier
  s_waitcnt vmcnt(4)
  v_bfe_u32 v32, v0, 1, 3
  v_lshlrev_b32 v32, 11, v32
  v_and_b32 v33, 1, v0
  v_lshl_add_u32 v32, v33, 2, v32
  v_and_b32 v33, 16, v0
  v_add_u32 v32, v32, v33
  s_lshl_b32 s28, s2, 3
  s_add_u32 s28, s28, 34668544
  v_lshl_or_b32 v34, v35, 16, v34
  s_mov_b32 exec_hi, 0
  s_mov_b32 exec_lo, s31
  buffer_store_dword v34, v32, s[56:59], s28 offen sc1
  s_mov_b64 exec, -1
  v_mov_b32 v16, 0
  global_load_dword v17, v16, s[54:55] sc1
  s_barrier
  s_barrier
  s_mov_b32 s40, 0
  s_waitcnt vmcnt(0)
boot_43:
  v_readfirstlane_b32 s41, v17
  s_nop 1
  s_cmp_ge_u32 s41, 31
  s_cbranch_scc1 booted_44
  global_load_dword v17, v16, s[54:55] sc1
  s_add_u32 s40, s40, 1
  s_cmp_lt_u32 s40, 65536
  s_waitcnt vmcnt(0)
  s_cbranch_scc1 boot_43
booted_44:
  s_lshl_b32 s42, s3, 7
  s_add_u32 s42, s42, 33554432
  v_mov_b32 v20, 1
  s_mov_b64 exec, 1
  buffer_atomic_add v20, off, s[56:59], s42 sc1
  s_mov_b64 exec, -1
  v_lshlrev_b32 v16, 2, v0
  v_add_u32 v17, 151552, v16
  ds_read_b32 v24, v17 offset:0
  ds_read_b32 v25, v17 offset:256
  ds_read_b32 v26, v17 offset:512
  ds_read_b32 v27, v17 offset:768
  s_lshl_b32 s28, s4, 10
  s_add_u32 s28, s28, 33603584
  s_waitcnt lgkmcnt(0)
  buffer_atomic_add_f32 v24, v16, s[56:59], s28 offen offset:0 sc1
  buffer_atomic_add_f32 v25, v16, s[56:59], s28 offen offset:256 sc1
  buffer_atomic_add_f32 v26, v16, s[56:59], s28 offen offset:512 sc1
  buffer_atomic_add_f32 v27, v16, s[56:59], s28 offen offset:768 sc1
  s_barrier
  s_barrier
  s_barrier
  s_barrier
  s_barrier
  s_waitcnt vmcnt(0)
  s_lshl_b32 s42, s4, 7
  s_add_u32 s42, s42, 33566720
  v_mov_b32 v20, 1
  s_mov_b64 exec, 1
  buffer_atomic_add v20, off, s[56:59], s42 sc1
  s_mov_b64 exec, -1
  s_barrier
  s_barrier
  s_barrier
  s_lshl_b32 s41, s4, 7
  s_add_u32 s41, s41, 33566720
  s_lshl_b32 s42, s3, 7
  s_add_u32 s42, s42, 33554432
  v_mov_b32 v16, s42
  v_writelane_b32 v16, s41, 1
  buffer_load_dword v17, v16, s[56:59], 0 offen sc1
  s_barrier
  s_getpc_b64 s[26:27]
pc_45:
  s_add_u32 s26, s26, f_epi-pc_45
  s_addc_u32 s27, s27, -1
  s_and_b32 s28, s3, 3
  s_mul_i32 s28, s28, 7
  s_add_u32 s28, s28, s45
  s_mul_i32 s28, s28, 10
  v_add_lshl_u32 v21, v0, s28, 7
  v_min_u32 v21, f_midlo-f_epi, v21
  s_mov_b64 exec, 0x3ff
  global_load_dword v21, v21, s[26:27]
  s_mov_b64 exec, -1
  s_barrier
  s_waitcnt vmcnt(1)
  s_mov_b32 s40, 0
  s_branch spinc_48
spin_46:
  buffer_load_dword v17, v16, s[56:59], 0 offen sc1
  s_waitcnt vmcnt(0)
spinc_48:
  v_cmp_gt_u32 vcc, 16, v17
  s_nop 1
  s_and_b32 s41, vcc_lo, 0x3
  s_cbranch_scc0 spun_47
  s_add_u32 s40, s40, 1
  s_cmp_lt_u32 s40, 65536
  s_cbranch_scc1 spin_46
spun_47:
  s_lshl_b32 s28, s4, 10
  s_add_u32 s28, s28, 33603584
  buffer_load_dwordx4 v[64:67], v1, s[56:59], s28 offen sc1
  s_add_u32 s28, s28, 14336
  s_mov_b32 s12, s70
  s_and_b32 s13, s71, 0xffff
  s_mov_b32 s14, 0x1c00
  s_mov_b32 s15, 0x20000
  v_lshlrev_b32 v20, 3, v0
  s_lshl_b32 s28, s4, 9
  buffer_load_dwordx2 v[128:129], v20, s[12:15], s28 offen
  s_lshl_b32 s28, s3, 10
  s_add_u32 s28, s28, 34603008
  buffer_load_dwordx4 v[132:135], v1, s[56:59], s28 offen sc1
  s_and_b32 s32, s3, 3
  s_mul_i32 s32, s32, 2
  s_cmp_eq_u32 s32, s46
  s_addc_u32 s32, s32, 0
  s_cmp_ge_u32 s32, 7
  s_cselect_b32 s32, 0, s32
  s_mov_b32 s38, s32
  s_mov_b32 s33, 0
  s_mov_b32 s34, 0
  s_mov_b32 s30, 81920
  s_mov_b32 s39, 131072
  s_mov_b32 s16, s72
  s_and_b32 s17, s73, 0xffff
  s_mov_b32 s18, 0x700000
  s_mov_b32 s19, 0x20000
  s_lshl_b32 s28, s45, 8
  s_lshl_b32 s36, s46, 20
  s_lshl_b32 s29, s44, 19
  s_add_u32 s28, s28, s29
  v_lshrrev_b32 v48, 4, v0
  v_and_b32 v49, 15, v0
  v_lshl_add_u32 v50, v48, 1, 0
  v_xor_b32 v50, v50, v49
  v_lshlrev_b32 v50, 4, v50
  v_lshl_add_u32 v50, v48, 11, v50
  v_add_u32 v50, s28, v50
  v_add_u32 v40, 0, v50
  v_add_u32 v42, 14336, v50
  v_add_u32 v44, 32768, v50
  v_add_u32 v46, 47104, v50
  v_lshl_add_u32 v50, v48, 1, 8
  v_xor_b32 v50, v50, v49
  v_lshlrev_b32 v50, 4, v50
  v_lshl_add_u32 v50, v48, 11, v50
  v_add_u32 v50, s28, v50
  v_add_u32 v41, 7168, v50
  v_add_u32 v43, 21504, v50
  v_add_u32 v45, 39936, v50
  v_add_u32 v47, 54272, v50
  s_barrier
  s_barrier
  s_waitcnt vmcnt(0)
  v_cvt_pk_bf16_f32 v68, v64, v64
  v_cvt_pk_bf16_f32 v69, v65, v65
  v_cvt_pk_bf16_f32 v70, v66, v66
  v_cvt_pk_bf16_f32 v71, v67, v67
  v_and_b32 v72, 0xffff0000, v68
  v_sub_f32 v64, v64, v72
  v_cvt_pk_bf16_f32 v73, v64, 0
  v_mov_b32 v136, 0xffff
  v_alignbit_b32 v72, v128, v68, 16
  v_and_b32 v74, 0xffff0000, v69
  v_sub_f32 v65, v65, v74
  v_cvt_pk_bf16_f32 v75, v65, 0
  v_bfi_b32 v74, v136, v69, v128
  v_and_b32 v76, 0xffff0000, v70
  v_sub_f32 v66, v66, v76
  v_cvt_pk_bf16_f32 v77, v66, 0
  v_alignbit_b32 v76, v129, v70, 16
  v_and_b32 v78, 0xffff0000, v71
  v_sub_f32 v67, v67, v78
  v_cvt_pk_bf16_f32 v79, v67, 0
  v_bfi_b32 v78, v136, v71, v129
  v_lshlrev_b32 v20, 5, v0
  v_add_u32 v20, 151552, v20
  v_mov_b32 v133, v132
  v_mov_b32 v135, v134
  v_add_u32 v137, 153600, v1
  v_mov_b32 v64, 0
  v_mov_b32 v65, 0
  v_mov_b32 v66, 0
  v_mov_b32 v67, 0
  v_mov_b32 v138, v20
  ds_write_b128 v138, v[72:75]
  s_barrier
  ds_write_b128 v138, v[76:79] offset:16
  ds_write_b128 v137, v[132:135]
  ds_write_b128 v137, v[64:67] offset:1024
  s_add_u32 s28, s36, 0
  s_mov_b32 s35, 81920
  s_add_u32 s29, s28, s39
  s_add_u32 m0, s35, 0
  s_nop 0
  buffer_load_dwordx4 v40, s[16:19], s28 offen offset:0 sc1 lds
  buffer_load_dwordx4 v41, s[16:19], s28 offen offset:1024 sc1 lds
  buffer_load_dwordx4 v42, s[16:19], s28 offen offset:2048 sc1 lds
  buffer_load_dwordx4 v43, s[16:19], s28 offen offset:3072 sc1 lds
  s_add_u32 m0, s35, 4096
  s_nop 0
  buffer_load_dwordx4 v44, s[16:19], s28 offen offset:0 sc1 lds
  buffer_load_dwordx4 v45, s[16:19], s28 offen offset:1024 sc1 lds
  buffer_load_dwordx4 v46, s[16:19], s28 offen offset:2048 sc1 lds
  buffer_load_dwordx4 v47, s[16:19], s28 offen offset:3072 sc1 lds
  s_add_u32 m0, s35, 8192
  s_nop 0
  buffer_load_dwordx4 v40, s[16:19], s29 offen offset:0 sc1 lds
  buffer_load_dwordx4 v41, s[16:19], s29 offen offset:1024 sc1 lds
  buffer_load_dwordx4 v42, s[16:19], s29 offen offset:2048 sc1 lds
  buffer_load_dwordx4 v43, s[16:19], s29 offen offset:3072 sc1 lds
  s_add_u32 m0, s35, 12288
  s_nop 0
  buffer_load_dwordx4 v44, s[16:19], s29 offen offset:0 sc1 lds
  buffer_load_dwordx4 v45, s[16:19], s29 offen offset:1024 sc1 lds
  buffer_load_dwordx4 v46, s[16:19], s29 offen offset:2048 sc1 lds
  buffer_load_dwordx4 v47, s[16:19], s29 offen offset:3072 sc1 lds
  s_add_u32 s28, s36, 262144
  s_mov_b32 s35, 98304
  s_add_u32 s29, s28, s39
  s_add_u32 m0, s35, 0
  s_nop 0
  buffer_load_dwordx4 v40, s[16:19], s28 offen offset:0 sc1 lds
  buffer_load_dwordx4 v41, s[16:19], s28 offen offset:1024 sc1 lds
  buffer_load_dwordx4 v42, s[16:19], s28 offen offset:2048 sc1 lds
  buffer_load_dwordx4 v43, s[16:19], s28 offen offset:3072 sc1 lds
  s_add_u32 m0, s35, 4096
  s_nop 0
  buffer_load_dwordx4 v44, s[16:19], s28 offen offset:0 sc1 lds
  buffer_load_dwordx4 v45, s[16:19], s28 offen offset:1024 sc1 lds
  buffer_load_dwordx4 v46, s[16:19], s28 offen offset:2048 sc1 lds
  buffer_load_dwordx4 v47, s[16:19], s28 offen offset:3072 sc1 lds
  s_add_u32 m0, s35, 8192
  s_nop 0
  buffer_load_dwordx4 v40, s[16:19], s29 offen offset:0 sc1 lds
  buffer_load_dwordx4 v41, s[16:19], s29 offen offset:1024 sc1 lds
  buffer_load_dwordx4 v42, s[16:19], s29 offen offset:2048 sc1 lds
  buffer_load_dwordx4 v43, s[16:19], s29 offen offset:3072 sc1 lds
  s_add_u32 m0, s35, 12288
  s_nop 0
  buffer_load_dwordx4 v44, s[16:19], s29 offen offset:0 sc1 lds
  buffer_load_dwordx4 v45, s[16:19], s29 offen offset:1024 sc1 lds
  buffer_load_dwordx4 v46, s[16:19], s29 offen offset:2048 sc1 lds
  buffer_load_dwordx4 v47, s[16:19], s29 offen offset:3072 sc1 lds
  s_barrier
  s_waitcnt lgkmcnt(0)
  s_barrier
  s_add_u32 s28, s36, 65536
  s_mov_b32 s35, 114688
  s_add_u32 s29, s28, s39
  s_add_u32 m0, s35, 0
  s_nop 0
  buffer_load_dwordx4 v40, s[16:19], s28 offen offset:0 sc1 lds
  buffer_load_dwordx4 v41, s[16:19], s28 offen offset:1024 sc1 lds
  buffer_load_dwordx4 v42, s[16:19], s28 offen offset:2048 sc1 lds
  buffer_load_dwordx4 v43, s[16:19], s28 offen offset:3072 sc1 lds
  s_add_u32 m0, s35, 4096
  s_nop 0
  buffer_load_dwordx4 v44, s[16:19], s28 offen offset:0 sc1 lds
  buffer_load_dwordx4 v45, s[16:19], s28 offen offset:1024 sc1 lds
  buffer_load_dwordx4 v46, s[16:19], s28 offen offset:2048 sc1 lds
  buffer_load_dwordx4 v47, s[16:19], s28 offen offset:3072 sc1 lds
  s_add_u32 m0, s35, 8192
  s_nop 0
  buffer_load_dwordx4 v40, s[16:19], s29 offen offset:0 sc1 lds
  buffer_load_dwordx4 v41, s[16:19], s29 offen offset:1024 sc1 lds
  buffer_load_dwordx4 v42, s[16:19], s29 offen offset:2048 sc1 lds
  buffer_load_dwordx4 v43, s[16:19], s29 offen offset:3072 sc1 lds
  s_add_u32 m0, s35, 12288
  s_nop 0
  buffer_load_dwordx4 v44, s[16:19], s29 offen offset:0 sc1 lds
  buffer_load_dwordx4 v45, s[16:19], s29 offen offset:1024 sc1 lds
  buffer_load_dwordx4 v46, s[16:19], s29 offen offset:2048 sc1 lds
  buffer_load_dwordx4 v47, s[16:19], s29 offen offset:3072 sc1 lds
  s_barrier
  s_waitcnt vmcnt(47)
  s_add_u32 s28, s36, 327680
  s_mov_b32 s35, 131072
  s_add_u32 s29, s28, s39
  s_add_u32 m0, s35, 0
  s_nop 0
  buffer_load_dwordx4 v40, s[16:19], s28 offen offset:0 sc1 lds
  buffer_load_dwordx4 v41, s[16:19], s28 offen offset:1024 sc1 lds
  buffer_load_dwordx4 v42, s[16:19], s28 offen offset:2048 sc1 lds
  buffer_load_dwordx4 v43, s[16:19], s28 offen offset:3072 sc1 lds
  s_add_u32 m0, s35, 4096
  s_nop 0
  buffer_load_dwordx4 v44, s[16:19], s28 offen offset:0 sc1 lds
  buffer_load_dwordx4 v45, s[16:19], s28 offen offset:1024 sc1 lds
  buffer_load_dwordx4 v46, s[16:19], s28 offen offset:2048 sc1 lds
  buffer_load_dwordx4 v47, s[16:19], s28 offen offset:3072 sc1 lds
  s_add_u32 m0, s35, 8192
  s_nop 0
  buffer_load_dwordx4 v40, s[16:19], s29 offen offset:0 sc1 lds
  buffer_load_dwordx4 v41, s[16:19], s29 offen offset:1024 sc1 lds
  buffer_load_dwordx4 v42, s[16:19], s29 offen offset:2048 sc1 lds
  buffer_load_dwordx4 v43, s[16:19], s29 offen offset:3072 sc1 lds
  s_add_u32 m0, s35, 12288
  s_nop 0
  buffer_load_dwordx4 v44, s[16:19], s29 offen offset:0 sc1 lds
  buffer_load_dwordx4 v45, s[16:19], s29 offen offset:1024 sc1 lds
  buffer_load_dwordx4 v46, s[16:19], s29 offen offset:2048 sc1 lds
  buffer_load_dwordx4 v47, s[16:19], s29 offen offset:3072 sc1 lds
f_w2go:
  v_add_u32 v56, 131072, v40
  v_add_u32 v57, 131072, v41
  v_add_u32 v58, 131072, v42
  v_add_u32 v59, 131072, v43
  v_add_u32 v60, 131072, v44
  v_add_u32 v61, 131072, v45
  v_add_u32 v62, 131072, v46
  v_add_u32 v63, 131072, v47
  s_lshl_b32 s28, s32, 20
  s_lshr_b32 s29, s33, 1
  s_lshl_b32 s29, s29, 16
  s_add_u32 s28, s28, s29
  s_and_b32 s29, s33, 1
  s_lshl_b32 s29, s29, 18
  s_add_u32 s28, s28, s29
  s_add_u32 s35, s30, s34
  s_mov_b32 m0, s35
  s_mov_b32 s31, 0
  s_waitcnt vmcnt(48)
  s_barrier
  s_waitcnt vmcnt(32)
  s_barrier
w2_loop_49:
  buffer_load_dwordx4 v40, s[16:19], s28 offen offset:0 sc1 lds
  s_add_u32 s32, s32, 1
  s_cmp_eq_u32 s32, s46
  s_addc_u32 s32, s32, 0
  buffer_load_dwordx4 v41, s[16:19], s28 offen offset:1024 sc1 lds
  s_cmp_ge_u32 s32, 7
  s_cselect_b32 s32, 0, s32
  buffer_load_dwordx4 v42, s[16:19], s28 offen offset:2048 sc1 lds
  s_cmp_eq_u32 s32, s46
  s_addc_u32 s32, s32, 0
  buffer_load_dwordx4 v43, s[16:19], s28 offen offset:3072 sc1 lds
  s_cmp_eq_u32 s32, s38
  s_addc_u32 s33, s33, 0
  s_add_u32 m0, s35, 4096
  s_nop 0
  buffer_load_dwordx4 v44, s[16:19], s28 offen offset:0 sc1 lds
  s_add_u32 s34, s34, 16384
  s_and_b32 s34, s34, 0xffff
  buffer_load_dwordx4 v45, s[16:19], s28 offen offset:1024 sc1 lds
  s_lshl_b32 s29, s32, 20
  s_lshr_b32 s26, s33, 1
  s_lshl_b32 s26, s26, 16
  s_add_u32 s29, s29, s26
  buffer_load_dwordx4 v46, s[16:19], s28 offen offset:2048 sc1 lds
  s_and_b32 s26, s33, 1
  s_lshl_b32 s26, s26, 18
  s_add_u32 s29, s29, s26
  buffer_load_dwordx4 v47, s[16:19], s28 offen offset:3072 sc1 lds
  s_add_u32 s31, s31, 1
  s_add_u32 m0, s35, 8192
  s_nop 0
  buffer_load_dwordx4 v56, s[16:19], s28 offen offset:0 sc1 lds
  buffer_load_dwordx4 v57, s[16:19], s28 offen offset:1024 sc1 lds
  buffer_load_dwordx4 v58, s[16:19], s28 offen offset:2048 sc1 lds
  buffer_load_dwordx4 v59, s[16:19], s28 offen offset:3072 sc1 lds
  s_add_u32 m0, s35, 12288
  s_nop 0
  buffer_load_dwordx4 v60, s[16:19], s28 offen offset:0 sc1 lds
  s_add_u32 s35, s30, s34
  s_cmp_lt_u32 s31, 24
  buffer_load_dwordx4 v61, s[16:19], s28 offen offset:1024 sc1 lds
  buffer_load_dwordx4 v62, s[16:19], s28 offen offset:2048 sc1 lds
  buffer_load_dwordx4 v63, s[16:19], s28 offen offset:3072 sc1 lds
  s_mov_b32 s28, s29
  s_mov_b32 m0, s35
  s_waitcnt vmcnt(32)
  s_barrier
  s_cbranch_scc1 w2_loop_49
  s_waitcnt vmcnt(16)
  s_barrier
  s_waitcnt vmcnt(0)
  s_barrier
  v_lshrrev_b32 v2, 4, v0
  v_and_b32 v3, 15, v0
  v_lshlrev_b32 v4, 11, v2
  v_lshl_add_u32 v4, v3, 4, v4
  v_xor_b32 v3, v3, v2
  s_lshl_b32 s28, s5, 13
  s_add_u32 s28, s28, 81920
  v_lshl_add_u32 v2, v2, 8, s28
  v_lshl_add_u32 v40, v3, 4, v2
  v_xor_b32 v41, 64, v40
  v_xor_b32 v42, 128, v40
  v_xor_b32 v43, 192, v40
  s_lshl_b32 s28, s3, 2
  s_add_u32 s28, s28, s5
  s_lshl_b32 s40, s28, 9
  s_lshl1_add_u32 s29, s45, s44
  s_lshl_b32 s29, s29, 2
  s_add_u32 s40, s40, s29
  s_add_u32 s40, s40, 33570816
  s_lshl_b32 s28, s28, 17
  s_lshl_b32 s29, s44, 14
  s_add_u32 s28, s28, s29
  s_lshl_b32 s29, s45, 8
  s_add_u32 s28, s28, s29
  s_add_u32 s28, s28, 41943040
  s_add_u32 s29, s28, 8192
  s_add_u32 s30, s28, 32768
  s_add_u32 s31, s28, 40960
  s_add_u32 s32, s28, 65536
  s_add_u32 s33, s28, 73728
  s_add_u32 s34, s28, 98304
  s_add_u32 s35, s28, 106496
  v_lshlrev_b32 v6, 7, v0
  v_mov_b32 v7, 1
  s_barrier
  ds_read_b128 v[8:11], v40 offset:0
  ds_read_b128 v[12:15], v41 offset:1024
  ds_read_b128 v[16:19], v42 offset:2048
  ds_read_b128 v[20:23], v43 offset:3072
  ds_read_b128 v[24:27], v40 offset:4096
  ds_read_b128 v[28:31], v41 offset:5120
  ds_read_b128 v[32:35], v42 offset:6144
  ds_read_b128 v[36:39], v43 offset:7168
  s_waitcnt lgkmcnt(7)
  buffer_store_dwordx4 v[8:11], v4, s[56:59], s28 offen sc1
  s_waitcnt lgkmcnt(6)
  buffer_store_dwordx4 v[12:15], v4, s[56:59], s29 offen sc1
  s_barrier
  s_waitcnt lgkmcnt(5)
  buffer_store_dwordx4 v[16:19], v4, s[56:59], s30 offen sc1
  s_waitcnt lgkmcnt(4)
  buffer_store_dwordx4 v[20:23], v4, s[56:59], s31 offen sc1
  s_waitcnt lgkmcnt(3)
  buffer_store_dwordx4 v[24:27], v4, s[56:59], s32 offen sc1
  s_waitcnt lgkmcnt(2)
  buffer_store_dwordx4 v[28:31], v4, s[56:59], s33 offen sc1
  s_waitcnt lgkmcnt(1)
  buffer_store_dwordx4 v[32:35], v4, s[56:59], s34 offen sc1
  s_waitcnt lgkmcnt(0)
  buffer_store_dwordx4 v[36:39], v4, s[56:59], s35 offen sc1
  s_waitcnt vmcnt(0)
  s_mov_b64 exec, 0xf
  buffer_store_dword v7, v6, s[56:59], s40 offen sc1
  s_endpgm
f_hst:
  s_mul_i32 s28, s3, 917504
  s_lshl_b32 s29, s4, 16
  s_add_u32 s28, s28, s29
  s_add_u32 s28, s28, 16777216
  v_add_u32 v18, s28, v1
  s_lshl_b32 s42, s3, 8
  s_lshl_b32 s43, s44, 7
  s_add_u32 s42, s42, s43
  s_add_u32 s42, s42, 33558528
  s_lshl_b32 s40, s46, 1
  s_lshl_b32 s40, 1, s40
  s_barrier
  s_waitcnt vmcnt(0)
  s_barrier
  s_cmp_eq_u32 s5, 2
  s_barrier
  s_cbranch_scc1 f_hst2
  s_barrier
  ds_read_b128 v[64:67], v1 offset:0
  ds_read_b128 v[68:71], v1 offset:1024
  ds_read_b128 v[72:75], v1 offset:2048
  ds_read_b128 v[76:79], v1 offset:3072
  ds_read_b128 v[80:83], v1 offset:4096
  ds_read_b128 v[84:87], v1 offset:5120
  ds_read_b128 v[88:91], v1 offset:6144
  ds_read_b128 v[92:95], v1 offset:7168
  ds_read_b128 v[96:99], v1 offset:16384
  ds_read_b128 v[100:103], v1 offset:17408
  ds_read_b128 v[104:107], v1 offset:18432
  ds_read_b128 v[108:111], v1 offset:19456
  ds_read_b128 v[112:115], v1 offset:20480
  ds_read_b128 v[116:119], v1 offset:21504
  ds_read_b128 v[120:123], v1 offset:22528
  ds_read_b128 v[124:127], v1 offset:23552
  s_waitcnt lgkmcnt(15)
  s_mov_b32 s28, 0
  buffer_store_dwordx4 v[64:67], v18, s[56:59], s28 offen offset:0 sc1
  s_waitcnt lgkmcnt(14)
  buffer_store_dwordx4 v[68:71], v18, s[56:59], s28 offen offset:1024 sc1
  s_waitcnt lgkmcnt(13)
  buffer_store_dwordx4 v[72:75], v18, s[56:59], s28 offen offset:2048 sc1
  s_waitcnt lgkmcnt(12)
  buffer_store_dwordx4 v[76:79], v18, s[56:59], s28 offen offset:3072 sc1
  s_waitcnt lgkmcnt(11)
  s_mov_b32 s28, 4096
  buffer_store_dwordx4 v[80:83], v18, s[56:59], s28 offen offset:0 sc1
  s_waitcnt lgkmcnt(10)
  buffer_store_dwordx4 v[84:87], v18, s[56:59], s28 offen offset:1024 sc1
  s_waitcnt lgkmcnt(9)
  buffer_store_dwordx4 v[88:91], v18, s[56:59], s28 offen offset:2048 sc1
  s_waitcnt lgkmcnt(8)
  buffer_store_dwordx4 v[92:95], v18, s[56:59], s28 offen offset:3072 sc1
  s_barrier
  ds_read_b128 v[128:131], v1 offset:32768
  ds_read_b128 v[132:135], v1 offset:33792
  ds_read_b128 v[136:139], v1 offset:34816
  ds_read_b128 v[140:143], v1 offset:35840
  ds_read_b128 v[144:147], v1 offset:36864
  ds_read_b128 v[148:151], v1 offset:37888
  ds_read_b128 v[152:155], v1 offset:38912
  ds_read_b128 v[156:159], v1 offset:39936
  ds_read_b128 v[160:163], v1 offset:49152
  ds_read_b128 v[164:167], v1 offset:50176
  ds_read_b128 v[168:171], v1 offset:51200
  ds_read_b128 v[172:175], v1 offset:52224
  ds_read_b128 v[176:179], v1 offset:53248
  ds_read_b128 v[180:183], v1 offset:54272
  ds_read_b128 v[184:187], v1 offset:55296
  ds_read_b128 v[188:191], v1 offset:56320
  s_waitcnt vmcnt(0)
  s_add_u32 s41, s42, 0
  v_mov_b32 v20, s40
  s_mov_b64 exec, 1
  buffer_atomic_add v20, off, s[56:59], s41 sc1
  s_mov_b64 exec, -1
  s_waitcnt lgkmcnt(0)
  s_barrier
  s_mov_b32 s28, 16384
  buffer_store_dwordx4 v[96:99], v18, s[56:59], s28 offen offset:0 sc1
  buffer_store_dwordx4 v[100:103], v18, s[56:59], s28 offen offset:1024 sc1
  buffer_store_dwordx4 v[104:107], v18, s[56:59], s28 offen offset:2048 sc1
  buffer_store_dwordx4 v[108:111], v18, s[56:59], s28 offen offset:3072 sc1
  s_barrier
  s_mov_b32 s28, 20480
  buffer_store_dwordx4 v[112:115], v18, s[56:59], s28 offen offset:0 sc1
  buffer_store_dwordx4 v[116:119], v18, s[56:59], s28 offen offset:1024 sc1
  buffer_store_dwordx4 v[120:123], v18, s[56:59], s28 offen offset:2048 sc1
  buffer_store_dwordx4 v[124:127], v18, s[56:59], s28 offen offset:3072 sc1
  s_barrier
  s_mov_b32 s28, 32768
  buffer_store_dwordx4 v[128:131], v18, s[56:59], s28 offen offset:0 sc1
  buffer_store_dwordx4 v[132:135], v18, s[56:59], s28 offen offset:1024 sc1
  buffer_store_dwordx4 v[136:139], v18, s[56:59], s28 offen offset:2048 sc1
  buffer_store_dwordx4 v[140:143], v18, s[56:59], s28 offen offset:3072 sc1
  s_waitcnt vmcnt(4)
  s_add_u32 s41, s42, 4
  v_mov_b32 v20, s40
  s_mov_b64 exec, 1
  buffer_atomic_add v20, off, s[56:59], s41 sc1
  s_mov_b64 exec, -1
  s_barrier
  s_mov_b32 s28, 36864
  buffer_store_dwordx4 v[144:147], v18, s[56:59], s28 offen offset:0 sc1
  buffer_store_dwordx4 v[148:151], v18, s[56:59], s28 offen offset:1024 sc1
  buffer_store_dwordx4 v[152:155], v18, s[56:59], s28 offen offset:2048 sc1
  buffer_store_dwordx4 v[156:159], v18, s[56:59], s28 offen offset:3072 sc1
  s_barrier
  s_mov_b32 s28, 49152
  buffer_store_dwordx4 v[160:163], v18, s[56:59], s28 offen offset:0 sc1
  buffer_store_dwordx4 v[164:167], v18, s[56:59], s28 offen offset:1024 sc1
  buffer_store_dwordx4 v[168:171], v18, s[56:59], s28 offen offset:2048 sc1
  buffer_store_dwordx4 v[172:175], v18, s[56:59], s28 offen offset:3072 sc1
  s_waitcnt vmcnt(4)
  s_add_u32 s41, s42, 8
  v_mov_b32 v20, s40
  s_mov_b64 exec, 1
  buffer_atomic_add v20, off, s[56:59], s41 sc1
  s_mov_b64 exec, -1
  s_barrier
  s_mov_b32 s28, 53248
  buffer_store_dwordx4 v[176:179], v18, s[56:59], s28 offen offset:0 sc1
  buffer_store_dwordx4 v[180:183], v18, s[56:59], s28 offen offset:1024 sc1
  buffer_store_dwordx4 v[184:187], v18, s[56:59], s28 offen offset:2048 sc1
  buffer_store_dwordx4 v[188:191], v18, s[56:59], s28 offen offset:3072 sc1
  s_barrier
  s_waitcnt vmcnt(0)
  s_add_u32 s41, s42, 12
  v_mov_b32 v20, s40
  s_mov_b64 exec, 1
  buffer_atomic_add v20, off, s[56:59], s41 sc1
  s_mov_b64 exec, -1
  s_barrier
  s_mov_b32 s31, 15
f_tail1:
  s_cmp_eq_u32 s31, 0
  s_cbranch_scc1 barsd_51
bars_50:
  s_barrier
  s_sub_u32 s31, s31, 1
  s_cmp_lg_u32 s31, 0
  s_cbranch_scc1 bars_50
barsd_51:
  s_mov_b32 s31, 4
  s_lshl_b32 s42, s3, 7
  s_add_u32 s42, s42, 33562624
  s_mov_b32 s27, 0
p_p_52:
  s_cmp_eq_u32 s31, 0
  s_cbranch_scc1 p_s_53
  s_cmp_ge_u32 s27, 32
  s_cbranch_scc1 p_g_54
  s_load_dword s27, s[56:57], s42 glc
  s_barrier
  s_sub_u32 s31, s31, 1
  s_branch p_p_52
p_s_53:
  s_mov_b32 s40, 0
sspin_55:
  s_load_dword s27, s[56:57], s42 glc
  s_waitcnt lgkmcnt(0)
  s_cmp_ge_u32 s27, 32
  s_cbranch_scc1 sspun_56
  s_add_u32 s40, s40, 1
  s_cmp_lt_u32 s40, 65536
  s_cbranch_scc1 sspin_55
sspun_56:
p_g_54:
  s_waitcnt lgkmcnt(0)
  v_lshrrev_b32 v20, 4, v0
  v_and_b32 v21, 7, v0
  v_xor_b32 v21, v21, v20
  v_lshrrev_b32 v20, 3, v0
  v_lshlrev_b32 v20, 7, v20
  v_lshl_add_u32 v20, v21, 4, v20
  v_xor_b32 v21, 64, v20
  s_lshl_b32 s28, s2, 14
  s_add_u32 s28, s28, 8388608
  s_mov_b32 m0, 147456
  s_nop 0
  buffer_load_dwordx4 v20, s[56:59], s28 offen offset:0 sc1 lds
  buffer_load_dwordx4 v21, s[56:59], s28 offen offset:1024 sc1 lds
  buffer_load_dwordx4 v20, s[56:59], s28 offen offset:2048 sc1 lds
  buffer_load_dwordx4 v21, s[56:59], s28 offen offset:3072 sc1 lds
  s_mov_b32 m0, 151552
  s_add_u32 s28, s28, 4096
  buffer_load_dwordx4 v20, s[56:59], s28 offen offset:0 sc1 lds
  buffer_load_dwordx4 v21, s[56:59], s28 offen offset:1024 sc1 lds
  buffer_load_dwordx4 v20, s[56:59], s28 offen offset:2048 sc1 lds
  buffer_load_dwordx4 v21, s[56:59], s28 offen offset:3072 sc1 lds
  s_mov_b32 m0, 155648
  s_add_u32 s28, s28, 4096
  buffer_load_dwordx4 v20, s[56:59], s28 offen offset:0 sc1 lds
  buffer_load_dwordx4 v21, s[56:59], s28 offen offset:1024 sc1 lds
  buffer_load_dwordx4 v20, s[56:59], s28 offen offset:2048 sc1 lds
  buffer_load_dwordx4 v21, s[56:59], s28 offen offset:3072 sc1 lds
  s_mov_b32 m0, 159744
  s_add_u32 s28, s28, 4096
  buffer_load_dwordx4 v20, s[56:59], s28 offen offset:0 sc1 lds
  buffer_load_dwordx4 v21, s[56:59], s28 offen offset:1024 sc1 lds
  buffer_load_dwordx4 v20, s[56:59], s28 offen offset:2048 sc1 lds
  buffer_load_dwordx4 v21, s[56:59], s28 offen offset:3072 sc1 lds
  s_cmp_eq_u32 s31, 0
  s_cbranch_scc1 barsd_58
bars_57:
  s_barrier
  s_sub_u32 s31, s31, 1
  s_cmp_lg_u32 s31, 0
  s_cbranch_scc1 bars_57
barsd_58:
  s_waitcnt vmcnt(0)
  v_lshrrev_b32 v2, 4, v0
  v_and_b32 v3, 15, v0
  v_lshlrev_b32 v4, 11, v2
  v_lshl_add_u32 v4, v3, 4, v4
  v_xor_b32 v3, v3, v2
  s_lshl_b32 s28, s5, 13
  s_add_u32 s28, s28, 81920
  v_lshl_add_u32 v2, v2, 8, s28
  v_lshl_add_u32 v40, v3, 4, v2
  v_xor_b32 v41, 64, v40
  v_xor_b32 v42, 128, v40
  v_xor_b32 v43, 192, v40
  s_lshl_b32 s28, s3, 2
  s_add_u32 s28, s28, s5
  s_lshl_b32 s40, s28, 9
  s_lshl1_add_u32 s29, s45, s44
  s_lshl_b32 s29, s29, 2
  s_add_u32 s40, s40, s29
  s_add_u32 s40, s40, 33570816
  s_lshl_b32 s28, s28, 17
  s_lshl_b32 s29, s44, 14
  s_add_u32 s28, s28, s29
  s_lshl_b32 s29, s45, 8
  s_add_u32 s28, s28, s29
  s_add_u32 s28, s28, 41943040
  s_add_u32 s29, s28, 8192
  s_add_u32 s30, s28, 32768
  s_add_u32 s31, s28, 40960
  s_add_u32 s32, s28, 65536
  s_add_u32 s33, s28, 73728
  s_add_u32 s34, s28, 98304
  s_add_u32 s35, s28, 106496
  v_lshlrev_b32 v6, 7, v0
  v_mov_b32 v7, 1
  s_barrier
  ds_read_b128 v[8:11], v40 offset:0
  ds_read_b128 v[12:15], v41 offset:1024
  ds_read_b128 v[16:19], v42 offset:2048
  ds_read_b128 v[20:23], v43 offset:3072
  ds_read_b128 v[24:27], v40 offset:4096
  ds_read_b128 v[28:31], v41 offset:5120
  ds_read_b128 v[32:35], v42 offset:6144
  ds_read_b128 v[36:39], v43 offset:7168
  s_waitcnt lgkmcnt(7)
  buffer_store_dwordx4 v[8:11], v4, s[56:59], s28 offen sc1
  s_waitcnt lgkmcnt(6)
  buffer_store_dwordx4 v[12:15], v4, s[56:59], s29 offen sc1
  s_barrier
  s_waitcnt lgkmcnt(5)
  buffer_store_dwordx4 v[16:19], v4, s[56:59], s30 offen sc1
  s_waitcnt lgkmcnt(4)
  buffer_store_dwordx4 v[20:23], v4, s[56:59], s31 offen sc1
  s_waitcnt lgkmcnt(3)
  buffer_store_dwordx4 v[24:27], v4, s[56:59], s32 offen sc1
  s_waitcnt lgkmcnt(2)
  buffer_store_dwordx4 v[28:31], v4, s[56:59], s33 offen sc1
  s_waitcnt lgkmcnt(1)
  buffer_store_dwordx4 v[32:35], v4, s[56:59], s34 offen sc1
  s_waitcnt lgkmcnt(0)
  buffer_store_dwordx4 v[36:39], v4, s[56:59], s35 offen sc1
  s_waitcnt vmcnt(0)
  s_mov_b64 exec, 0xf
  buffer_store_dword v7, v6, s[56:59], s40 offen sc1
  s_endpgm
f_hst2:
  s_barrier
  ds_read_b128 v[64:67], v1 offset:8192
  ds_read_b128 v[68:71], v1 offset:9216
  ds_read_b128 v[72:75], v1 offset:10240
  ds_read_b128 v[76:79], v1 offset:11264
  ds_read_b128 v[80:83], v1 offset:12288
  ds_read_b128 v[84:87], v1 offset:13312
  ds_read_b128 v[88:91], v1 offset:14336
  ds_read_b128 v[92:95], v1 offset:15360
  ds_read_b128 v[96:99], v1 offset:24576
  ds_read_b128 v[100:103], v1 offset:25600
  ds_read_b128 v[104:107], v1 offset:26624
  ds_read_b128 v[108:111], v1 offset:27648
  ds_read_b128 v[112:115], v1 offset:28672
  ds_read_b128 v[116:119], v1 offset:29696
  ds_read_b128 v[120:123], v1 offset:30720
  ds_read_b128 v[124:127], v1 offset:31744
  s_waitcnt lgkmcnt(15)
  s_mov_b32 s28, 8192
  buffer_store_dwordx4 v[64:67], v18, s[56:59], s28 offen offset:0 sc1
  s_waitcnt lgkmcnt(14)
  buffer_store_dwordx4 v[68:71], v18, s[56:59], s28 offen offset:1024 sc1
  s_waitcnt lgkmcnt(13)
  buffer_store_dwordx4 v[72:75], v18, s[56:59], s28 offen offset:2048 sc1
  s_waitcnt lgkmcnt(12)
  buffer_store_dwordx4 v[76:79], v18, s[56:59], s28 offen offset:3072 sc1
  s_waitcnt lgkmcnt(11)
  s_mov_b32 s28, 12288
  buffer_store_dwordx4 v[80:83], v18, s[56:59], s28 offen offset:0 sc1
  s_waitcnt lgkmcnt(10)
  buffer_store_dwordx4 v[84:87], v18, s[56:59], s28 offen offset:1024 sc1
  s_waitcnt lgkmcnt(9)
  buffer_store_dwordx4 v[88:91], v18, s[56:59], s28 offen offset:2048 sc1
  s_waitcnt lgkmcnt(8)
  buffer_store_dwordx4 v[92:95], v18, s[56:59], s28 offen offset:3072 sc1
  s_barrier
  ds_read_b128 v[128:131], v1 offset:40960
  ds_read_b128 v[132:135], v1 offset:41984
  ds_read_b128 v[136:139], v1 offset:43008
  ds_read_b128 v[140:143], v1 offset:44032
  ds_read_b128 v[144:147], v1 offset:45056
  ds_read_b128 v[148:151], v1 offset:46080
  ds_read_b128 v[152:155], v1 offset:47104
  ds_read_b128 v[156:159], v1 offset:48128
  ds_read_b128 v[160:163], v1 offset:57344
  ds_read_b128 v[164:167], v1 offset:58368
  ds_read_b128 v[168:171], v1 offset:59392
  ds_read_b128 v[172:175], v1 offset:60416
  ds_read_b128 v[176:179], v1 offset:61440
  ds_read_b128 v[180:183], v1 offset:62464
  ds_read_b128 v[184:187], v1 offset:63488
  ds_read_b128 v[188:191], v1 offset:64512
  s_waitcnt vmcnt(0)
  s_add_u32 s41, s42, 0
  v_mov_b32 v20, s40
  s_mov_b64 exec, 1
  buffer_atomic_add v20, off, s[56:59], s41 sc1
  s_mov_b64 exec, -1
  s_waitcnt lgkmcnt(0)
  s_barrier
  s_mov_b32 s28, 24576
  buffer_store_dwordx4 v[96:99], v18, s[56:59], s28 offen offset:0 sc1
  buffer_store_dwordx4 v[100:103], v18, s[56:59], s28 offen offset:1024 sc1
  buffer_store_dwordx4 v[104:107], v18, s[56:59], s28 offen offset:2048 sc1
  buffer_store_dwordx4 v[108:111], v18, s[56:59], s28 offen offset:3072 sc1
  s_barrier
  s_mov_b32 s28, 28672
  buffer_store_dwordx4 v[112:115], v18, s[56:59], s28 offen offset:0 sc1
  buffer_store_dwordx4 v[116:119], v18, s[56:59], s28 offen offset:1024 sc1
  buffer_store_dwordx4 v[120:123], v18, s[56:59], s28 offen offset:2048 sc1
  buffer_store_dwordx4 v[124:127], v18, s[56:59], s28 offen offset:3072 sc1
  s_barrier
  s_mov_b32 s28, 40960
  buffer_store_dwordx4 v[128:131], v18, s[56:59], s28 offen offset:0 sc1
  buffer_store_dwordx4 v[132:135], v18, s[56:59], s28 offen offset:1024 sc1
  buffer_store_dwordx4 v[136:139], v18, s[56:59], s28 offen offset:2048 sc1
  buffer_store_dwordx4 v[140:143], v18, s[56:59], s28 offen offset:3072 sc1
  s_waitcnt vmcnt(4)
  s_add_u32 s41, s42, 4
  v_mov_b32 v20, s40
  s_mov_b64 exec, 1
  buffer_atomic_add v20, off, s[56:59], s41 sc1
  s_mov_b64 exec, -1
  s_barrier
  s_mov_b32 s28, 45056
  buffer_store_dwordx4 v[144:147], v18, s[56:59], s28 offen offset:0 sc1
  buffer_store_dwordx4 v[148:151], v18, s[56:59], s28 offen offset:1024 sc1
  buffer_store_dwordx4 v[152:155], v18, s[56:59], s28 offen offset:2048 sc1
  buffer_store_dwordx4 v[156:159], v18, s[56:59], s28 offen offset:3072 sc1
  s_barrier
  s_mov_b32 s28, 57344
  buffer_store_dwordx4 v[160:163], v18, s[56:59], s28 offen offset:0 sc1
  buffer_store_dwordx4 v[164:167], v18, s[56:59], s28 offen offset:1024 sc1
  buffer_store_dwordx4 v[168:171], v18, s[56:59], s28 offen offset:2048 sc1
  buffer_store_dwordx4 v[172:175], v18, s[56:59], s28 offen offset:3072 sc1
  s_waitcnt vmcnt(4)
  s_add_u32 s41, s42, 8
  v_mov_b32 v20, s40
  s_mov_b64 exec, 1
  buffer_atomic_add v20, off, s[56:59], s41 sc1
  s_mov_b64 exec, -1
  s_barrier
  s_mov_b32 s28, 61440
  buffer_store_dwordx4 v[176:179], v18, s[56:59], s28 offen offset:0 sc1
  buffer_store_dwordx4 v[180:183], v18, s[56:59], s28 offen offset:1024 sc1
  buffer_store_dwordx4 v[184:187], v18, s[56:59], s28 offen offset:2048 sc1
  buffer_store_dwordx4 v[188:191], v18, s[56:59], s28 offen offset:3072 sc1
  s_barrier
  s_waitcnt vmcnt(0)
  s_add_u32 s41, s42, 12
  v_mov_b32 v20, s40
  s_mov_b64 exec, 1
  buffer_atomic_add v20, off, s[56:59], s41 sc1
  s_mov_b64 exec, -1
  s_barrier
  s_mov_b32 s31, 17
f_tail2:
  s_cmp_eq_u32 s31, 0
  s_cbranch_scc1 barsd_60
bars_59:
  s_barrier
  s_sub_u32 s31, s31, 1
  s_cmp_lg_u32 s31, 0
  s_cbranch_scc1 bars_59
barsd_60:
  v_and_b32 v20, 15, v0
  v_lshlrev_b32 v20, 6, v20
  v_bfe_u32 v21, v0, 4, 1
  v_lshl_add_u32 v20, v21, 5, v20
  v_lshrrev_b32 v21, 5, v0
  v_lshl_add_u32 v20, v21, 4, v20
  s_mov_b32 s8, s60
  s_and_b32 s9, s61, 0xffff
  s_mov_b32 s10, 0x400000
  s_mov_b32 s11, 0x20000
  s_mov_b32 s12, s74
  s_and_b32 s13, s75, 0xffff
  s_mov_b32 s14, 0x800
  s_mov_b32 s15, 0x20000
  s_lshl_b32 s28, s2, 11
  s_mov_b32 m0, 0
  s_nop 0
  buffer_load_dwordx4 v20, s[8:11], s28 offen offset:0 lds
  buffer_load_dwordx4 v20, s[8:11], s28 offen offset:1024 lds
  s_mov_b32 m0, 2048
  s_add_u32 s28, s28, 524288
  buffer_load_dwordx4 v20, s[8:11], s28 offen offset:0 lds
  buffer_load_dwordx4 v20, s[8:11], s28 offen offset:1024 lds
  s_mov_b32 m0, 4096
  s_add_u32 s28, s28, 524288
  buffer_load_dwordx4 v20, s[8:11], s28 offen offset:0 lds
  buffer_load_dwordx4 v20, s[8:11], s28 offen offset:1024 lds
  s_mov_b32 m0, 6144
  s_add_u32 s28, s28, 524288
  buffer_load_dwordx4 v20, s[8:11], s28 offen offset:0 lds
  buffer_load_dwordx4 v20, s[8:11], s28 offen offset:1024 lds
  s_mov_b32 m0, 8192
  s_add_u32 s28, s28, 524288
  buffer_load_dwordx4 v20, s[8:11], s28 offen offset:0 lds
  buffer_load_dwordx4 v20, s[8:11], s28 offen offset:1024 lds
  s_mov_b32 m0, 10240
  s_add_u32 s28, s28, 524288
  buffer_load_dwordx4 v20, s[8:11], s28 offen offset:0 lds
  buffer_load_dwordx4 v20, s[8:11], s28 offen offset:1024 lds
  s_mov_b32 m0, 12288
  s_add_u32 s28, s28, 524288
  buffer_load_dwordx4 v20, s[8:11], s28 offen offset:0 lds
  buffer_load_dwordx4 v20, s[8:11], s28 offen offset:1024 lds
  s_mov_b32 m0, 14336
  s_add_u32 s28, s28, 524288
  buffer_load_dwordx4 v20, s[8:11], s28 offen offset:0 lds
  buffer_load_dwordx4 v20, s[8:11], s28 offen offset:1024 lds
  s_barrier
  s_mov_b32 m0, 16384
  s_nop 0
  buffer_load_dwordx4 v20, s[12:15], 0 offen offset:0 lds
  buffer_load_dwordx4 v20, s[12:15], 0 offen offset:1024 lds
  s_barrier
  s_waitcnt vmcnt(0)
  v_lshrrev_b32 v2, 4, v0
  v_and_b32 v3, 15, v0
  v_lshlrev_b32 v4, 11, v2
  v_lshl_add_u32 v4, v3, 4, v4
  v_xor_b32 v3, v3, v2
  s_lshl_b32 s28, s5, 13
  s_add_u32 s28, s28, 81920
  v_lshl_add_u32 v2, v2, 8, s28
  v_lshl_add_u32 v40, v3, 4, v2
  v_xor_b32 v41, 64, v40
  v_xor_b32 v42, 128, v40
  v_xor_b32 v43, 192, v40
  s_lshl_b32 s28, s3, 2
  s_add_u32 s28, s28, s5
  s_lshl_b32 s40, s28, 9
  s_lshl1_add_u32 s29, s45, s44
  s_lshl_b32 s29, s29, 2
  s_add_u32 s40, s40, s29
  s_add_u32 s40, s40, 33570816
  s_lshl_b32 s28, s28, 17
  s_lshl_b32 s29, s44, 14
  s_add_u32 s28, s28, s29
  s_lshl_b32 s29, s45, 8
  s_add_u32 s28, s28, s29
  s_add_u32 s28, s28, 41943040
  s_add_u32 s29, s28, 8192
  s_add_u32 s30, s28, 32768
  s_add_u32 s31, s28, 40960
  s_add_u32 s32, s28, 65536
  s_add_u32 s33, s28, 73728
  s_add_u32 s34, s28, 98304
  s_add_u32 s35, s28, 106496
  v_lshlrev_b32 v6, 7, v0
  v_mov_b32 v7, 1
  s_barrier
  ds_read_b128 v[8:11], v40 offset:0
  ds_read_b128 v[12:15], v41 offset:1024
  ds_read_b128 v[16:19], v42 offset:2048
  ds_read_b128 v[20:23], v43 offset:3072
  ds_read_b128 v[24:27], v40 offset:4096
  ds_read_b128 v[28:31], v41 offset:5120
  ds_read_b128 v[32:35], v42 offset:6144
  ds_read_b128 v[36:39], v43 offset:7168
  s_waitcnt lgkmcnt(7)
  buffer_store_dwordx4 v[8:11], v4, s[56:59], s28 offen sc1
  s_waitcnt lgkmcnt(6)
  buffer_store_dwordx4 v[12:15], v4, s[56:59], s29 offen sc1
  s_barrier
  s_waitcnt lgkmcnt(5)
  buffer_store_dwordx4 v[16:19], v4, s[56:59], s30 offen sc1
  s_waitcnt lgkmcnt(4)
  buffer_store_dwordx4 v[20:23], v4, s[56:59], s31 offen sc1
  s_waitcnt lgkmcnt(3)
  buffer_store_dwordx4 v[24:27], v4, s[56:59], s32 offen sc1
  s_waitcnt lgkmcnt(2)
  buffer_store_dwordx4 v[28:31], v4, s[56:59], s33 offen sc1
  s_waitcnt lgkmcnt(1)
  buffer_store_dwordx4 v[32:35], v4, s[56:59], s34 offen sc1
  s_waitcnt lgkmcnt(0)
  buffer_store_dwordx4 v[36:39], v4, s[56:59], s35 offen sc1
  s_waitcnt vmcnt(0)
  s_mov_b64 exec, 0xf
  buffer_store_dword v7, v6, s[56:59], s40 offen sc1
  s_endpgm
f_tailh:
  s_cmp_eq_u32 s5, 0
  s_cbranch_scc1 f_tailh0
  s_cmp_lg_u32 s5, 3
  s_cbranch_scc1 f_tailh1
  s_and_b32 s32, s3, 3
  s_mul_i32 s32, s32, 2
  s_cmp_eq_u32 s32, s46
  s_addc_u32 s32, s32, 0
  s_cmp_ge_u32 s32, 7
  s_cselect_b32 s32, 0, s32
  s_mov_b32 s38, s32
  s_mov_b32 s33, 0
  s_mov_b32 s34, 0
  s_mov_b32 s30, 81920
  s_mov_b32 s39, 131072
  s_mov_b32 s16, s72
  s_and_b32 s17, s73, 0xffff
  s_mov_b32 s18, 0x700000
  s_mov_b32 s19, 0x20000
  s_lshl_b32 s28, s45, 8
  s_lshl_b32 s36, s46, 20
  s_lshl_b32 s29, s44, 19
  s_add_u32 s28, s28, s29
  v_lshrrev_b32 v48, 4, v0
  v_and_b32 v49, 15, v0
  v_lshl_add_u32 v50, v48, 1, 0
  v_xor_b32 v50, v50, v49
  v_lshlrev_b32 v50, 4, v50
  v_lshl_add_u32 v50, v48, 11, v50
  v_add_u32 v50, s28, v50
  v_add_u32 v40, 0, v50
  v_add_u32 v42, 14336, v50
  v_add_u32 v44, 32768, v50
  v_add_u32 v46, 47104, v50
  v_lshl_add_u32 v50, v48, 1, 8
  v_xor_b32 v50, v50, v49
  v_lshlrev_b32 v50, 4, v50
  v_lshl_add_u32 v50, v48, 11, v50
  v_add_u32 v50, s28, v50
  v_add_u32 v41, 7168, v50
  v_add_u32 v43, 21504, v50
  v_add_u32 v45, 39936, v50
  v_add_u32 v47, 54272, v50
  s_lshl_b32 s28, s32, 20
  s_lshr_b32 s29, s33, 1
  s_lshl_b32 s29, s29, 16
  s_add_u32 s28, s28, s29
  s_and_b32 s29, s33, 1
  s_lshl_b32 s29, s29, 18
  s_add_u32 s28, s28, s29
  s_add_u32 s35, s30, s34
  s_add_u32 s29, s28, s39
  s_add_u32 m0, s35, 0
  s_nop 0
  buffer_load_dwordx4 v40, s[16:19], s28 offen offset:0 sc1 lds
  buffer_load_dwordx4 v41, s[16:19], s28 offen offset:1024 sc1 lds
  buffer_load_dwordx4 v42, s[16:19], s28 offen offset:2048 sc1 lds
  buffer_load_dwordx4 v43, s[16:19], s28 offen offset:3072 sc1 lds
  s_add_u32 m0, s35, 4096
  s_nop 0
  buffer_load_dwordx4 v44, s[16:19], s28 offen offset:0 sc1 lds
  buffer_load_dwordx4 v45, s[16:19], s28 offen offset:1024 sc1 lds
  buffer_load_dwordx4 v46, s[16:19], s28 offen offset:2048 sc1 lds
  buffer_load_dwordx4 v47, s[16:19], s28 offen offset:3072 sc1 lds
  s_add_u32 m0, s35, 8192
  s_nop 0
  buffer_load_dwordx4 v40, s[16:19], s29 offen offset:0 sc1 lds
  buffer_load_dwordx4 v41, s[16:19], s29 offen offset:1024 sc1 lds
  buffer_load_dwordx4 v42, s[16:19], s29 offen offset:2048 sc1 lds
  buffer_load_dwordx4 v43, s[16:19], s29 offen offset:3072 sc1 lds
  s_add_u32 m0, s35, 12288
  s_nop 0
  buffer_load_dwordx4 v44, s[16:19], s29 offen offset:0 sc1 lds
  buffer_load_dwordx4 v45, s[16:19], s29 offen offset:1024 sc1 lds
  buffer_load_dwordx4 v46, s[16:19], s29 offen offset:2048 sc1 lds
  buffer_load_dwordx4 v47, s[16:19], s29 offen offset:3072 sc1 lds
  s_add_u32 s34, s34, 16384
  s_and_b32 s34, s34, 0xffff
  s_add_u32 s32, s32, 1
  s_cmp_eq_u32 s32, s46
  s_addc_u32 s32, s32, 0
  s_cmp_ge_u32 s32, 7
  s_cselect_b32 s32, 0, s32
  s_cmp_eq_u32 s32, s46
  s_addc_u32 s32, s32, 0
  s_cmp_eq_u32 s32, s38
  s_addc_u32 s33, s33, 0
  s_lshl_b32 s28, s32, 20
  s_lshr_b32 s29, s33, 1
  s_lshl_b32 s29, s29, 16
  s_add_u32 s28, s28, s29
  s_and_b32 s29, s33, 1
  s_lshl_b32 s29, s29, 18
  s_add_u32 s28, s28, s29
  s_add_u32 s35, s30, s34
  s_add_u32 s29, s28, s39
  s_add_u32 m0, s35, 0
  s_nop 0
  buffer_load_dwordx4 v40, s[16:19], s28 offen offset:0 sc1 lds
  buffer_load_dwordx4 v41, s[16:19], s28 offen offset:1024 sc1 lds
  buffer_load_dwordx4 v42, s[16:19], s28 offen offset:2048 sc1 lds
  buffer_load_dwordx4 v43, s[16:19], s28 offen offset:3072 sc1 lds
  s_add_u32 m0, s35, 4096
  s_nop 0
  buffer_load_dwordx4 v44, s[16:19], s28 offen offset:0 sc1 lds
  buffer_load_dwordx4 v45, s[16:19], s28 offen offset:1024 sc1 lds
  buffer_load_dwordx4 v46, s[16:19], s28 offen offset:2048 sc1 lds
  buffer_load_dwordx4 v47, s[16:19], s28 offen offset:3072 sc1 lds
  s_add_u32 m0, s35, 8192
  s_nop 0
  buffer_load_dwordx4 v40, s[16:19], s29 offen offset:0 sc1 lds
  buffer_load_dwordx4 v41, s[16:19], s29 offen offset:1024 sc1 lds
  buffer_load_dwordx4 v42, s[16:19], s29 offen offset:2048 sc1 lds
  buffer_load_dwordx4 v43, s[16:19], s29 offen offset:3072 sc1 lds
  s_add_u32 m0, s35, 12288
  s_nop 0
  buffer_load_dwordx4 v44, s[16:19], s29 offen offset:0 sc1 lds
  buffer_load_dwordx4 v45, s[16:19], s29 offen offset:1024 sc1 lds
  buffer_load_dwordx4 v46, s[16:19], s29 offen offset:2048 sc1 lds
  buffer_load_dwordx4 v47, s[16:19], s29 offen offset:3072 sc1 lds
  s_add_u32 s34, s34, 16384
  s_and_b32 s34, s34, 0xffff
  s_add_u32 s32, s32, 1
  s_cmp_eq_u32 s32, s46
  s_addc_u32 s32, s32, 0
  s_cmp_ge_u32 s32, 7
  s_cselect_b32 s32, 0, s32
  s_cmp_eq_u32 s32, s46
  s_addc_u32 s32, s32, 0
  s_cmp_eq_u32 s32, s38
  s_addc_u32 s33, s33, 0
  s_waitcnt vmcnt(47)
  s_lshl_b32 s28, s32, 20
  s_lshr_b32 s29, s33, 1
  s_lshl_b32 s29, s29, 16
  s_add_u32 s28, s28, s29
  s_and_b32 s29, s33, 1
  s_lshl_b32 s29, s29, 18
  s_add_u32 s28, s28, s29
  s_add_u32 s35, s30, s34
  s_add_u32 s29, s28, s39
  s_add_u32 m0, s35, 0
  s_nop 0
  buffer_load_dwordx4 v40, s[16:19], s28 offen offset:0 sc1 lds
  buffer_load_dwordx4 v41, s[16:19], s28 offen offset:1024 sc1 lds
  buffer_load_dwordx4 v42, s[16:19], s28 offen offset:2048 sc1 lds
  buffer_load_dwordx4 v43, s[16:19], s28 offen offset:3072 sc1 lds
  s_add_u32 m0, s35, 4096
  s_nop 0
  buffer_load_dwordx4 v44, s[16:19], s28 offen offset:0 sc1 lds
  buffer_load_dwordx4 v45, s[16:19], s28 offen offset:1024 sc1 lds
  buffer_load_dwordx4 v46, s[16:19], s28 offen offset:2048 sc1 lds
  buffer_load_dwordx4 v47, s[16:19], s28 offen offset:3072 sc1 lds
  s_add_u32 m0, s35, 8192
  s_nop 0
  buffer_load_dwordx4 v40, s[16:19], s29 offen offset:0 sc1 lds
  buffer_load_dwordx4 v41, s[16:19], s29 offen offset:1024 sc1 lds
  buffer_load_dwordx4 v42, s[16:19], s29 offen offset:2048 sc1 lds
  buffer_load_dwordx4 v43, s[16:19], s29 offen offset:3072 sc1 lds
  s_add_u32 m0, s35, 12288
  s_nop 0
  buffer_load_dwordx4 v44, s[16:19], s29 offen offset:0 sc1 lds
  buffer_load_dwordx4 v45, s[16:19], s29 offen offset:1024 sc1 lds
  buffer_load_dwordx4 v46, s[16:19], s29 offen offset:2048 sc1 lds
  buffer_load_dwordx4 v47, s[16:19], s29 offen offset:3072 sc1 lds
  s_add_u32 s34, s34, 16384
  s_and_b32 s34, s34, 0xffff
  s_add_u32 s32, s32, 1
  s_cmp_eq_u32 s32, s46
  s_addc_u32 s32, s32, 0
  s_cmp_ge_u32 s32, 7
  s_cselect_b32 s32, 0, s32
  s_cmp_eq_u32 s32, s46
  s_addc_u32 s32, s32, 0
  s_cmp_eq_u32 s32, s38
  s_addc_u32 s33, s33, 0
  s_waitcnt vmcnt(47)
  s_lshl_b32 s28, s32, 20
  s_lshr_b32 s29, s33, 1
  s_lshl_b32 s29, s29, 16
  s_add_u32 s28, s28, s29
  s_and_b32 s29, s33, 1
  s_lshl_b32 s29, s29, 18
  s_add_u32 s28, s28, s29
  s_add_u32 s35, s30, s34
  s_add_u32 s29, s28, s39
  s_add_u32 m0, s35, 0
  s_nop 0
  buffer_load_dwordx4 v40, s[16:19], s28 offen offset:0 sc1 lds
  buffer_load_dwordx4 v41, s[16:19], s28 offen offset:1024 sc1 lds
  buffer_load_dwordx4 v42, s[16:19], s28 offen offset:2048 sc1 lds
  buffer_load_dwordx4 v43, s[16:19], s28 offen offset:3072 sc1 lds
  s_add_u32 m0, s35, 4096
  s_nop 0
  buffer_load_dwordx4 v44, s[16:19], s28 offen offset:0 sc1 lds
  buffer_load_dwordx4 v45, s[16:19], s28 offen offset:1024 sc1 lds
  buffer_load_dwordx4 v46, s[16:19], s28 offen offset:2048 sc1 lds
  buffer_load_dwordx4 v47, s[16:19], s28 offen offset:3072 sc1 lds
  s_add_u32 m0, s35, 8192
  s_nop 0
  buffer_load_dwordx4 v40, s[16:19], s29 offen offset:0 sc1 lds
  buffer_load_dwordx4 v41, s[16:19], s29 offen offset:1024 sc1 lds
  buffer_load_dwordx4 v42, s[16:19], s29 offen offset:2048 sc1 lds
  buffer_load_dwordx4 v43, s[16:19], s29 offen offset:3072 sc1 lds
  s_add_u32 m0, s35, 12288
  s_nop 0
  buffer_load_dwordx4 v44, s[16:19], s29 offen offset:0 sc1 lds
  buffer_load_dwordx4 v45, s[16:19], s29 offen offset:1024 sc1 lds
  buffer_load_dwordx4 v46, s[16:19], s29 offen offset:2048 sc1 lds
  buffer_load_dwordx4 v47, s[16:19], s29 offen offset:3072 sc1 lds
  s_add_u32 s34, s34, 16384
  s_and_b32 s34, s34, 0xffff
  s_add_u32 s32, s32, 1
  s_cmp_eq_u32 s32, s46
  s_addc_u32 s32, s32, 0
  s_cmp_ge_u32 s32, 7
  s_cselect_b32 s32, 0, s32
  s_cmp_eq_u32 s32, s46
  s_addc_u32 s32, s32, 0
  s_cmp_eq_u32 s32, s38
  s_addc_u32 s33, s33, 0
  s_branch f_w2go
f_tailh1:
  s_barrier
  s_barrier
  s_waitcnt vmcnt(0)
  s_barrier
  s_mov_b32 s31, 23
  s_cmp_eq_u32 s5, 2
  s_cbranch_scc1 f_tail2
  v_lshlrev_b32 v21, 7, v0
  v_mov_b32 v20, 1
  s_mov_b32 s42, 33562624
  s_mov_b64 exec, 0xffff
  buffer_atomic_add v20, v21, s[56:59], s42 offen sc1
  s_mov_b64 exec, -1
  s_mov_b32 s31, 21
  s_branch f_tail1
f_tail0:
  s_mov_b32 s14, 4
  s_mov_b32 s12, 1
  s_barrier
  s_barrier
  s_barrier
f_hgo:
  v_add_u32 v56, 8192, v40
  v_add_u32 v57, 12288, v40
  s_lshl_b32 s42, s3, 8
  s_lshl_b32 s43, s44, 7
  s_add_u32 s42, s42, s43
  s_add_u32 s42, s42, 33558528
  s_add_u32 s13, s12, 2
  s_max_u32 s13, s13, 3
  s_mov_b64 s[8:9], 0
  s_mov_b64 s[10:11], 0
h_i_62:
  s_cmp_gt_u32 s14, s13
  s_cbranch_scc1 h_w_64
  s_cmp_eq_u32 s33, 1
  s_cselect_b32 s29, s9, s8
  s_cmp_eq_u32 s33, 2
  s_cselect_b32 s29, s10, s29
  s_cmp_eq_u32 s33, 3
  s_cselect_b32 s29, s11, s29
  s_lshl1_add_u32 s28, s32, 1
  s_bitcmp1_b32 s29, s28
  s_cbranch_scc1 h_g_63
  s_cmp_gt_u32 s14, s12
  s_cbranch_scc1 h_n_65
  s_mov_b32 s40, 0
sspin_70:
  s_load_dwordx4 s[8:11], s[56:57], s42 glc
  s_waitcnt lgkmcnt(0)
  s_cmp_eq_u32 s33, 1
  s_cselect_b32 s29, s9, s8
  s_cmp_eq_u32 s33, 2
  s_cselect_b32 s29, s10, s29
  s_cmp_eq_u32 s33, 3
  s_cselect_b32 s29, s11, s29
  s_lshl1_add_u32 s28, s32, 1
  s_bitcmp1_b32 s29, s28
  s_cbranch_scc1 sspun_71
  s_add_u32 s40, s40, 1
  s_cmp_lt_u32 s40, 65536
  s_cbranch_scc1 sspin_70
sspun_71:
h_g_63:
  s_waitcnt vmcnt(47)
  s_lshl_b32 s28, s32, 17
  s_lshl_b32 s29, s33, 14
  s_add_u32 s28, s28, s29
  s_add_u32 s35, s30, s34
  s_add_u32 s29, s28, s39
  s_add_u32 m0, s35, 0
  s_nop 0
  buffer_load_dwordx4 v40, s[16:19], s28 offen offset:0 sc1 lds
  buffer_load_dwordx4 v41, s[16:19], s28 offen offset:1024 sc1 lds
  buffer_load_dwordx4 v42, s[16:19], s28 offen offset:2048 sc1 lds
  buffer_load_dwordx4 v43, s[16:19], s28 offen offset:3072 sc1 lds
  s_add_u32 m0, s35, 4096
  s_nop 0
  buffer_load_dwordx4 v44, s[16:19], s28 offen offset:0 sc1 lds
  buffer_load_dwordx4 v45, s[16:19], s28 offen offset:1024 sc1 lds
  buffer_load_dwordx4 v46, s[16:19], s28 offen offset:2048 sc1 lds
  buffer_load_dwordx4 v47, s[16:19], s28 offen offset:3072 sc1 lds
  s_add_u32 m0, s35, 8192
  s_nop 0
  buffer_load_dwordx4 v40, s[16:19], s29 offen offset:0 sc1 lds
  buffer_load_dwordx4 v41, s[16:19], s29 offen offset:1024 sc1 lds
  buffer_load_dwordx4 v42, s[16:19], s29 offen offset:2048 sc1 lds
  buffer_load_dwordx4 v43, s[16:19], s29 offen offset:3072 sc1 lds
  s_add_u32 m0, s35, 12288
  s_nop 0
  buffer_load_dwordx4 v44, s[16:19], s29 offen offset:0 sc1 lds
  buffer_load_dwordx4 v45, s[16:19], s29 offen offset:1024 sc1 lds
  buffer_load_dwordx4 v46, s[16:19], s29 offen offset:2048 sc1 lds
  buffer_load_dwordx4 v47, s[16:19], s29 offen offset:3072 sc1 lds
  s_add_u32 s34, s34, 16384
  s_and_b32 s34, s34, 0xffff
  s_add_u32 s32, s32, 1
  s_cmp_eq_u32 s32, s46
  s_addc_u32 s32, s32, 0
  s_cmp_ge_u32 s32, 7
  s_cselect_b32 s32, 0, s32
  s_cmp_eq_u32 s32, s46
  s_addc_u32 s32, s32, 0
  s_cmp_eq_u32 s32, s38
  s_addc_u32 s33, s33, 0
  s_add_u32 s14, s14, 1
  s_branch h_i_62
h_n_65:
h_w_64:
  s_load_dwordx4 s[8:11], s[56:57], s42 glc
  s_sub_u32 s28, s14, s12
  s_cmp_eq_u32 s28, 3
  s_cbranch_scc0 h_w1_67
  s_lshl_b32 s28, s32, 17
  s_lshl_b32 s29, s33, 14
  s_add_u32 s28, s28, s29
  s_add_u32 s35, s30, s34
  s_mov_b32 m0, s35
  s_cmp_lt_u32 s14, 28
  s_cselect_b32 s26, -1, 0
  s_cmp_eq_u32 s33, 1
  s_cselect_b32 s29, s9, s8
  s_cmp_eq_u32 s33, 2
  s_cselect_b32 s29, s10, s29
  s_cmp_eq_u32 s33, 3
  s_cselect_b32 s29, s11, s29
  s_lshl1_add_u32 s27, s32, 1
  s_and_b32 s29, s29, s26
  s_bitcmp1_b32 s29, s27
  s_branch h_s_73
h_f_72:
  buffer_load_dwordx4 v40, s[16:19], s28 offen offset:0 sc1 lds
  s_add_u32 s32, s32, 1
  s_cmp_eq_u32 s32, s46
  s_addc_u32 s32, s32, 0
  buffer_load_dwordx4 v40, s[16:19], s28 offen offset:1024 sc1 lds
  s_cmp_ge_u32 s32, 7
  s_cselect_b32 s32, 0, s32
  buffer_load_dwordx4 v40, s[16:19], s28 offen offset:2048 sc1 lds
  s_cmp_eq_u32 s32, s46
  s_addc_u32 s32, s32, 0
  buffer_load_dwordx4 v40, s[16:19], s28 offen offset:3072 sc1 lds
  s_cmp_eq_u32 s32, s38
  s_addc_u32 s33, s33, 0
  s_add_u32 m0, s35, 4096
  s_nop 0
  buffer_load_dwordx4 v44, s[16:19], s28 offen offset:0 sc1 lds
  s_add_u32 s34, s34, 16384
  s_and_b32 s34, s34, 0xffff
  buffer_load_dwordx4 v44, s[16:19], s28 offen offset:1024 sc1 lds
  s_lshl_b32 s29, s32, 17
  s_lshl_b32 s26, s33, 14
  s_add_u32 s29, s29, s26
  buffer_load_dwordx4 v44, s[16:19], s28 offen offset:2048 sc1 lds
  s_add_u32 s14, s14, 1
  s_add_u32 s12, s12, 1
  buffer_load_dwordx4 v44, s[16:19], s28 offen offset:3072 sc1 lds
  s_cmp_eq_u32 s33, 1
  s_cselect_b32 s27, s9, s8
  s_cmp_eq_u32 s33, 2
  s_cselect_b32 s27, s10, s27
  s_add_u32 m0, s35, 8192
  s_nop 0
  buffer_load_dwordx4 v56, s[16:19], s28 offen offset:0 sc1 lds
  s_cmp_eq_u32 s33, 3
  s_cselect_b32 s27, s11, s27
  s_lshl1_add_u32 s37, s32, 1
  s_load_dwordx4 s[8:11], s[56:57], s42 glc
  buffer_load_dwordx4 v56, s[16:19], s28 offen offset:1024 sc1 lds
  s_cmp_lt_u32 s14, 28
  s_cselect_b32 s27, s27, 0
  buffer_load_dwordx4 v56, s[16:19], s28 offen offset:2048 sc1 lds
  buffer_load_dwordx4 v56, s[16:19], s28 offen offset:3072 sc1 lds
  s_add_u32 m0, s35, 12288
  s_nop 0
  buffer_load_dwordx4 v57, s[16:19], s28 offen offset:0 sc1 lds
  s_add_u32 s35, s30, s34
  s_bitcmp1_b32 s27, s37
  buffer_load_dwordx4 v57, s[16:19], s28 offen offset:1024 sc1 lds
  buffer_load_dwordx4 v57, s[16:19], s28 offen offset:2048 sc1 lds
  buffer_load_dwordx4 v57, s[16:19], s28 offen offset:3072 sc1 lds
  s_mov_b32 s28, s29
  s_mov_b32 m0, s35
h_s_73:
  s_waitcnt vmcnt(32)
  s_barrier
  s_cbranch_scc1 h_f_72
  s_branch h_c_61
  s_waitcnt vmcnt(32)
h_b_66:
  s_cmp_eq_u32 s12, 27
  s_cbranch_scc1 f_hend
  s_barrier
h_c_61:
  s_add_u32 s12, s12, 1
  s_add_u32 s13, s12, 2
  s_min_u32 s13, s13, 27
  s_branch h_i_62
h_w1_67:
  s_cmp_eq_u32 s28, 2
  s_cbranch_scc0 h_w2_68
  s_waitcnt vmcnt(16)
  s_branch h_b_66
h_w2_68:
  s_cmp_eq_u32 s28, 1
  s_cbranch_scc0 h_w3_69
  s_waitcnt vmcnt(0)
  s_branch h_b_66
h_w3_69:
  s_waitcnt vmcnt(48)
  s_branch h_b_66
f_hend:
  s_waitcnt vmcnt(0) lgkmcnt(0)
  s_barrier
  v_lshrrev_b32 v2, 4, v0
  v_and_b32 v3, 15, v0
  v_lshlrev_b32 v4, 11, v2
  v_lshl_add_u32 v4, v3, 4, v4
  v_xor_b32 v3, v3, v2
  s_lshl_b32 s28, s5, 13
  s_add_u32 s28, s28, 81920
  v_lshl_add_u32 v2, v2, 8, s28
  v_lshl_add_u32 v40, v3, 4, v2
  v_xor_b32 v41, 64, v40
  v_xor_b32 v42, 128, v40
  v_xor_b32 v43, 192, v40
  s_lshl_b32 s28, s3, 2
  s_add_u32 s28, s28, s5
  s_lshl_b32 s40, s28, 9
  s_lshl1_add_u32 s29, s45, s44
  s_lshl_b32 s29, s29, 2
  s_add_u32 s40, s40, s29
  s_add_u32 s40, s40, 33570816
  s_lshl_b32 s28, s28, 17
  s_lshl_b32 s29, s44, 14
  s_add_u32 s28, s28, s29
  s_lshl_b32 s29, s45, 8
  s_add_u32 s28, s28, s29
  s_add_u32 s28, s28, 41943040
  s_add_u32 s29, s28, 8192
  s_add_u32 s30, s28, 32768
  s_add_u32 s31, s28, 40960
  s_add_u32 s32, s28, 65536
  s_add_u32 s33, s28, 73728
  s_add_u32 s34, s28, 98304
  s_add_u32 s35, s28, 106496
  v_lshlrev_b32 v6, 7, v0
  v_mov_b32 v7, 1
  s_barrier
  ds_read_b128 v[8:11], v40 offset:0
  ds_read_b128 v[12:15], v41 offset:1024
  ds_read_b128 v[16:19], v42 offset:2048
  ds_read_b128 v[20:23], v43 offset:3072
  ds_read_b128 v[24:27], v40 offset:4096
  ds_read_b128 v[28:31], v41 offset:5120
  ds_read_b128 v[32:35], v42 offset:6144
  ds_read_b128 v[36:39], v43 offset:7168
  s_waitcnt lgkmcnt(7)
  buffer_store_dwordx4 v[8:11], v4, s[56:59], s28 offen sc1
  s_waitcnt lgkmcnt(6)
  buffer_store_dwordx4 v[12:15], v4, s[56:59], s29 offen sc1
  s_barrier
  s_waitcnt lgkmcnt(5)
  buffer_store_dwordx4 v[16:19], v4, s[56:59], s30 offen sc1
  s_waitcnt lgkmcnt(4)
  buffer_store_dwordx4 v[20:23], v4, s[56:59], s31 offen sc1
  s_waitcnt lgkmcnt(3)
  buffer_store_dwordx4 v[24:27], v4, s[56:59], s32 offen sc1
  s_waitcnt lgkmcnt(2)
  buffer_store_dwordx4 v[28:31], v4, s[56:59], s33 offen sc1
  s_waitcnt lgkmcnt(1)
  buffer_store_dwordx4 v[32:35], v4, s[56:59], s34 offen sc1
  s_waitcnt lgkmcnt(0)
  buffer_store_dwordx4 v[36:39], v4, s[56:59], s35 offen sc1
  s_waitcnt vmcnt(0)
  s_mov_b64 exec, 0xf
  buffer_store_dword v7, v6, s[56:59], s40 offen sc1
  s_endpgm
f_tailh0:
  s_and_b32 s32, s3, 3
  s_mul_i32 s32, s32, 2
  s_cmp_eq_u32 s32, s46
  s_addc_u32 s32, s32, 0
  s_cmp_ge_u32 s32, 7
  s_cselect_b32 s32, 0, s32
  s_mov_b32 s38, s32
  s_mov_b32 s33, 0
  s_mov_b32 s34, 0
  s_mov_b32 s30, 0
  s_mov_b32 s16, s56
  s_mov_b32 s17, s57
  s_mov_b32 s18, s58
  s_mov_b32 s19, 0x20000
  s_mov_b32 s39, 8192
  s_mul_i32 s28, s3, 917504
  s_lshl_b32 s29, s44, 16
  s_add_u32 s28, s28, s29
  s_add_u32 s28, s28, 16777216
  v_add_u32 v40, s28, v1
  v_add_u32 v41, 0, v40
  v_add_u32 v42, 0, v40
  v_add_u32 v43, 0, v40
  v_add_u32 v44, 4096, v40
  v_add_u32 v45, 4096, v40
  v_add_u32 v46, 4096, v40
  v_add_u32 v47, 4096, v40
  s_mov_b32 s14, 0
  s_mov_b32 s12, 0
  s_branch f_hgo
f_midlo:
  s_mov_b32 s14, 0
  s_branch f_mid
f_midhi:
  s_waitcnt lgkmcnt(0)
  s_mov_b32 s56, s50
  s_and_b32 s57, s51, 0xffff
  s_mov_b32 s58, 0x3800000
  s_mov_b32 s59, 0x20000
  s_lshl_b32 s14, s3, 1
  s_add_u32 s14, s14, s44
  s_cmp_eq_u32 s5, 5
  s_cselect_b32 s14, s14, 99
  s_cmp_ge_u32 s14, 31
  s_cbranch_scc1 f_midz
  v_lshlrev_b32 v1, 4, v0
  v_mov_b32 v28, 0
  v_mov_b32 v29, 0
  v_mov_b32 v30, 0
  v_mov_b32 v31, 0
  s_lshl_b32 s28, s14, 11
  s_add_u32 s28, s28, 33554432
  buffer_store_dwordx4 v[28:31], v1, s[56:59], s28 offen sc1
  buffer_store_dwordx4 v[28:31], v1, s[56:59], s28 offen offset:1024 sc1
f_midz:
  v_mov_b32 v198, 146432
  v_mov_b32 v199, 0
  ds_write_b32 v198, v199
  s_waitcnt lgkmcnt(0)
  s_barrier
f_mid:
  s_lshr_b32 s21, s3, 2
  s_and_b32 s20, s3, 3
  s_lshl_b32 s28, s44, 2
  s_add_u32 s20, s20, s28
  s_and_b32 s6, s5, 3
  s_sub_u32 s28, 8, s21
  s_cmp_eq_u32 s21, 0
  s_cselect_b32 s28, 4, s28
  s_cmp_ge_u32 s5, 4
  s_cselect_b32 s7, s28, s21
  s_cselect_b32 s12, 66560, 0
  v_lshrrev_b32 v1, 4, v0
  v_and_b32 v2, 15, v0
  v_bfe_u32 v177, v0, 2, 2
  v_xor_b32 v177, v177, v1
  v_lshlrev_b32 v177, 6, v177
  v_lshl_add_u32 v177, v1, 8, v177
  v_and_b32 v178, 3, v0
  v_lshl_add_u32 v177, v178, 4, v177
  s_lshl_b32 s29, s7, 19
  s_lshl_b32 s30, s20, 16
  s_add_u32 s29, s29, s30
  s_lshl_b32 s30, s6, 14
  s_add_u32 s29, s29, s30
  s_add_u32 s29, s29, 4194304
  s_mul_i32 s30, s6, 16640
  s_add_u32 s30, s30, s12
  s_mov_b32 s16, s62
  s_and_b32 s17, s63, 0xffff
  s_mov_b32 s18, 0x201000
  s_mov_b32 s19, 0x20000
  s_mov_b32 s24, s64
  s_and_b32 s25, s65, 0xffff
  s_mov_b32 s26, 0x201000
  s_mov_b32 s27, 0x20000
  s_mul_i32 s37, s6, 32832
  s_lshl_b32 s28, s20, 7
  s_add_u32 s37, s37, s28
  s_mul_i32 s28, s21, 1026
  s_add_u32 s39, s37, s28
  s_mul_i32 s28, s7, 1026
  s_add_u32 s37, s37, s28
  s_and_b32 s37, s37, -4
  s_and_b32 s39, s39, -4
  v_and_b32 v115, 0x33, v0
  v_lshlrev_b32 v112, 2, v115
  v_and_b32 v115, 3, v115
  v_mad_u32_u24 v115, v115, 12, v112
  v_bfe_u32 v112, v0, 2, 2
  v_add_u32 v115, v115, v112
  v_mul_u32_u24 v115, 8208, v115
  v_add_u32 v115, 128, v115
  s_lshl_b32 s15, s5, 9
  s_add_u32 s15, s15, 133120
  v_lshl_add_u32 v116, v1, 6, s15
  v_bfe_u32 v112, v0, 3, 2
  v_lshrrev_b32 v113, 5, v0
  v_lshl_add_u32 v112, v112, 2, v113
  v_mul_u32_u24 v112, 131328, v112
  v_and_b32 v113, 7, v0
  v_lshl_add_u32 v112, v113, 4, v112
  s_mul_i32 s34, s6, 16640
  v_lshl_add_u32 v114, v0, 3, s30
  s_cmp_lt_u32 s5, 4
  s_cbranch_scc1 mid_up_75
  s_cmp_ge_u32 s14, 31
  s_cbranch_scc1 mid_nboot_76
  v_mov_b32 v180, 0
  v_mov_b32 v181, 1
  s_waitcnt vmcnt(0)
  s_mov_b64 exec, 1
  global_atomic_add v180, v181, s[54:55] sc1
  s_mov_b64 exec, -1
mid_nboot_76:
mid_up_75:
  v_cvt_f32_u32 v148, v2
  v_cvt_f32_u32 v149, v1
  v_mul_f32 v150, 0x3d800000, v148
  v_add_f32 v151, v149, v149
  v_mul_f32 v151, v151, v150
  v_fmamk_f32 v156, v150, 0x00000000, v151
  v_cos_f32 v154, v156
  v_sin_f32 v155, v156
  v_fmamk_f32 v160, v150, 0x3f800000, v151
  v_cos_f32 v158, v160
  v_sin_f32 v159, v160
  v_cvt_pk_bf16_f32 v32, v154, v155
  v_cvt_pk_bf16_f32 v36, -v155, v154
  v_cvt_pk_bf16_f32 v40, v154, -v155
  v_cvt_pk_bf16_f32 v44, v155, v154
  v_fmamk_f32 v164, v150, 0x41000000, v151
  v_cos_f32 v162, v164
  v_sin_f32 v163, v164
  v_cvt_pk_bf16_f32 v33, v158, v159
  v_cvt_pk_bf16_f32 v37, -v159, v158
  v_cvt_pk_bf16_f32 v41, v158, -v159
  v_cvt_pk_bf16_f32 v45, v159, v158
  v_fmamk_f32 v168, v150, 0x41100000, v151
  v_cos_f32 v166, v168
  v_sin_f32 v167, v168
  v_cvt_pk_bf16_f32 v34, v162, v163
  v_cvt_pk_bf16_f32 v38, -v163, v162
  v_cvt_pk_bf16_f32 v42, v162, -v163
  v_cvt_pk_bf16_f32 v46, v163, v162
  v_cvt_pk_bf16_f32 v35, v166, v167
  v_cvt_pk_bf16_f32 v39, -v167, v166
  v_cvt_pk_bf16_f32 v43, v166, -v167
  v_cvt_pk_bf16_f32 v47, v167, v166
  s_cmp_lt_u32 s5, 4
  s_cbranch_scc1 mid_up_77
  s_add_u32 s38, s37, 0
  s_add_u32 m0, s30, 0
  s_nop 0
  buffer_load_dwordx4 v112, s[16:19], s38 offen lds
  s_add_u32 m0, s30, 8192
  s_nop 0
  buffer_load_dwordx4 v112, s[24:27], s38 offen lds
  s_add_u32 s38, s37, 262656
  s_add_u32 m0, s30, 1024
  s_nop 0
  buffer_load_dwordx4 v112, s[16:19], s38 offen lds
  s_add_u32 m0, s30, 9216
  s_nop 0
  buffer_load_dwordx4 v112, s[24:27], s38 offen lds
  s_add_u32 s38, s37, 8208
  s_add_u32 m0, s30, 2048
  s_nop 0
  buffer_load_dwordx4 v112, s[16:19], s38 offen lds
  s_add_u32 m0, s30, 10240
  s_nop 0
  buffer_load_dwordx4 v112, s[24:27], s38 offen lds
  s_add_u32 s38, s37, 270864
  s_add_u32 m0, s30, 3072
  s_nop 0
  buffer_load_dwordx4 v112, s[16:19], s38 offen lds
  s_add_u32 m0, s30, 11264
  s_nop 0
  buffer_load_dwordx4 v112, s[24:27], s38 offen lds
mid_up_77:
  s_lshl_b32 s28, s6, 2
  v_lshl_add_u32 v152, v2, 4, s28
  v_cvt_f32_u32 v152, v152
  v_mul_f32 v152, 0x3b800000, v152
  v_add_f32 v153, v149, v149
  v_mul_f32 v151, v153, v152
  v_fmamk_f32 v156, v152, 0x00000000, v151
  v_cos_f32 v154, v156
  v_sin_f32 v155, v156
  v_fmamk_f32 v160, v152, 0x3f800000, v151
  v_cos_f32 v158, v160
  v_sin_f32 v159, v160
  v_cvt_pk_bf16_f32 v192, v154, v155
  v_cvt_pk_bf16_f32 v196, -v155, v154
  v_fmamk_f32 v164, v152, 0x41000000, v151
  v_cos_f32 v162, v164
  v_sin_f32 v163, v164
  v_cvt_pk_bf16_f32 v193, v158, v159
  v_cvt_pk_bf16_f32 v197, -v159, v158
  v_fmamk_f32 v168, v152, 0x41100000, v151
  v_cos_f32 v166, v168
  v_sin_f32 v167, v168
  v_cvt_pk_bf16_f32 v194, v162, v163
  v_cvt_pk_bf16_f32 v198, -v163, v162
  v_add_f32 v152, 0x3b800000, v152
  v_mul_f32 v151, v153, v152
  v_fmamk_f32 v156, v152, 0x00000000, v151
  v_cos_f32 v154, v156
  v_sin_f32 v155, v156
  v_cvt_pk_bf16_f32 v195, v166, v167
  v_cvt_pk_bf16_f32 v199, -v167, v166
  v_fmamk_f32 v160, v152, 0x3f800000, v151
  v_cos_f32 v158, v160
  v_sin_f32 v159, v160
  v_cvt_pk_bf16_f32 v200, v154, v155
  v_cvt_pk_bf16_f32 v204, -v155, v154
  v_fmamk_f32 v164, v152, 0x41000000, v151
  v_cos_f32 v162, v164
  v_sin_f32 v163, v164
  v_cvt_pk_bf16_f32 v201, v158, v159
  v_cvt_pk_bf16_f32 v205, -v159, v158
  v_fmamk_f32 v168, v152, 0x41100000, v151
  v_cos_f32 v166, v168
  v_sin_f32 v167, v168
  v_cvt_pk_bf16_f32 v202, v162, v163
  v_cvt_pk_bf16_f32 v206, -v163, v162
  v_add_f32 v152, 0x3b800000, v152
  v_mul_f32 v151, v153, v152
  v_fmamk_f32 v156, v152, 0x00000000, v151
  v_cos_f32 v154, v156
  v_sin_f32 v155, v156
  v_cvt_pk_bf16_f32 v203, v166, v167
  v_cvt_pk_bf16_f32 v207, -v167, v166
  v_fmamk_f32 v160, v152, 0x3f800000, v151
  v_cos_f32 v158, v160
  v_sin_f32 v159, v160
  v_cvt_pk_bf16_f32 v208, v154, v155
  v_cvt_pk_bf16_f32 v212, -v155, v154
  v_fmamk_f32 v164, v152, 0x41000000, v151
  v_cos_f32 v162, v164
  v_sin_f32 v163, v164
  v_cvt_pk_bf16_f32 v209, v158, v159
  v_cvt_pk_bf16_f32 v213, -v159, v158
  v_fmamk_f32 v168, v152, 0x41100000, v151
  v_cos_f32 v166, v168
  v_sin_f32 v167, v168
  v_cvt_pk_bf16_f32 v210, v162, v163
  v_cvt_pk_bf16_f32 v214, -v163, v162
  v_add_f32 v152, 0x3b800000, v152
  v_mul_f32 v151, v153, v152
  v_fmamk_f32 v156, v152, 0x00000000, v151
  v_cos_f32 v154, v156
  v_sin_f32 v155, v156
  v_cvt_pk_bf16_f32 v211, v166, v167
  v_cvt_pk_bf16_f32 v215, -v167, v166
  v_fmamk_f32 v160, v152, 0x3f800000, v151
  v_cos_f32 v158, v160
  v_sin_f32 v159, v160
  v_cvt_pk_bf16_f32 v216, v154, v155
  v_cvt_pk_bf16_f32 v220, -v155, v154
  v_fmamk_f32 v164, v152, 0x41000000, v151
  v_cos_f32 v162, v164
  v_sin_f32 v163, v164
  v_cvt_pk_bf16_f32 v217, v158, v159
  v_cvt_pk_bf16_f32 v221, -v159, v158
  v_fmamk_f32 v168, v152, 0x41100000, v151
  v_cos_f32 v166, v168
  v_sin_f32 v167, v168
  v_cvt_pk_bf16_f32 v218, v162, v163
  v_cvt_pk_bf16_f32 v222, -v163, v162
  s_cmp_lt_u32 s5, 4
  s_cbranch_scc1 mid_up_78
  s_bitcmp0_b32 s21, 0
  s_cbranch_scc1 mid_even_79
  s_sub_u32 m0, s15, 0
  s_nop 0
  buffer_load_dword v115, s[16:19], s37 offen lds
  s_sub_u32 m0, s15, -256
  s_nop 0
  buffer_load_dword v115, s[24:27], s37 offen lds
  s_sub_u32 m0, s15, 2048
  s_nop 0
  buffer_load_dword v115, s[16:19], s39 offen lds
  s_sub_u32 m0, s15, 1792
  s_nop 0
  buffer_load_dword v115, s[24:27], s39 offen lds
mid_even_79:
  s_add_u32 s38, s37, 16416
  s_add_u32 m0, s30, 4096
  s_nop 0
  buffer_load_dwordx4 v112, s[16:19], s38 offen lds
  s_add_u32 m0, s30, 12288
  s_nop 0
  buffer_load_dwordx4 v112, s[24:27], s38 offen lds
  s_add_u32 s38, s37, 279072
  s_add_u32 m0, s30, 5120
  s_nop 0
  buffer_load_dwordx4 v112, s[16:19], s38 offen lds
  s_add_u32 m0, s30, 13312
  s_nop 0
  buffer_load_dwordx4 v112, s[24:27], s38 offen lds
  s_add_u32 s38, s37, 24624
  s_add_u32 m0, s30, 6144
  s_nop 0
  buffer_load_dwordx4 v112, s[16:19], s38 offen lds
  s_add_u32 m0, s30, 14336
  s_nop 0
  buffer_load_dwordx4 v112, s[24:27], s38 offen lds
  s_add_u32 s38, s37, 287280
  s_add_u32 m0, s30, 7168
  s_nop 0
  buffer_load_dwordx4 v112, s[16:19], s38 offen lds
  s_add_u32 m0, s30, 15360
  s_nop 0
  buffer_load_dwordx4 v112, s[24:27], s38 offen lds
  s_add_u32 s38, s39, 0
  s_add_u32 m0, s34, 0
  s_nop 0
  buffer_load_dwordx4 v112, s[16:19], s38 offen lds
  s_add_u32 m0, s34, 8192
  s_nop 0
  buffer_load_dwordx4 v112, s[24:27], s38 offen lds
  s_add_u32 s38, s39, 262656
  s_add_u32 m0, s34, 1024
  s_nop 0
  buffer_load_dwordx4 v112, s[16:19], s38 offen lds
  s_add_u32 m0, s34, 9216
  s_nop 0
  buffer_load_dwordx4 v112, s[24:27], s38 offen lds
  s_add_u32 s38, s39, 8208
  s_add_u32 m0, s34, 2048
  s_nop 0
  buffer_load_dwordx4 v112, s[16:19], s38 offen lds
  s_add_u32 m0, s34, 10240
  s_nop 0
  buffer_load_dwordx4 v112, s[24:27], s38 offen lds
  s_add_u32 s38, s39, 270864
  s_add_u32 m0, s34, 3072
  s_nop 0
  buffer_load_dwordx4 v112, s[16:19], s38 offen lds
  s_add_u32 m0, s34, 11264
  s_nop 0
  buffer_load_dwordx4 v112, s[24:27], s38 offen lds
mid_up_78:
  s_cmp_ge_u32 s5, 4
  s_cbranch_scc1 mid_nosig_80
  v_mov_b32 v130, 0
  global_load_dword v131, v130, s[54:55] sc1
  v_mov_b32 v128, 146432
  v_mov_b32 v129, 1
  s_waitcnt vmcnt(0)
  s_mov_b64 exec, 1
  ds_add_rtn_u32 v129, v128, v129
  s_mov_b64 exec, -1
  s_waitcnt lgkmcnt(0)
  v_readfirstlane_b32 s40, v129
  s_nop 1
  s_cmp_lg_u32 s40, 7
  s_cbranch_scc1 mid_nosig_80
  s_mov_b32 s40, 0
  s_waitcnt vmcnt(0)
boot_81:
  v_readfirstlane_b32 s41, v131
  s_nop 1
  s_cmp_ge_u32 s41, 31
  s_cbranch_scc1 booted_82
  global_load_dword v131, v130, s[54:55] sc1
  s_add_u32 s40, s40, 1
  s_cmp_lt_u32 s40, 65536
  s_waitcnt vmcnt(0)
  s_cbranch_scc1 boot_81
booted_82:
  s_lshl_b32 s42, s3, 7
  s_add_u32 s42, s42, 33554432
  v_mov_b32 v128, 1
  s_mov_b64 exec, 1
  buffer_atomic_add v128, off, s[56:59], s42 sc1
  s_mov_b64 exec, -1
mid_nosig_80:
  v_lshl_add_u32 v151, v1, 6, s28
  v_cvt_f32_u32 v151, v151
  v_mul_f32 v152, 0x3b800000, v148
  v_mul_f32 v151, v151, v152
  v_fmamk_f32 v156, v152, 0x00000000, v151
  v_cos_f32 v154, v156
  v_sin_f32 v155, v156
  v_cvt_pk_bf16_f32 v219, v166, v167
  v_cvt_pk_bf16_f32 v223, -v167, v166
  v_fmamk_f32 v160, v152, 0x41800000, v151
  v_cos_f32 v158, v160
  v_sin_f32 v159, v160
  v_cvt_pk_bf16_f32 v224, v154, -v155
  v_cvt_pk_bf16_f32 v228, v155, v154
  v_fmamk_f32 v164, v152, 0x42000000, v151
  v_cos_f32 v162, v164
  v_sin_f32 v163, v164
  v_cvt_pk_bf16_f32 v225, v158, -v159
  v_cvt_pk_bf16_f32 v229, v159, v158
  v_fmamk_f32 v168, v152, 0x42400000, v151
  v_cos_f32 v166, v168
  v_sin_f32 v167, v168
  v_cvt_pk_bf16_f32 v226, v162, -v163
  v_cvt_pk_bf16_f32 v230, v163, v162
  v_fmamk_f32 v156, v152, 0x3f800000, v151
  v_cos_f32 v154, v156
  v_sin_f32 v155, v156
  v_cvt_pk_bf16_f32 v227, v166, -v167
  v_cvt_pk_bf16_f32 v231, v167, v166
  v_fmamk_f32 v160, v152, 0x41880000, v151
  v_cos_f32 v158, v160
  v_sin_f32 v159, v160
  v_cvt_pk_bf16_f32 v232, v154, -v155
  v_cvt_pk_bf16_f32 v236, v155, v154
  v_fmamk_f32 v164, v152, 0x42040000, v151
  v_cos_f32 v162, v164
  v_sin_f32 v163, v164
  v_cvt_pk_bf16_f32 v233, v158, -v159
  v_cvt_pk_bf16_f32 v237, v159, v158
  v_fmamk_f32 v168, v152, 0x42440000, v151
  v_cos_f32 v166, v168
  v_sin_f32 v167, v168
  v_cvt_pk_bf16_f32 v234, v162, -v163
  v_cvt_pk_bf16_f32 v238, v163, v162
  v_fmamk_f32 v156, v152, 0x40000000, v151
  v_cos_f32 v154, v156
  v_sin_f32 v155, v156
  v_cvt_pk_bf16_f32 v235, v166, -v167
  v_cvt_pk_bf16_f32 v239, v167, v166
  v_fmamk_f32 v160, v152, 0x41900000, v151
  v_cos_f32 v158, v160
  v_sin_f32 v159, v160
  v_cvt_pk_bf16_f32 v240, v154, -v155
  v_cvt_pk_bf16_f32 v244, v155, v154
  v_fmamk_f32 v164, v152, 0x42080000, v151
  v_cos_f32 v162, v164
  v_sin_f32 v163, v164
  v_cvt_pk_bf16_f32 v241, v158, -v159
  v_cvt_pk_bf16_f32 v245, v159, v158
  v_fmamk_f32 v168, v152, 0x42480000, v151
  v_cos_f32 v166, v168
  v_sin_f32 v167, v168
  v_cvt_pk_bf16_f32 v242, v162, -v163
  v_cvt_pk_bf16_f32 v246, v163, v162
  v_fmamk_f32 v156, v152, 0x40400000, v151
  v_cos_f32 v154, v156
  v_sin_f32 v155, v156
  v_cvt_pk_bf16_f32 v243, v166, -v167
  v_cvt_pk_bf16_f32 v247, v167, v166
  v_fmamk_f32 v160, v152, 0x41980000, v151
  v_cos_f32 v158, v160
  v_sin_f32 v159, v160
  v_cvt_pk_bf16_f32 v248, v154, -v155
  v_cvt_pk_bf16_f32 v252, v155, v154
  v_fmamk_f32 v164, v152, 0x420c0000, v151
  v_cos_f32 v162, v164
  v_sin_f32 v163, v164
  v_cvt_pk_bf16_f32 v249, v158, -v159
  v_cvt_pk_bf16_f32 v253, v159, v158
  v_fmamk_f32 v168, v152, 0x424c0000, v151
  v_cos_f32 v166, v168
  v_sin_f32 v167, v168
  v_cvt_pk_bf16_f32 v250, v162, -v163
  v_cvt_pk_bf16_f32 v254, v163, v162
  v_cvt_pk_bf16_f32 v251, v166, -v167
  v_cvt_pk_bf16_f32 v255, v167, v166
  s_cmp_lt_u32 s5, 4
  s_cbranch_scc1 mid_up_83
  s_add_u32 s38, s39, 16416
  s_add_u32 m0, s34, 4096
  s_nop 0
  buffer_load_dwordx4 v112, s[16:19], s38 offen lds
  s_add_u32 m0, s34, 12288
  s_nop 0
  buffer_load_dwordx4 v112, s[24:27], s38 offen lds
  s_add_u32 s38, s39, 279072
  s_add_u32 m0, s34, 5120
  s_nop 0
  buffer_load_dwordx4 v112, s[16:19], s38 offen lds
  s_add_u32 m0, s34, 13312
  s_nop 0
  buffer_load_dwordx4 v112, s[24:27], s38 offen lds
  s_add_u32 s38, s39, 24624
  s_add_u32 m0, s34, 6144
  s_nop 0
  buffer_load_dwordx4 v112, s[16:19], s38 offen lds
  s_add_u32 m0, s34, 14336
  s_nop 0
  buffer_load_dwordx4 v112, s[24:27], s38 offen lds
  s_add_u32 s38, s39, 287280
  s_add_u32 m0, s34, 7168
  s_nop 0
  buffer_load_dwordx4 v112, s[16:19], s38 offen lds
  s_add_u32 m0, s34, 15360
  s_nop 0
  buffer_load_dwordx4 v112, s[24:27], s38 offen lds
mid_up_83:
  s_lshl_b32 s28, s6, 6
  v_add_u32 v20, s28, v0
  v_lshl_add_u32 v178, v20, 3, s7
  v_sub_u32 v179, 2048, v178
  v_bfe_u32 v21, v179, 3, 8
  v_and_b32 v179, 7, v179
  v_lshlrev_b32 v179, 11, v179
  v_lshl_add_u32 v179, v21, 3, v179
  s_lshl_b32 s28, s7, 11
  v_lshl_add_u32 v178, v20, 3, s28
  s_lshr_b32 s28, s5, 2
  s_xor_b32 s31, s28, 1
  s_cmp_eq_u32 s21, 0
  s_cselect_b32 s31, s28, s31
  s_lshl_b32 s28, s28, 11
  s_lshl_b32 s31, s31, 11
  s_add_u32 s28, s28, 133120
  s_add_u32 s31, s31, 133120
  v_lshl_add_u32 v20, v20, 3, s28
  v_lshl_add_u32 v21, v21, 3, s31
  s_mov_b32 s13, s28
  v_bfe_u32 v180, v0, 3, 1
  v_lshl_add_u32 v180, v1, 1, v180
  v_and_b32 v181, 7, v0
  v_lshlrev_b32 v181, 3, v181
  v_and_b32 v182, 3, v180
  v_lshl_add_u32 v182, v182, 6, v181
  v_lshl_add_u32 v182, v180, 8, v182
  v_add_u32 v182, s30, v182
  v_lshrrev_b32 v184, 1, v2
  v_xor_b32 v184, v184, v1
  v_lshlrev_b32 v184, 3, v184
  v_and_b32 v183, 3, v2
  v_lshl_add_u32 v183, v183, 6, v184
  v_lshl_add_u32 v183, v2, 8, v183
  v_add_u32 v183, s30, v183
  v_xor_b32 v4, 0, v182
  v_xor_b32 v8, 0, v183
  v_xor_b32 v9, 32, v183
  v_xor_b32 v5, 64, v182
  v_xor_b32 v10, 64, v183
  v_xor_b32 v11, 96, v183
  v_xor_b32 v6, 128, v182
  v_xor_b32 v12, 128, v183
  v_xor_b32 v13, 160, v183
  v_xor_b32 v7, 192, v182
  v_xor_b32 v14, 192, v183
  v_xor_b32 v15, 224, v183
  s_lshl_b32 s28, s6, 10
  s_add_u32 s28, s28, s12
  s_lshl_b32 s35, s6, 4
  v_mul_u32_u24 v16, 4160, v180
  v_add3_u32 v16, v16, v181, s28
  v_xor_b32 v16, s35, v16
  v_xor_b32 v17, 8, v16
  v_mul_u32_u24 v18, 4160, v2
  v_add3_u32 v18, v18, v184, s28
  v_xor_b32 v19, 32, v18
  v_lshlrev_b32 v3, 20, v1
  v_lshl_add_u32 v3, v2, 4, v3
  s_lshl_b32 s32, s6, 16
  s_lshl_b32 s33, s7, 11
  s_add_u32 s32, s32, s33
  s_lshl_b32 s33, s20, 8
  s_add_u32 s32, s32, s33
  s_add_u32 s32, s32, 8388608
  s_mov_b32 s36, 0xffff0000
  s_cmp_ge_u32 s5, 4
  s_cbranch_scc1 mid_nobl_84
  v_lshrrev_b32 v136, 4, v0
  v_and_b32 v137, 15, v0
  v_lshlrev_b32 v136, 11, v136
  v_lshl_add_u32 v136, v137, 4, v136
  v_mov_b32 v140, -1
  v_mov_b32 v141, -1
  v_mov_b32 v142, -1
  v_mov_b32 v143, -1
  s_lshl_b32 s28, s3, 2
  s_add_u32 s28, s28, s5
  s_lshl_b32 s28, s28, 17
  s_lshl_b32 s31, s44, 14
  s_add_u32 s28, s28, s31
  s_add_u32 s28, s28, 41944832
  buffer_store_dwordx4 v[140:143], v136, s[56:59], s28 offen sc1
  s_add_u32 s28, s28, 8192
  buffer_store_dwordx4 v[140:143], v136, s[56:59], s28 offen sc1
  s_add_u32 s28, s28, 24576
  buffer_store_dwordx4 v[140:143], v136, s[56:59], s28 offen sc1
  s_add_u32 s28, s28, 8192
  buffer_store_dwordx4 v[140:143], v136, s[56:59], s28 offen sc1
  s_add_u32 s28, s28, 24576
  buffer_store_dwordx4 v[140:143], v136, s[56:59], s28 offen sc1
  s_add_u32 s28, s28, 8192
  buffer_store_dwordx4 v[140:143], v136, s[56:59], s28 offen sc1
  s_add_u32 s28, s28, 24576
  buffer_store_dwordx4 v[140:143], v136, s[56:59], s28 offen sc1
  s_add_u32 s28, s28, 8192
  buffer_store_dwordx4 v[140:143], v136, s[56:59], s28 offen sc1
mid_nobl_84:
  s_cmp_lt_u32 s5, 4
  s_cbranch_scc1 mid_up_85
  s_waitcnt vmcnt(16)
  s_bitcmp0_b32 s21, 0
  s_cbranch_scc1 mid_even_86
  ds_read_b128 v[144:147], v116 offset:0
  ds_read_b128 v[148:151], v116 offset:16
  ds_read_b128 v[152:155], v116 offset:32
  ds_read_b128 v[156:159], v116 offset:48
  ds_read_b128 v[160:163], v116 offset:256
  ds_read_b128 v[164:167], v116 offset:272
  ds_read_b128 v[168:171], v116 offset:288
  ds_read_b128 v[172:175], v116 offset:304
mid_even_86:
  ds_read2st64_b64 v[48:51], v114 offset0:0 offset1:16
  ds_read2st64_b64 v[52:55], v114 offset0:1 offset1:17
  ds_read2st64_b64 v[56:59], v114 offset0:2 offset1:18
  ds_read2st64_b64 v[60:63], v114 offset0:3 offset1:19
  ds_read2st64_b64 v[64:67], v114 offset0:4 offset1:20
  ds_read2st64_b64 v[68:71], v114 offset0:5 offset1:21
  ds_read2st64_b64 v[72:75], v114 offset0:6 offset1:22
  ds_read2st64_b64 v[76:79], v114 offset0:7 offset1:23
  ds_read2st64_b64 v[80:83], v114 offset0:8 offset1:24
  ds_read2st64_b64 v[84:87], v114 offset0:9 offset1:25
  ds_read2st64_b64 v[88:91], v114 offset0:10 offset1:26
  ds_read2st64_b64 v[92:95], v114 offset0:11 offset1:27
  ds_read2st64_b64 v[96:99], v114 offset0:12 offset1:28
  ds_read2st64_b64 v[100:103], v114 offset0:13 offset1:29
  ds_read2st64_b64 v[104:107], v114 offset0:14 offset1:30
  ds_read2st64_b64 v[108:111], v114 offset0:15 offset1:31
  s_waitcnt vmcnt(0)
mid_up_85:
  s_barrier
  s_cmp_ge_u32 s5, 4
  s_cbranch_scc1 mid_hi2_87
  s_bitcmp0_b32 s21, 0
  s_cbranch_scc1 mid_even_88
  ds_read_b128 v[144:147], v116 offset:0
  ds_read_b128 v[148:151], v116 offset:16
  ds_read_b128 v[152:155], v116 offset:32
  ds_read_b128 v[156:159], v116 offset:48
  ds_read_b128 v[160:163], v116 offset:256
  ds_read_b128 v[164:167], v116 offset:272
  ds_read_b128 v[168:171], v116 offset:288
  ds_read_b128 v[172:175], v116 offset:304
mid_even_88:
  ds_read2st64_b64 v[48:51], v114 offset0:0 offset1:16
  ds_read2st64_b64 v[52:55], v114 offset0:1 offset1:17
  ds_read2st64_b64 v[56:59], v114 offset0:2 offset1:18
  ds_read2st64_b64 v[60:63], v114 offset0:3 offset1:19
  ds_read2st64_b64 v[64:67], v114 offset0:4 offset1:20
  ds_read2st64_b64 v[68:71], v114 offset0:5 offset1:21
  ds_read2st64_b64 v[72:75], v114 offset0:6 offset1:22
  ds_read2st64_b64 v[76:79], v114 offset0:7 offset1:23
  ds_read2st64_b64 v[80:83], v114 offset0:8 offset1:24
  ds_read2st64_b64 v[84:87], v114 offset0:9 offset1:25
  ds_read2st64_b64 v[88:91], v114 offset0:10 offset1:26
  ds_read2st64_b64 v[92:95], v114 offset0:11 offset1:27
  ds_read2st64_b64 v[96:99], v114 offset0:12 offset1:28
  ds_read2st64_b64 v[100:103], v114 offset0:13 offset1:29
  ds_read2st64_b64 v[104:107], v114 offset0:14 offset1:30
  ds_read2st64_b64 v[108:111], v114 offset0:15 offset1:31
mid_hi2_87:
  s_waitcnt lgkmcnt(0)
  s_cmp_lg_u32 s5, 4
  s_cbranch_scc1 mid_nopoll_89
  v_and_b32 v112, 15, v0
  v_lshlrev_b32 v112, 7, v112
  s_mov_b32 s42, 33554432
  s_mov_b32 s40, 0
spin_90:
  buffer_load_dword v113, v112, s[56:59], s42 offen sc1
  s_waitcnt vmcnt(0)
  v_cmp_gt_u32 vcc, 16, v113
  s_nop 1
  s_and_b32 s41, vcc_lo, 0xffff
  s_cbranch_scc0 spun_91
  s_add_u32 s40, s40, 1
  s_cmp_lt_u32 s40, 65536
  s_cbranch_scc1 spin_90
spun_91:
mid_nopoll_89:
  s_barrier
  s_add_u32 m0, s30, 0
  s_add_u32 s31, s29, 0
  buffer_load_dwordx4 v177, s[56:59], s31 offen offset:0 sc1 lds
  buffer_load_dwordx4 v177, s[56:59], s31 offen offset:1024 sc1 lds
  buffer_load_dwordx4 v177, s[56:59], s31 offen offset:2048 sc1 lds
  buffer_load_dwordx4 v177, s[56:59], s31 offen offset:3072 sc1 lds
  s_add_u32 m0, s30, 4160
  s_add_u32 s31, s29, 4096
  buffer_load_dwordx4 v177, s[56:59], s31 offen offset:0 sc1 lds
  buffer_load_dwordx4 v177, s[56:59], s31 offen offset:1024 sc1 lds
  buffer_load_dwordx4 v177, s[56:59], s31 offen offset:2048 sc1 lds
  buffer_load_dwordx4 v177, s[56:59], s31 offen offset:3072 sc1 lds
  s_add_u32 m0, s30, 8320
  s_add_u32 s31, s29, 8192
  buffer_load_dwordx4 v177, s[56:59], s31 offen offset:0 sc1 lds
  buffer_load_dwordx4 v177, s[56:59], s31 offen offset:1024 sc1 lds
  buffer_load_dwordx4 v177, s[56:59], s31 offen offset:2048 sc1 lds
  buffer_load_dwordx4 v177, s[56:59], s31 offen offset:3072 sc1 lds
  s_add_u32 m0, s30, 12480
  s_add_u32 s31, s29, 12288
  buffer_load_dwordx4 v177, s[56:59], s31 offen offset:0 sc1 lds
  buffer_load_dwordx4 v177, s[56:59], s31 offen offset:1024 sc1 lds
  buffer_load_dwordx4 v177, s[56:59], s31 offen offset:2048 sc1 lds
  buffer_load_dwordx4 v177, s[56:59], s31 offen offset:3072 sc1 lds
  s_mov_b32 s31, 34668544
  buffer_load_dwordx2 v[24:25], v178, s[56:59], s31 offen sc1
  buffer_load_dwordx2 v[28:29], v179, s[56:59], s31 offen sc1
  s_bitcmp0_b32 s21, 0
  s_cbranch_scc1 mid_even_92
  v_mov_b32_dpp v144, v48 row_shl:1 row_mask:0xf bank_mask:0xf
  v_mov_b32_dpp v160, v50 row_shl:1 row_mask:0xf bank_mask:0xf
  v_alignbit_b32 v48, v49, v48, 16
  v_alignbit_b32 v50, v51, v50, 16
  v_alignbit_b32 v49, v144, v49, 16
  v_alignbit_b32 v51, v160, v51, 16
  v_mov_b32_dpp v145, v52 row_shl:1 row_mask:0xf bank_mask:0xf
  v_mov_b32_dpp v161, v54 row_shl:1 row_mask:0xf bank_mask:0xf
  v_alignbit_b32 v52, v53, v52, 16
  v_alignbit_b32 v54, v55, v54, 16
  v_alignbit_b32 v53, v145, v53, 16
  v_alignbit_b32 v55, v161, v55, 16
  v_mov_b32_dpp v146, v56 row_shl:1 row_mask:0xf bank_mask:0xf
  v_mov_b32_dpp v162, v58 row_shl:1 row_mask:0xf bank_mask:0xf
  v_alignbit_b32 v56, v57, v56, 16
  v_alignbit_b32 v58, v59, v58, 16
  v_alignbit_b32 v57, v146, v57, 16
  v_alignbit_b32 v59, v162, v59, 16
  v_mov_b32_dpp v147, v60 row_shl:1 row_mask:0xf bank_mask:0xf
  v_mov_b32_dpp v163, v62 row_shl:1 row_mask:0xf bank_mask:0xf
  v_alignbit_b32 v60, v61, v60, 16
  v_alignbit_b32 v62, v63, v62, 16
  v_alignbit_b32 v61, v147, v61, 16
  v_alignbit_b32 v63, v163, v63, 16
  v_mov_b32_dpp v148, v64 row_shl:1 row_mask:0xf bank_mask:0xf
  v_mov_b32_dpp v164, v66 row_shl:1 row_mask:0xf bank_mask:0xf
  v_alignbit_b32 v64, v65, v64, 16
  v_alignbit_b32 v66, v67, v66, 16
  v_alignbit_b32 v65, v148, v65, 16
  v_alignbit_b32 v67, v164, v67, 16
  v_mov_b32_dpp v149, v68 row_shl:1 row_mask:0xf bank_mask:0xf
  v_mov_b32_dpp v165, v70 row_shl:1 row_mask:0xf bank_mask:0xf
  v_alignbit_b32 v68, v69, v68, 16
  v_alignbit_b32 v70, v71, v70, 16
  v_alignbit_b32 v69, v149, v69, 16
  v_alignbit_b32 v71, v165, v71, 16
  v_mov_b32_dpp v150, v72 row_shl:1 row_mask:0xf bank_mask:0xf
  v_mov_b32_dpp v166, v74 row_shl:1 row_mask:0xf bank_mask:0xf
  v_alignbit_b32 v72, v73, v72, 16
  v_alignbit_b32 v74, v75, v74, 16
  v_alignbit_b32 v73, v150, v73, 16
  v_alignbit_b32 v75, v166, v75, 16
  v_mov_b32_dpp v151, v76 row_shl:1 row_mask:0xf bank_mask:0xf
  v_mov_b32_dpp v167, v78 row_shl:1 row_mask:0xf bank_mask:0xf
  v_alignbit_b32 v76, v77, v76, 16
  v_alignbit_b32 v78, v79, v78, 16
  v_alignbit_b32 v77, v151, v77, 16
  v_alignbit_b32 v79, v167, v79, 16
  v_mov_b32_dpp v152, v80 row_shl:1 row_mask:0xf bank_mask:0xf
  v_mov_b32_dpp v168, v82 row_shl:1 row_mask:0xf bank_mask:0xf
  v_alignbit_b32 v80, v81, v80, 16
  v_alignbit_b32 v82, v83, v82, 16
  v_alignbit_b32 v81, v152, v81, 16
  v_alignbit_b32 v83, v168, v83, 16
  v_mov_b32_dpp v153, v84 row_shl:1 row_mask:0xf bank_mask:0xf
  v_mov_b32_dpp v169, v86 row_shl:1 row_mask:0xf bank_mask:0xf
  v_alignbit_b32 v84, v85, v84, 16
  v_alignbit_b32 v86, v87, v86, 16
  v_alignbit_b32 v85, v153, v85, 16
  v_alignbit_b32 v87, v169, v87, 16
  v_mov_b32_dpp v154, v88 row_shl:1 row_mask:0xf bank_mask:0xf
  v_mov_b32_dpp v170, v90 row_shl:1 row_mask:0xf bank_mask:0xf
  v_alignbit_b32 v88, v89, v88, 16
  v_alignbit_b32 v90, v91, v90, 16
  v_alignbit_b32 v89, v154, v89, 16
  v_alignbit_b32 v91, v170, v91, 16
  v_mov_b32_dpp v155, v92 row_shl:1 row_mask:0xf bank_mask:0xf
  v_mov_b32_dpp v171, v94 row_shl:1 row_mask:0xf bank_mask:0xf
  v_alignbit_b32 v92, v93, v92, 16
  v_alignbit_b32 v94, v95, v94, 16
  v_alignbit_b32 v93, v155, v93, 16
  v_alignbit_b32 v95, v171, v95, 16
  v_mov_b32_dpp v156, v96 row_shl:1 row_mask:0xf bank_mask:0xf
  v_mov_b32_dpp v172, v98 row_shl:1 row_mask:0xf bank_mask:0xf
  v_alignbit_b32 v96, v97, v96, 16
  v_alignbit_b32 v98, v99, v98, 16
  v_alignbit_b32 v97, v156, v97, 16
  v_alignbit_b32 v99, v172, v99, 16
  v_mov_b32_dpp v157, v100 row_shl:1 row_mask:0xf bank_mask:0xf
  v_mov_b32_dpp v173, v102 row_shl:1 row_mask:0xf bank_mask:0xf
  v_alignbit_b32 v100, v101, v100, 16
  v_alignbit_b32 v102, v103, v102, 16
  v_alignbit_b32 v101, v157, v101, 16
  v_alignbit_b32 v103, v173, v103, 16
  v_mov_b32_dpp v158, v104 row_shl:1 row_mask:0xf bank_mask:0xf
  v_mov_b32_dpp v174, v106 row_shl:1 row_mask:0xf bank_mask:0xf
  v_alignbit_b32 v104, v105, v104, 16
  v_alignbit_b32 v106, v107, v106, 16
  v_alignbit_b32 v105, v158, v105, 16
  v_alignbit_b32 v107, v174, v107, 16
  v_mov_b32_dpp v159, v108 row_shl:1 row_mask:0xf bank_mask:0xf
  v_mov_b32_dpp v175, v110 row_shl:1 row_mask:0xf bank_mask:0xf
  v_alignbit_b32 v108, v109, v108, 16
  v_alignbit_b32 v110, v111, v110, 16
  v_alignbit_b32 v109, v159, v109, 16
  v_alignbit_b32 v111, v175, v111, 16
mid_even_92:
  s_mov_b32 s24, s72
  s_and_b32 s25, s73, 0xffff
  s_mov_b32 s26, 0x700000
  s_mov_b32 s27, 0x20000
  s_lshl_b32 s28, s21, 3
  s_add_u32 s28, s28, s20
  s_lshl_b32 s28, s28, 3
  s_add_u32 s28, s28, s5
  s_mul_i32 s28, s28, 56
  v_add_u32 v23, s28, v0
  v_lshrrev_b32 v144, 10, v23
  v_bfe_u32 v145, v23, 9, 1
  v_and_b32 v23, 511, v23
  v_lshlrev_b32 v23, 7, v23
  v_lshl_add_u32 v23, v144, 19, v23
  v_lshl_add_u32 v23, v145, 17, v23
  v_cmp_gt_u32 vcc, 56, v0
  s_nop 1
  v_cndmask_b32 v23, -1, v23, vcc
  s_waitcnt vmcnt(14)
  ds_read_b64_tr_b16 v[112:113], v4 offset:0
  ds_read_b64_tr_b16 v[114:115], v4 offset:2048
  ds_read_b64_tr_b16 v[116:117], v5 offset:0
  ds_read_b64_tr_b16 v[118:119], v5 offset:2048
  ds_read_b64_tr_b16 v[120:121], v6 offset:0
  ds_read_b64_tr_b16 v[122:123], v6 offset:2048
  ds_read_b64_tr_b16 v[124:125], v7 offset:0
  ds_read_b64_tr_b16 v[126:127], v7 offset:2048
  s_waitcnt lgkmcnt(6)
  v_mfma_f32_16x16x32_bf16 v[144:147], v[112:115], v[32:35], 0
  v_mfma_f32_16x16x32_bf16 v[148:151], v[112:115], v[36:39], 0
  s_waitcnt lgkmcnt(4)
  v_mfma_f32_16x16x32_bf16 v[152:155], v[116:119], v[32:35], 0
  v_mfma_f32_16x16x32_bf16 v[156:159], v[116:119], v[36:39], 0
  s_waitcnt lgkmcnt(2)
  v_mfma_f32_16x16x32_bf16 v[160:163], v[120:123], v[32:35], 0
  v_mfma_f32_16x16x32_bf16 v[164:167], v[120:123], v[36:39], 0
  s_waitcnt lgkmcnt(0)
  v_mfma_f32_16x16x32_bf16 v[168:171], v[124:127], v[32:35], 0
  v_mfma_f32_16x16x32_bf16 v[172:175], v[124:127], v[36:39], 0
  s_waitcnt vmcnt(10)
  ds_read_b64_tr_b16 v[128:129], v4 offset:4160
  ds_read_b64_tr_b16 v[130:131], v4 offset:6208
  ds_read_b64_tr_b16 v[132:133], v5 offset:4160
  ds_read_b64_tr_b16 v[134:135], v5 offset:6208
  ds_read_b64_tr_b16 v[136:137], v6 offset:4160
  ds_read_b64_tr_b16 v[138:139], v6 offset:6208
  ds_read_b64_tr_b16 v[140:141], v7 offset:4160
  ds_read_b64_tr_b16 v[142:143], v7 offset:6208
  v_cvt_pk_bf16_f32 v176, v144, v145
  v_cvt_pk_bf16_f32 v177, v146, v147
  v_cvt_pk_bf16_f32 v178, v148, v149
  v_cvt_pk_bf16_f32 v179, v150, v151
  ds_write_b64 v8, v[176:177] offset:0
  ds_write_b64 v9, v[178:179] offset:0
  v_cvt_pk_bf16_f32 v180, v152, v153
  v_cvt_pk_bf16_f32 v181, v154, v155
  v_cvt_pk_bf16_f32 v182, v156, v157
  v_cvt_pk_bf16_f32 v183, v158, v159
  ds_write_b64 v10, v[180:181] offset:0
  ds_write_b64 v11, v[182:183] offset:0
  v_cvt_pk_bf16_f32 v184, v160, v161
  v_cvt_pk_bf16_f32 v185, v162, v163
  v_cvt_pk_bf16_f32 v186, v164, v165
  v_cvt_pk_bf16_f32 v187, v166, v167
  ds_write_b64 v12, v[184:185] offset:0
  ds_write_b64 v13, v[186:187] offset:0
  v_cvt_pk_bf16_f32 v188, v168, v169
  v_cvt_pk_bf16_f32 v189, v170, v171
  v_cvt_pk_bf16_f32 v190, v172, v173
  v_cvt_pk_bf16_f32 v191, v174, v175
  ds_write_b64 v14, v[188:189] offset:0
  ds_write_b64 v15, v[190:191] offset:0
  s_waitcnt lgkmcnt(14)
  v_mfma_f32_16x16x32_bf16 v[144:147], v[128:131], v[32:35], 0
  v_mfma_f32_16x16x32_bf16 v[148:151], v[128:131], v[36:39], 0
  s_waitcnt lgkmcnt(12)
  v_mfma_f32_16x16x32_bf16 v[152:155], v[132:135], v[32:35], 0
  v_mfma_f32_16x16x32_bf16 v[156:159], v[132:135], v[36:39], 0
  s_waitcnt lgkmcnt(10)
  v_mfma_f32_16x16x32_bf16 v[160:163], v[136:139], v[32:35], 0
  v_mfma_f32_16x16x32_bf16 v[164:167], v[136:139], v[36:39], 0
  s_waitcnt lgkmcnt(8)
  v_mfma_f32_16x16x32_bf16 v[168:171], v[140:143], v[32:35], 0
  v_mfma_f32_16x16x32_bf16 v[172:175], v[140:143], v[36:39], 0
  s_waitcnt vmcnt(6)
  ds_read_b64_tr_b16 v[112:113], v4 offset:8320
  ds_read_b64_tr_b16 v[114:115], v4 offset:10368
  ds_read_b64_tr_b16 v[116:117], v5 offset:8320
  ds_read_b64_tr_b16 v[118:119], v5 offset:10368
  ds_read_b64_tr_b16 v[120:121], v6 offset:8320
  ds_read_b64_tr_b16 v[122:123], v6 offset:10368
  ds_read_b64_tr_b16 v[124:125], v7 offset:8320
  ds_read_b64_tr_b16 v[126:127], v7 offset:10368
  v_cvt_pk_bf16_f32 v176, v144, v145
  v_cvt_pk_bf16_f32 v177, v146, v147
  v_cvt_pk_bf16_f32 v178, v148, v149
  v_cvt_pk_bf16_f32 v179, v150, v151
  ds_write_b64 v8, v[176:177] offset:4160
  ds_write_b64 v9, v[178:179] offset:4160
  v_cvt_pk_bf16_f32 v180, v152, v153
  v_cvt_pk_bf16_f32 v181, v154, v155
  v_cvt_pk_bf16_f32 v182, v156, v157
  v_cvt_pk_bf16_f32 v183, v158, v159
  ds_write_b64 v10, v[180:181] offset:4160
  ds_write_b64 v11, v[182:183] offset:4160
  v_cvt_pk_bf16_f32 v184, v160, v161
  v_cvt_pk_bf16_f32 v185, v162, v163
  v_cvt_pk_bf16_f32 v186, v164, v165
  v_cvt_pk_bf16_f32 v187, v166, v167
  ds_write_b64 v12, v[184:185] offset:4160
  ds_write_b64 v13, v[186:187] offset:4160
  v_cvt_pk_bf16_f32 v188, v168, v169
  v_cvt_pk_bf16_f32 v189, v170, v171
  v_cvt_pk_bf16_f32 v190, v172, v173
  v_cvt_pk_bf16_f32 v191, v174, v175
  ds_write_b64 v14, v[188:189] offset:4160
  ds_write_b64 v15, v[190:191] offset:4160
  s_waitcnt lgkmcnt(14)
  v_mfma_f32_16x16x32_bf16 v[144:147], v[112:115], v[32:35], 0
  v_mfma_f32_16x16x32_bf16 v[148:151], v[112:115], v[36:39], 0
  s_waitcnt lgkmcnt(12)
  v_mfma_f32_16x16x32_bf16 v[152:155], v[116:119], v[32:35], 0
  v_mfma_f32_16x16x32_bf16 v[156:159], v[116:119], v[36:39], 0
  s_waitcnt lgkmcnt(10)
  v_mfma_f32_16x16x32_bf16 v[160:163], v[120:123], v[32:35], 0
  v_mfma_f32_16x16x32_bf16 v[164:167], v[120:123], v[36:39], 0
  s_waitcnt lgkmcnt(8)
  v_mfma_f32_16x16x32_bf16 v[168:171], v[124:127], v[32:35], 0
  v_mfma_f32_16x16x32_bf16 v[172:175], v[124:127], v[36:39], 0
  s_waitcnt vmcnt(2)
  ds_read_b64_tr_b16 v[128:129], v4 offset:12480
  ds_read_b64_tr_b16 v[130:131], v4 offset:14528
  ds_read_b64_tr_b16 v[132:133], v5 offset:12480
  ds_read_b64_tr_b16 v[134:135], v5 offset:14528
  ds_read_b64_tr_b16 v[136:137], v6 offset:12480
  ds_read_b64_tr_b16 v[138:139], v6 offset:14528
  ds_read_b64_tr_b16 v[140:141], v7 offset:12480
  ds_read_b64_tr_b16 v[142:143], v7 offset:14528
  s_mov_b32 m0, 155648
  s_mov_b32 s31, 0
  buffer_load_dword v23, s[24:27], s31 offen lds
  v_cvt_pk_bf16_f32 v176, v144, v145
  v_cvt_pk_bf16_f32 v177, v146, v147
  v_cvt_pk_bf16_f32 v178, v148, v149
  v_cvt_pk_bf16_f32 v179, v150, v151
  ds_write_b64 v8, v[176:177] offset:8320
  ds_write_b64 v9, v[178:179] offset:8320
  v_cvt_pk_bf16_f32 v180, v152, v153
  v_cvt_pk_bf16_f32 v181, v154, v155
  v_cvt_pk_bf16_f32 v182, v156, v157
  v_cvt_pk_bf16_f32 v183, v158, v159
  ds_write_b64 v10, v[180:181] offset:8320
  ds_write_b64 v11, v[182:183] offset:8320
  v_cvt_pk_bf16_f32 v184, v160, v161
  v_cvt_pk_bf16_f32 v185, v162, v163
  v_cvt_pk_bf16_f32 v186, v164, v165
  v_cvt_pk_bf16_f32 v187, v166, v167
  ds_write_b64 v12, v[184:185] offset:8320
  ds_write_b64 v13, v[186:187] offset:8320
  v_cvt_pk_bf16_f32 v188, v168, v169
  v_cvt_pk_bf16_f32 v189, v170, v171
  v_cvt_pk_bf16_f32 v190, v172, v173
  v_cvt_pk_bf16_f32 v191, v174, v175
  ds_write_b64 v14, v[188:189] offset:8320
  ds_write_b64 v15, v[190:191] offset:8320
  s_waitcnt lgkmcnt(14)
  v_mfma_f32_16x16x32_bf16 v[144:147], v[128:131], v[32:35], 0
  v_mfma_f32_16x16x32_bf16 v[148:151], v[128:131], v[36:39], 0
  s_waitcnt lgkmcnt(12)
  v_mfma_f32_16x16x32_bf16 v[152:155], v[132:135], v[32:35], 0
  v_mfma_f32_16x16x32_bf16 v[156:159], v[132:135], v[36:39], 0
  s_waitcnt lgkmcnt(10)
  v_mfma_f32_16x16x32_bf16 v[160:163], v[136:139], v[32:35], 0
  v_mfma_f32_16x16x32_bf16 v[164:167], v[136:139], v[36:39], 0
  s_waitcnt lgkmcnt(8)
  v_mfma_f32_16x16x32_bf16 v[168:171], v[140:143], v[32:35], 0
  v_mfma_f32_16x16x32_bf16 v[172:175], v[140:143], v[36:39], 0
  v_cvt_pk_bf16_f32 v176, v144, v145
  v_cvt_pk_bf16_f32 v177, v146, v147
  v_cvt_pk_bf16_f32 v178, v148, v149
  v_cvt_pk_bf16_f32 v179, v150, v151
  ds_write_b64 v8, v[176:177] offset:12480
  ds_write_b64 v9, v[178:179] offset:12480
  v_cvt_pk_bf16_f32 v180, v152, v153
  v_cvt_pk_bf16_f32 v181, v154, v155
  v_cvt_pk_bf16_f32 v182, v156, v157
  v_cvt_pk_bf16_f32 v183, v158, v159
  ds_write_b64 v10, v[180:181] offset:12480
  ds_write_b64 v11, v[182:183] offset:12480
  v_cvt_pk_bf16_f32 v184, v160, v161
  v_cvt_pk_bf16_f32 v185, v162, v163
  v_cvt_pk_bf16_f32 v186, v164, v165
  v_cvt_pk_bf16_f32 v187, v166, v167
  ds_write_b64 v12, v[184:185] offset:12480
  ds_write_b64 v13, v[186:187] offset:12480
  v_cvt_pk_bf16_f32 v188, v168, v169
  v_cvt_pk_bf16_f32 v189, v170, v171
  v_cvt_pk_bf16_f32 v190, v172, v173
  v_cvt_pk_bf16_f32 v191, v174, v175
  ds_write_b64 v14, v[188:189] offset:12480
  ds_write_b64 v15, v[190:191] offset:12480
  v_xor_b32 v8, s35, v4
  v_xor_b32 v9, 8, v8
  v_xor_b32 v10, s35, v5
  v_xor_b32 v11, 8, v10
  v_xor_b32 v12, s35, v6
  v_xor_b32 v13, 8, v12
  v_xor_b32 v14, s35, v7
  v_xor_b32 v15, 8, v14
  s_waitcnt vmcnt(1) lgkmcnt(0)
  s_barrier
  ds_read_b64_tr_b16 v[112:113], v16 offset:64
  ds_read_b64_tr_b16 v[114:115], v16 offset:33344
  ds_read_b64_tr_b16 v[116:117], v16 offset:256
  ds_read_b64_tr_b16 v[118:119], v16 offset:33536
  ds_read_b64_tr_b16 v[120:121], v17 offset:704
  ds_read_b64_tr_b16 v[122:123], v17 offset:33984
  ds_read_b64_tr_b16 v[124:125], v17 offset:896
  ds_read_b64_tr_b16 v[126:127], v17 offset:34176
  s_cmp_eq_u32 s20, 0
  s_cselect_b32 s16, 0x00010001, 0
  s_mov_b32 s17, s16
  s_cmp_lg_u32 s20, 0
  s_cbranch_scc1 mid_nocol0_93
  ds_read_b64_tr_b16 v[128:129], v16 offset:0
  ds_read_b64_tr_b16 v[130:131], v16 offset:33280
  ds_read_b64_tr_b16 v[132:133], v16 offset:320
  ds_read_b64_tr_b16 v[134:135], v16 offset:33600
  ds_read_b64_tr_b16 v[136:137], v17 offset:640
  ds_read_b64_tr_b16 v[138:139], v17 offset:33920
  ds_read_b64_tr_b16 v[140:141], v17 offset:960
  ds_read_b64_tr_b16 v[142:143], v17 offset:34240
  s_lshl_b32 s28, s6, 5
  s_add_u32 s28, s28, s13
  v_lshl_add_u32 v22, v1, 9, s28
  s_waitcnt lgkmcnt(6)
  v_mfma_f32_16x16x32_bf16 v[144:147], v[192:195], v[128:131], 0
  v_mfma_f32_16x16x32_bf16 v[148:151], v[196:199], v[128:131], 0
  s_waitcnt lgkmcnt(4)
  v_mfma_f32_16x16x32_bf16 v[152:155], v[200:203], v[132:135], 0
  v_mfma_f32_16x16x32_bf16 v[156:159], v[204:207], v[132:135], 0
  s_waitcnt lgkmcnt(2)
  v_mfma_f32_16x16x32_bf16 v[160:163], v[208:211], v[136:139], 0
  v_mfma_f32_16x16x32_bf16 v[164:167], v[212:215], v[136:139], 0
  s_waitcnt lgkmcnt(0)
  v_mfma_f32_16x16x32_bf16 v[168:171], v[216:219], v[140:143], 0
  v_mfma_f32_16x16x32_bf16 v[172:175], v[220:223], v[140:143], 0
  v_and_b32 v27, s36, v25
  v_lshlrev_b32 v26, 16, v25
  v_and_b32 v25, s36, v24
  v_lshlrev_b32 v24, 16, v24
  v_and_b32 v31, s36, v29
  v_lshlrev_b32 v30, 16, v29
  v_and_b32 v29, s36, v28
  v_lshlrev_b32 v28, 16, v28
  v_add_f32 v24, v24, v28
  v_sub_f32 v25, v25, v29
  v_add_f32 v26, v26, v30
  v_sub_f32 v27, v27, v31
  v_add_f32 v28, v24, v26
  v_add_f32 v29, v25, v27
  v_sub_f32 v30, v24, v26
  v_sub_f32 v31, v25, v27
  s_mov_b32 exec_lo, 0x00010001
  s_mov_b32 exec_hi, 0x00010001
  ds_write2_b32 v22, v144, v148 offset0:0 offset1:1
  ds_write2_b32 v22, v145, v149 offset0:32 offset1:33
  ds_write2_b32 v22, v146, v150 offset0:64 offset1:65
  ds_write2_b32 v22, v147, v151 offset0:96 offset1:97
  ds_write2_b32 v22, v152, v156 offset0:2 offset1:3
  ds_write2_b32 v22, v153, v157 offset0:34 offset1:35
  ds_write2_b32 v22, v154, v158 offset0:66 offset1:67
  ds_write2_b32 v22, v155, v159 offset0:98 offset1:99
  ds_write2_b32 v22, v160, v164 offset0:4 offset1:5
  ds_write2_b32 v22, v161, v165 offset0:36 offset1:37
  ds_write2_b32 v22, v162, v166 offset0:68 offset1:69
  ds_write2_b32 v22, v163, v167 offset0:100 offset1:101
  ds_write2_b32 v22, v168, v172 offset0:6 offset1:7
  ds_write2_b32 v22, v169, v173 offset0:38 offset1:39
  ds_write2_b32 v22, v170, v174 offset0:70 offset1:71
  ds_write2_b32 v22, v171, v175 offset0:102 offset1:103
  s_mov_b64 exec, -1
mid_nocol0_93:
  ds_read_b64_tr_b16 v[128:129], v16 offset:128
  ds_read_b64_tr_b16 v[130:131], v16 offset:33408
  ds_read_b64_tr_b16 v[132:133], v16 offset:448
  ds_read_b64_tr_b16 v[134:135], v16 offset:33728
  s_waitcnt lgkmcnt(10)
  v_mfma_f32_16x16x32_bf16 v[144:147], v[192:195], v[112:115], 0
  v_mfma_f32_16x16x32_bf16 v[148:151], v[196:199], v[112:115], 0
  s_mov_b32 m0, 155648
  s_mov_b32 s31, 262144
  buffer_load_dword v23, s[24:27], s31 offen lds
  s_waitcnt lgkmcnt(8)
  v_mfma_f32_16x16x32_bf16 v[152:155], v[200:203], v[116:119], 0
  v_and_b32 v176, s36, v48
  v_and_b32 v180, s36, v50
  v_and_b32 v177, s36, v52
  v_and_b32 v181, s36, v54
  v_and_b32 v178, s36, v56
  v_and_b32 v182, s36, v58
  v_mfma_f32_16x16x32_bf16 v[156:159], v[204:207], v[116:119], 0
  v_and_b32 v179, s36, v60
  v_and_b32 v183, s36, v62
  v_pk_mul_f32 v[112:113], v[144:145], v[176:177]
  v_pk_mul_f32 v[144:145], v[144:145], v[180:181]
  v_pk_mul_f32 v[114:115], v[146:147], v[178:179]
  v_pk_mul_f32 v[146:147], v[146:147], v[182:183]
  v_pk_fma_f32 v[112:113], v[148:149], v[180:181], v[112:113] neg_lo:[1,0,0] neg_hi:[1,0,0]
  v_pk_fma_f32 v[144:145], v[148:149], v[176:177], v[144:145]
  v_pk_fma_f32 v[114:115], v[150:151], v[182:183], v[114:115] neg_lo:[1,0,0] neg_hi:[1,0,0]
  v_pk_fma_f32 v[146:147], v[150:151], v[178:179], v[146:147]
  ds_read_b64_tr_b16 v[136:137], v17 offset:512
  ds_read_b64_tr_b16 v[138:139], v17 offset:33792
  v_cvt_pk_bf16_f32 v112, v112, v144
  v_cvt_pk_bf16_f32 v113, v113, v145
  v_cvt_pk_bf16_f32 v114, v114, v146
  v_cvt_pk_bf16_f32 v115, v115, v147
  s_waitcnt lgkmcnt(8)
  v_mfma_f32_16x16x32_bf16 v[144:147], v[208:211], v[120:123], 0
  v_and_b32 v176, s36, v64
  v_and_b32 v180, s36, v66
  v_and_b32 v177, s36, v68
  v_mfma_f32_16x16x32_bf16 v[160:163], v[112:115], v[224:227], 0
  v_and_b32 v181, s36, v70
  v_and_b32 v178, s36, v72
  v_and_b32 v182, s36, v74
  v_mfma_f32_16x16x32_bf16 v[148:151], v[212:215], v[120:123], 0
  v_and_b32 v179, s36, v76
  v_and_b32 v183, s36, v78
  v_pk_mul_f32 v[116:117], v[152:153], v[176:177]
  v_pk_mul_f32 v[152:153], v[152:153], v[180:181]
  v_pk_mul_f32 v[118:119], v[154:155], v[178:179]
  v_mfma_f32_16x16x32_bf16 v[164:167], v[112:115], v[228:231], 0
  v_pk_mul_f32 v[154:155], v[154:155], v[182:183]
  v_pk_fma_f32 v[116:117], v[156:157], v[180:181], v[116:117] neg_lo:[1,0,0] neg_hi:[1,0,0]
  v_pk_fma_f32 v[152:153], v[156:157], v[176:177], v[152:153]
  v_pk_fma_f32 v[118:119], v[158:159], v[182:183], v[118:119] neg_lo:[1,0,0] neg_hi:[1,0,0]
  v_pk_fma_f32 v[154:155], v[158:159], v[178:179], v[154:155]
  ds_read_b64_tr_b16 v[140:141], v17 offset:832
  ds_read_b64_tr_b16 v[142:143], v17 offset:34112
  v_cvt_pk_bf16_f32 v116, v116, v152
  v_cvt_pk_bf16_f32 v117, v117, v153
  v_cvt_pk_bf16_f32 v118, v118, v154
  v_cvt_pk_bf16_f32 v119, v119, v155
  s_waitcnt lgkmcnt(8)
  v_mfma_f32_16x16x32_bf16 v[152:155], v[216:219], v[124:127], 0
  v_cvt_pk_bf16_f32 v184, v160, v161
  v_cvt_pk_bf16_f32 v185, v162, v163
  v_and_b32 v176, s36, v80
  v_and_b32 v180, s36, v82
  v_and_b32 v177, s36, v84
  v_mfma_f32_16x16x32_bf16 v[168:171], v[116:119], v[232:235], 0
  ds_write_b64 v18, v[184:185] offset:64
  v_cvt_pk_bf16_f32 v186, v164, v165
  v_cvt_pk_bf16_f32 v187, v166, v167
  v_and_b32 v181, s36, v86
  v_and_b32 v178, s36, v88
  v_and_b32 v182, s36, v90
  v_mfma_f32_16x16x32_bf16 v[156:159], v[220:223], v[124:127], 0
  ds_write_b64 v19, v[186:187] offset:64
  v_and_b32 v179, s36, v92
  v_and_b32 v183, s36, v94
  v_pk_mul_f32 v[120:121], v[144:145], v[176:177]
  v_pk_mul_f32 v[144:145], v[144:145], v[180:181]
  v_pk_mul_f32 v[122:123], v[146:147], v[178:179]
  v_mfma_f32_16x16x32_bf16 v[172:175], v[116:119], v[236:239], 0
  v_pk_mul_f32 v[146:147], v[146:147], v[182:183]
  v_pk_fma_f32 v[120:121], v[148:149], v[180:181], v[120:121] neg_lo:[1,0,0] neg_hi:[1,0,0]
  v_pk_fma_f32 v[144:145], v[148:149], v[176:177], v[144:145]
  v_pk_fma_f32 v[122:123], v[150:151], v[182:183], v[122:123] neg_lo:[1,0,0] neg_hi:[1,0,0]
  v_pk_fma_f32 v[146:147], v[150:151], v[178:179], v[146:147]
  ds_read_b64_tr_b16 v[112:113], v16 offset:192
  ds_read_b64_tr_b16 v[114:115], v16 offset:33472
  v_cvt_pk_bf16_f32 v120, v120, v144
  v_cvt_pk_bf16_f32 v121, v121, v145
  v_cvt_pk_bf16_f32 v122, v122, v146
  v_cvt_pk_bf16_f32 v123, v123, v147
  s_waitcnt lgkmcnt(10)
  v_mfma_f32_16x16x32_bf16 v[144:147], v[192:195], v[128:131], 0
  v_cvt_pk_bf16_f32 v188, v168, v169
  v_cvt_pk_bf16_f32 v189, v170, v171
  v_and_b32 v176, s36, v96
  v_and_b32 v180, s36, v98
  v_and_b32 v177, s36, v100
  v_mfma_f32_16x16x32_bf16 v[160:163], v[120:123], v[240:243], 0
  ds_write_b64 v18, v[188:189] offset:256
  v_cvt_pk_bf16_f32 v190, v172, v173
  v_cvt_pk_bf16_f32 v191, v174, v175
  v_and_b32 v181, s36, v102
  v_and_b32 v178, s36, v104
  v_and_b32 v182, s36, v106
  v_mfma_f32_16x16x32_bf16 v[148:151], v[196:199], v[128:131], 0
  ds_write_b64 v19, v[190:191] offset:256
  v_and_b32 v179, s36, v108
  v_and_b32 v183, s36, v110
  v_pk_mul_f32 v[124:125], v[152:153], v[176:177]
  v_pk_mul_f32 v[152:153], v[152:153], v[180:181]
  v_pk_mul_f32 v[126:127], v[154:155], v[178:179]
  v_mfma_f32_16x16x32_bf16 v[164:167], v[120:123], v[244:247], 0
  v_pk_mul_f32 v[154:155], v[154:155], v[182:183]
  v_pk_fma_f32 v[124:125], v[156:157], v[180:181], v[124:125] neg_lo:[1,0,0] neg_hi:[1,0,0]
  v_pk_fma_f32 v[152:153], v[156:157], v[176:177], v[152:153]
  v_pk_fma_f32 v[126:127], v[158:159], v[182:183], v[126:127] neg_lo:[1,0,0] neg_hi:[1,0,0]
  v_pk_fma_f32 v[154:155], v[158:159], v[178:179], v[154:155]
  ds_read_b64_tr_b16 v[116:117], v16 offset:384
  ds_read_b64_tr_b16 v[118:119], v16 offset:33664
  v_cvt_pk_bf16_f32 v124, v124, v152
  v_cvt_pk_bf16_f32 v125, v125, v153
  v_cvt_pk_bf16_f32 v126, v126, v154
  v_cvt_pk_bf16_f32 v127, v127, v155
  s_cmp_lg_u32 s20, 0
  s_cbranch_scc1 mid_nocol0_94
  s_waitcnt lgkmcnt(0)
  s_barrier
  ds_read_b64 v[176:177], v20
  ds_read_b64 v[178:179], v21
  s_waitcnt lgkmcnt(1)
  v_mul_f32 v180, v176, v28
  v_mul_f32 v181, v176, v29
  v_fma_f32 v180, -v177, v29, v180
  v_fma_f32 v181, v177, v28, v181
  s_waitcnt lgkmcnt(0)
  v_fma_f32 v180, v178, v30, v180
  v_fma_f32 v181, v178, v31, v181
  v_fma_f32 v180, v179, v31, v180
  v_fma_f32 v181, -v179, v30, v181
  v_mul_f32 v180, 0x3e000000, v180
  v_mul_f32 v181, 0x3e000000, v181
  v_cvt_pk_bf16_f32 v180, v180, v181
  ds_write_b32 v20, v180 offset:4096
mid_nocol0_94:
  s_waitcnt lgkmcnt(12)
  v_mfma_f32_16x16x32_bf16 v[152:155], v[200:203], v[132:135], 0
  v_cvt_pk_bf16_f32 v184, v160, v161
  v_cvt_pk_bf16_f32 v185, v162, v163
  v_lshlrev_b32 v176, 16, v49
  v_lshlrev_b32 v180, 16, v51
  v_lshlrev_b32 v177, 16, v53
  v_mfma_f32_16x16x32_bf16 v[168:171], v[124:127], v[248:251], 0
  ds_write_b64 v18, v[184:185] offset:704
  v_cvt_pk_bf16_f32 v186, v164, v165
  v_cvt_pk_bf16_f32 v187, v166, v167
  v_lshlrev_b32 v181, 16, v55
  v_lshlrev_b32 v178, 16, v57
  v_lshlrev_b32 v182, 16, v59
  v_mfma_f32_16x16x32_bf16 v[156:159], v[204:207], v[132:135], 0
  ds_write_b64 v19, v[186:187] offset:704
  v_lshlrev_b32 v179, 16, v61
  v_lshlrev_b32 v183, 16, v63
  v_pk_mul_f32 v[128:129], v[144:145], v[176:177]
  v_pk_mul_f32 v[144:145], v[144:145], v[180:181]
  v_pk_mul_f32 v[130:131], v[146:147], v[178:179]
  v_mfma_f32_16x16x32_bf16 v[172:175], v[124:127], v[252:255], 0
  v_pk_mul_f32 v[146:147], v[146:147], v[182:183]
  v_pk_fma_f32 v[128:129], v[148:149], v[180:181], v[128:129] neg_lo:[1,0,0] neg_hi:[1,0,0]
  v_pk_fma_f32 v[144:145], v[148:149], v[176:177], v[144:145]
  v_pk_fma_f32 v[130:131], v[150:151], v[182:183], v[130:131] neg_lo:[1,0,0] neg_hi:[1,0,0]
  v_pk_fma_f32 v[146:147], v[150:151], v[178:179], v[146:147]
  ds_read_b64_tr_b16 v[120:121], v17 offset:576
  ds_read_b64_tr_b16 v[122:123], v17 offset:33856
  v_cvt_pk_bf16_f32 v128, v128, v144
  v_cvt_pk_bf16_f32 v129, v129, v145
  v_cvt_pk_bf16_f32 v130, v130, v146
  v_cvt_pk_bf16_f32 v131, v131, v147
  s_mov_b32 m0, 155648
  s_mov_b32 s31, 65536
  buffer_load_dword v23, s[24:27], s31 offen lds
  s_waitcnt lgkmcnt(14)
  v_mfma_f32_16x16x32_bf16 v[144:147], v[208:211], v[136:139], 0
  v_cvt_pk_bf16_f32 v188, v168, v169
  v_cvt_pk_bf16_f32 v189, v170, v171
  v_lshlrev_b32 v176, 16, v65
  v_lshlrev_b32 v180, 16, v67
  v_lshlrev_b32 v177, 16, v69
  v_mfma_f32_16x16x32_bf16 v[160:163], v[128:131], v[224:227], 0
  ds_write_b64 v18, v[188:189] offset:896
  v_cvt_pk_bf16_f32 v190, v172, v173
  v_cvt_pk_bf16_f32 v191, v174, v175
  v_lshlrev_b32 v181, 16, v71
  v_lshlrev_b32 v178, 16, v73
  v_lshlrev_b32 v182, 16, v75
  v_mfma_f32_16x16x32_bf16 v[148:151], v[212:215], v[136:139], 0
  ds_write_b64 v19, v[190:191] offset:896
  v_lshlrev_b32 v179, 16, v77
  v_lshlrev_b32 v183, 16, v79
  v_pk_mul_f32 v[132:133], v[152:153], v[176:177]
  v_pk_mul_f32 v[152:153], v[152:153], v[180:181]
  v_pk_mul_f32 v[134:135], v[154:155], v[178:179]
  v_mfma_f32_16x16x32_bf16 v[164:167], v[128:131], v[228:231], 0
  v_pk_mul_f32 v[154:155], v[154:155], v[182:183]
  v_pk_fma_f32 v[132:133], v[156:157], v[180:181], v[132:133] neg_lo:[1,0,0] neg_hi:[1,0,0]
  v_pk_fma_f32 v[152:153], v[156:157], v[176:177], v[152:153]
  v_pk_fma_f32 v[134:135], v[158:159], v[182:183], v[134:135] neg_lo:[1,0,0] neg_hi:[1,0,0]
  v_pk_fma_f32 v[154:155], v[158:159], v[178:179], v[154:155]
  ds_read_b64_tr_b16 v[124:125], v17 offset:768
  ds_read_b64_tr_b16 v[126:127], v17 offset:34048
  v_cvt_pk_bf16_f32 v132, v132, v152
  v_cvt_pk_bf16_f32 v133, v133, v153
  v_cvt_pk_bf16_f32 v134, v134, v154
  v_cvt_pk_bf16_f32 v135, v135, v155
  s_waitcnt lgkmcnt(15)
  v_mfma_f32_16x16x32_bf16 v[152:155], v[216:219], v[140:143], 0
  v_cvt_pk_bf16_f32 v184, v160, v161
  v_cvt_pk_bf16_f32 v185, v162, v163
  v_lshlrev_b32 v176, 16, v81
  v_lshlrev_b32 v180, 16, v83
  v_lshlrev_b32 v177, 16, v85
  v_mfma_f32_16x16x32_bf16 v[168:171], v[132:135], v[232:235], 0
  ds_write_b64 v18, v[184:185] offset:128
  v_cvt_pk_bf16_f32 v186, v164, v165
  v_cvt_pk_bf16_f32 v187, v166, v167
  v_lshlrev_b32 v181, 16, v87
  v_lshlrev_b32 v178, 16, v89
  v_lshlrev_b32 v182, 16, v91
  v_mfma_f32_16x16x32_bf16 v[156:159], v[220:223], v[140:143], 0
  ds_write_b64 v19, v[186:187] offset:128
  v_lshlrev_b32 v179, 16, v93
  v_lshlrev_b32 v183, 16, v95
  v_pk_mul_f32 v[136:137], v[144:145], v[176:177]
  v_pk_mul_f32 v[144:145], v[144:145], v[180:181]
  v_pk_mul_f32 v[138:139], v[146:147], v[178:179]
  v_mfma_f32_16x16x32_bf16 v[172:175], v[132:135], v[236:239], 0
  v_pk_mul_f32 v[146:147], v[146:147], v[182:183]
  v_pk_fma_f32 v[136:137], v[148:149], v[180:181], v[136:137] neg_lo:[1,0,0] neg_hi:[1,0,0]
  v_pk_fma_f32 v[144:145], v[148:149], v[176:177], v[144:145]
  v_pk_fma_f32 v[138:139], v[150:151], v[182:183], v[138:139] neg_lo:[1,0,0] neg_hi:[1,0,0]
  v_pk_fma_f32 v[146:147], v[150:151], v[178:179], v[146:147]
  ds_read_b64_tr_b16 v[128:129], v16 offset:0
  ds_read_b64_tr_b16 v[130:131], v16 offset:33280
  v_cvt_pk_bf16_f32 v136, v136, v144
  v_cvt_pk_bf16_f32 v137, v137, v145
  v_cvt_pk_bf16_f32 v138, v138, v146
  v_cvt_pk_bf16_f32 v139, v139, v147
  s_waitcnt lgkmcnt(15)
  v_mfma_f32_16x16x32_bf16 v[144:147], v[192:195], v[112:115], 0
  v_cvt_pk_bf16_f32 v188, v168, v169
  v_cvt_pk_bf16_f32 v189, v170, v171
  v_lshlrev_b32 v176, 16, v97
  v_lshlrev_b32 v180, 16, v99
  v_lshlrev_b32 v177, 16, v101
  v_mfma_f32_16x16x32_bf16 v[160:163], v[136:139], v[240:243], 0
  ds_write_b64 v18, v[188:189] offset:448
  v_cvt_pk_bf16_f32 v190, v172, v173
  v_cvt_pk_bf16_f32 v191, v174, v175
  v_lshlrev_b32 v181, 16, v103
  v_lshlrev_b32 v178, 16, v105
  v_lshlrev_b32 v182, 16, v107
  v_mfma_f32_16x16x32_bf16 v[148:151], v[196:199], v[112:115], 0
  ds_write_b64 v19, v[190:191] offset:448
  v_lshlrev_b32 v179, 16, v109
  v_lshlrev_b32 v183, 16, v111
  v_pk_mul_f32 v[140:141], v[152:153], v[176:177]
  v_pk_mul_f32 v[152:153], v[152:153], v[180:181]
  v_pk_mul_f32 v[142:143], v[154:155], v[178:179]
  v_mfma_f32_16x16x32_bf16 v[164:167], v[136:139], v[244:247], 0
  v_pk_mul_f32 v[154:155], v[154:155], v[182:183]
  v_pk_fma_f32 v[140:141], v[156:157], v[180:181], v[140:141] neg_lo:[1,0,0] neg_hi:[1,0,0]
  v_pk_fma_f32 v[152:153], v[156:157], v[176:177], v[152:153]
  v_pk_fma_f32 v[142:143], v[158:159], v[182:183], v[142:143] neg_lo:[1,0,0] neg_hi:[1,0,0]
  v_pk_fma_f32 v[154:155], v[158:159], v[178:179], v[154:155]
  ds_read_b64_tr_b16 v[132:133], v16 offset:320
  ds_read_b64_tr_b16 v[134:135], v16 offset:33600
  v_cvt_pk_bf16_f32 v140, v140, v152
  v_cvt_pk_bf16_f32 v141, v141, v153
  v_cvt_pk_bf16_f32 v142, v142, v154
  v_cvt_pk_bf16_f32 v143, v143, v155
  s_cmp_lg_u32 s20, 0
  s_cbranch_scc1 mid_nocol0_95
  s_waitcnt lgkmcnt(0)
  s_barrier
  s_mov_b32 exec_lo, 0x00010001
  s_mov_b32 exec_hi, 0x00010001
  ds_read_b32 v48, v22 offset:4096
  ds_read_b32 v52, v22 offset:4224
  ds_read_b32 v56, v22 offset:4352
  ds_read_b32 v60, v22 offset:4480
  ds_read_b32 v64, v22 offset:4104
  ds_read_b32 v68, v22 offset:4232
  ds_read_b32 v72, v22 offset:4360
  ds_read_b32 v76, v22 offset:4488
  ds_read_b32 v80, v22 offset:4112
  ds_read_b32 v84, v22 offset:4240
  ds_read_b32 v88, v22 offset:4368
  ds_read_b32 v92, v22 offset:4496
  ds_read_b32 v96, v22 offset:4120
  ds_read_b32 v100, v22 offset:4248
  ds_read_b32 v104, v22 offset:4376
  ds_read_b32 v108, v22 offset:4504
  s_mov_b64 exec, -1
mid_nocol0_95:
  s_waitcnt lgkmcnt(15)
  v_mfma_f32_16x16x32_bf16 v[152:155], v[200:203], v[116:119], 0
  v_cvt_pk_bf16_f32 v184, v160, v161
  v_cvt_pk_bf16_f32 v185, v162, v163
  v_and_b32 v176, s36, v49
  v_and_b32 v180, s36, v51
  v_and_b32 v177, s36, v53
  v_mfma_f32_16x16x32_bf16 v[168:171], v[140:143], v[248:251], 0
  ds_write_b64 v18, v[184:185] offset:512
  v_cvt_pk_bf16_f32 v186, v164, v165
  v_cvt_pk_bf16_f32 v187, v166, v167
  v_and_b32 v181, s36, v55
  v_and_b32 v178, s36, v57
  v_and_b32 v182, s36, v59
  v_mfma_f32_16x16x32_bf16 v[156:159], v[204:207], v[116:119], 0
  ds_write_b64 v19, v[186:187] offset:512
  v_and_b32 v179, s36, v61
  v_and_b32 v183, s36, v63
  v_pk_mul_f32 v[112:113], v[144:145], v[176:177]
  v_pk_mul_f32 v[144:145], v[144:145], v[180:181]
  v_pk_mul_f32 v[114:115], v[146:147], v[178:179]
  v_mfma_f32_16x16x32_bf16 v[172:175], v[140:143], v[252:255], 0
  v_pk_mul_f32 v[146:147], v[146:147], v[182:183]
  v_pk_fma_f32 v[112:113], v[148:149], v[180:181], v[112:113] neg_lo:[1,0,0] neg_hi:[1,0,0]
  v_pk_fma_f32 v[144:145], v[148:149], v[176:177], v[144:145]
  v_pk_fma_f32 v[114:115], v[150:151], v[182:183], v[114:115] neg_lo:[1,0,0] neg_hi:[1,0,0]
  v_pk_fma_f32 v[146:147], v[150:151], v[178:179], v[146:147]
  ds_read_b64_tr_b16 v[136:137], v17 offset:640
  ds_read_b64_tr_b16 v[138:139], v17 offset:33920
  v_cvt_pk_bf16_f32 v112, v112, v144
  v_cvt_pk_bf16_f32 v113, v113, v145
  v_cvt_pk_bf16_f32 v114, v114, v146
  v_cvt_pk_bf16_f32 v115, v115, v147
  s_waitcnt lgkmcnt(15)
  v_mfma_f32_16x16x32_bf16 v[144:147], v[208:211], v[120:123], 0
  v_cvt_pk_bf16_f32 v188, v168, v169
  v_cvt_pk_bf16_f32 v189, v170, v171
  v_and_b32 v176, s36, v65
  v_and_b32 v180, s36, v67
  v_and_b32 v177, s36, v69
  v_mfma_f32_16x16x32_bf16 v[160:163], v[112:115], v[224:227], 0
  ds_write_b64 v18, v[188:189] offset:832
  v_cvt_pk_bf16_f32 v190, v172, v173
  v_cvt_pk_bf16_f32 v191, v174, v175
  v_and_b32 v181, s36, v71
  v_and_b32 v178, s36, v73
  v_and_b32 v182, s36, v75
  v_mfma_f32_16x16x32_bf16 v[148:151], v[212:215], v[120:123], 0
  ds_write_b64 v19, v[190:191] offset:832
  v_and_b32 v179, s36, v77
  v_and_b32 v183, s36, v79
  v_pk_mul_f32 v[116:117], v[152:153], v[176:177]
  v_pk_mul_f32 v[152:153], v[152:153], v[180:181]
  v_pk_mul_f32 v[118:119], v[154:155], v[178:179]
  v_mfma_f32_16x16x32_bf16 v[164:167], v[112:115], v[228:231], 0
  v_pk_mul_f32 v[154:155], v[154:155], v[182:183]
  v_pk_fma_f32 v[116:117], v[156:157], v[180:181], v[116:117] neg_lo:[1,0,0] neg_hi:[1,0,0]
  v_pk_fma_f32 v[152:153], v[156:157], v[176:177], v[152:153]
  v_pk_fma_f32 v[118:119], v[158:159], v[182:183], v[118:119] neg_lo:[1,0,0] neg_hi:[1,0,0]
  v_pk_fma_f32 v[154:155], v[158:159], v[178:179], v[154:155]
  ds_read_b64_tr_b16 v[140:141], v17 offset:960
  ds_read_b64_tr_b16 v[142:143], v17 offset:34240
  v_cvt_pk_bf16_f32 v116, v116, v152
  v_cvt_pk_bf16_f32 v117, v117, v153
  v_cvt_pk_bf16_f32 v118, v118, v154
  v_cvt_pk_bf16_f32 v119, v119, v155
  s_mov_b32 m0, 155648
  s_mov_b32 s31, 327680
  buffer_load_dword v23, s[24:27], s31 offen lds
  s_waitcnt lgkmcnt(15)
  v_mfma_f32_16x16x32_bf16 v[152:155], v[216:219], v[124:127], 0
  v_cvt_pk_bf16_f32 v184, v160, v161
  v_cvt_pk_bf16_f32 v185, v162, v163
  v_and_b32 v176, s36, v81
  v_and_b32 v180, s36, v83
  v_and_b32 v177, s36, v85
  v_mfma_f32_16x16x32_bf16 v[168:171], v[116:119], v[232:235], 0
  ds_write_b64 v18, v[184:185] offset:192
  v_cvt_pk_bf16_f32 v186, v164, v165
  v_cvt_pk_bf16_f32 v187, v166, v167
  v_and_b32 v181, s36, v87
  v_and_b32 v178, s36, v89
  v_and_b32 v182, s36, v91
  v_mfma_f32_16x16x32_bf16 v[156:159], v[220:223], v[124:127], 0
  ds_write_b64 v19, v[186:187] offset:192
  v_and_b32 v179, s36, v93
  v_and_b32 v183, s36, v95
  v_pk_mul_f32 v[120:121], v[144:145], v[176:177]
  v_pk_mul_f32 v[144:145], v[144:145], v[180:181]
  v_pk_mul_f32 v[122:123], v[146:147], v[178:179]
  v_mfma_f32_16x16x32_bf16 v[172:175], v[116:119], v[236:239], 0
  v_pk_mul_f32 v[146:147], v[146:147], v[182:183]
  v_pk_fma_f32 v[120:121], v[148:149], v[180:181], v[120:121] neg_lo:[1,0,0] neg_hi:[1,0,0]
  v_pk_fma_f32 v[144:145], v[148:149], v[176:177], v[144:145]
  v_pk_fma_f32 v[122:123], v[150:151], v[182:183], v[122:123] neg_lo:[1,0,0] neg_hi:[1,0,0]
  v_pk_fma_f32 v[146:147], v[150:151], v[178:179], v[146:147]
  v_cvt_pk_bf16_f32 v120, v120, v144
  v_cvt_pk_bf16_f32 v121, v121, v145
  v_cvt_pk_bf16_f32 v122, v122, v146
  v_cvt_pk_bf16_f32 v123, v123, v147
  s_waitcnt lgkmcnt(14)
  v_mfma_f32_16x16x32_bf16 v[144:147], v[192:195], v[128:131], 0
  v_cvt_pk_bf16_f32 v188, v168, v169
  v_cvt_pk_bf16_f32 v189, v170, v171
  v_and_b32 v176, s36, v97
  v_and_b32 v180, s36, v99
  v_and_b32 v177, s36, v101
  v_mfma_f32_16x16x32_bf16 v[160:163], v[120:123], v[240:243], 0
  ds_write_b64 v18, v[188:189] offset:384
  v_cvt_pk_bf16_f32 v190, v172, v173
  v_cvt_pk_bf16_f32 v191, v174, v175
  v_and_b32 v181, s36, v103
  v_and_b32 v178, s36, v105
  v_and_b32 v182, s36, v107
  v_mfma_f32_16x16x32_bf16 v[148:151], v[196:199], v[128:131], 0
  ds_write_b64 v19, v[190:191] offset:384
  v_and_b32 v179, s36, v109
  v_and_b32 v183, s36, v111
  v_pk_mul_f32 v[124:125], v[152:153], v[176:177]
  v_pk_mul_f32 v[152:153], v[152:153], v[180:181]
  v_pk_mul_f32 v[126:127], v[154:155], v[178:179]
  v_mfma_f32_16x16x32_bf16 v[164:167], v[120:123], v[244:247], 0
  v_pk_mul_f32 v[154:155], v[154:155], v[182:183]
  v_pk_fma_f32 v[124:125], v[156:157], v[180:181], v[124:125] neg_lo:[1,0,0] neg_hi:[1,0,0]
  v_pk_fma_f32 v[152:153], v[156:157], v[176:177], v[152:153]
  v_pk_fma_f32 v[126:127], v[158:159], v[182:183], v[126:127] neg_lo:[1,0,0] neg_hi:[1,0,0]
  v_pk_fma_f32 v[154:155], v[158:159], v[178:179], v[154:155]
  v_cvt_pk_bf16_f32 v124, v124, v152
  v_cvt_pk_bf16_f32 v125, v125, v153
  v_cvt_pk_bf16_f32 v126, v126, v154
  v_cvt_pk_bf16_f32 v127, v127, v155
  s_waitcnt lgkmcnt(12)
  v_mfma_f32_16x16x32_bf16 v[152:155], v[200:203], v[132:135], 0
  v_cvt_pk_bf16_f32 v184, v160, v161
  v_cvt_pk_bf16_f32 v185, v162, v163
  v_lshlrev_b32 v176, 16, v48
  v_lshlrev_b32 v180, 16, v50
  v_lshlrev_b32 v177, 16, v52
  v_mfma_f32_16x16x32_bf16 v[168:171], v[124:127], v[248:251], 0
  ds_write_b64 v18, v[184:185] offset:576
  v_cvt_pk_bf16_f32 v186, v164, v165
  v_cvt_pk_bf16_f32 v187, v166, v167
  v_lshlrev_b32 v181, 16, v54
  v_lshlrev_b32 v178, 16, v56
  v_lshlrev_b32 v182, 16, v58
  v_mfma_f32_16x16x32_bf16 v[156:159], v[204:207], v[132:135], 0
  ds_write_b64 v19, v[186:187] offset:576
  v_lshlrev_b32 v179, 16, v60
  v_lshlrev_b32 v183, 16, v62
  v_pk_mul_f32 v[128:129], v[144:145], v[176:177]
  v_pk_mul_f32 v[144:145], v[144:145], v[180:181]
  v_pk_mul_f32 v[130:131], v[146:147], v[178:179]
  v_mfma_f32_16x16x32_bf16 v[172:175], v[124:127], v[252:255], 0
  v_pk_mul_f32 v[146:147], v[146:147], v[182:183]
  v_pk_fma_f32 v[128:129], v[148:149], v[180:181], v[128:129] neg_lo:[1,0,0] neg_hi:[1,0,0]
  v_pk_fma_f32 v[144:145], v[148:149], v[176:177], v[144:145]
  v_pk_fma_f32 v[130:131], v[150:151], v[182:183], v[130:131] neg_lo:[1,0,0] neg_hi:[1,0,0]
  v_pk_fma_f32 v[146:147], v[150:151], v[178:179], v[146:147]
  v_cvt_pk_bf16_f32 v128, v128, v144
  v_cvt_pk_bf16_f32 v129, v129, v145
  v_cvt_pk_bf16_f32 v130, v130, v146
  v_cvt_pk_bf16_f32 v131, v131, v147
  v_cndmask_b32 v128, v128, v48, s[16:17]
  v_cndmask_b32 v129, v129, v52, s[16:17]
  v_cndmask_b32 v130, v130, v56, s[16:17]
  v_cndmask_b32 v131, v131, v60, s[16:17]
  s_waitcnt lgkmcnt(10)
  v_mfma_f32_16x16x32_bf16 v[144:147], v[208:211], v[136:139], 0
  v_cvt_pk_bf16_f32 v188, v168, v169
  v_cvt_pk_bf16_f32 v189, v170, v171
  v_lshlrev_b32 v176, 16, v64
  v_lshlrev_b32 v180, 16, v66
  v_lshlrev_b32 v177, 16, v68
  v_mfma_f32_16x16x32_bf16 v[160:163], v[128:131], v[224:227], 0
  ds_write_b64 v18, v[188:189] offset:768
  v_cvt_pk_bf16_f32 v190, v172, v173
  v_cvt_pk_bf16_f32 v191, v174, v175
  v_lshlrev_b32 v181, 16, v70
  v_lshlrev_b32 v178, 16, v72
  v_lshlrev_b32 v182, 16, v74
  v_mfma_f32_16x16x32_bf16 v[148:151], v[212:215], v[136:139], 0
  ds_write_b64 v19, v[190:191] offset:768
  v_lshlrev_b32 v179, 16, v76
  v_lshlrev_b32 v183, 16, v78
  v_pk_mul_f32 v[132:133], v[152:153], v[176:177]
  v_pk_mul_f32 v[152:153], v[152:153], v[180:181]
  v_pk_mul_f32 v[134:135], v[154:155], v[178:179]
  v_mfma_f32_16x16x32_bf16 v[164:167], v[128:131], v[228:231], 0
  v_pk_mul_f32 v[154:155], v[154:155], v[182:183]
  v_pk_fma_f32 v[132:133], v[156:157], v[180:181], v[132:133] neg_lo:[1,0,0] neg_hi:[1,0,0]
  v_pk_fma_f32 v[152:153], v[156:157], v[176:177], v[152:153]
  v_pk_fma_f32 v[134:135], v[158:159], v[182:183], v[134:135] neg_lo:[1,0,0] neg_hi:[1,0,0]
  v_pk_fma_f32 v[154:155], v[158:159], v[178:179], v[154:155]
  v_cvt_pk_bf16_f32 v132, v132, v152
  v_cvt_pk_bf16_f32 v133, v133, v153
  v_cvt_pk_bf16_f32 v134, v134, v154
  v_cvt_pk_bf16_f32 v135, v135, v155
  v_cndmask_b32 v132, v132, v64, s[16:17]
  v_cndmask_b32 v133, v133, v68, s[16:17]
  v_cndmask_b32 v134, v134, v72, s[16:17]
  v_cndmask_b32 v135, v135, v76, s[16:17]
  s_waitcnt lgkmcnt(8)
  v_mfma_f32_16x16x32_bf16 v[152:155], v[216:219], v[140:143], 0
  v_cvt_pk_bf16_f32 v184, v160, v161
  v_cvt_pk_bf16_f32 v185, v162, v163
  v_lshlrev_b32 v176, 16, v80
  v_lshlrev_b32 v180, 16, v82
  v_lshlrev_b32 v177, 16, v84
  v_mfma_f32_16x16x32_bf16 v[168:171], v[132:135], v[232:235], 0
  ds_write_b64 v18, v[184:185] offset:0
  v_cvt_pk_bf16_f32 v186, v164, v165
  v_cvt_pk_bf16_f32 v187, v166, v167
  v_lshlrev_b32 v181, 16, v86
  v_lshlrev_b32 v178, 16, v88
  v_lshlrev_b32 v182, 16, v90
  v_mfma_f32_16x16x32_bf16 v[156:159], v[220:223], v[140:143], 0
  ds_write_b64 v19, v[186:187] offset:0
  v_lshlrev_b32 v179, 16, v92
  v_lshlrev_b32 v183, 16, v94
  v_pk_mul_f32 v[136:137], v[144:145], v[176:177]
  v_pk_mul_f32 v[144:145], v[144:145], v[180:181]
  v_pk_mul_f32 v[138:139], v[146:147], v[178:179]
  v_mfma_f32_16x16x32_bf16 v[172:175], v[132:135], v[236:239], 0
  v_pk_mul_f32 v[146:147], v[146:147], v[182:183]
  v_pk_fma_f32 v[136:137], v[148:149], v[180:181], v[136:137] neg_lo:[1,0,0] neg_hi:[1,0,0]
  v_pk_fma_f32 v[144:145], v[148:149], v[176:177], v[144:145]
  v_pk_fma_f32 v[138:139], v[150:151], v[182:183], v[138:139] neg_lo:[1,0,0] neg_hi:[1,0,0]
  v_pk_fma_f32 v[146:147], v[150:151], v[178:179], v[146:147]
  v_cvt_pk_bf16_f32 v136, v136, v144
  v_cvt_pk_bf16_f32 v137, v137, v145
  v_cvt_pk_bf16_f32 v138, v138, v146
  v_cvt_pk_bf16_f32 v139, v139, v147
  v_cndmask_b32 v136, v136, v80, s[16:17]
  v_cndmask_b32 v137, v137, v84, s[16:17]
  v_cndmask_b32 v138, v138, v88, s[16:17]
  v_cndmask_b32 v139, v139, v92, s[16:17]
  v_cvt_pk_bf16_f32 v188, v168, v169
  v_cvt_pk_bf16_f32 v189, v170, v171
  v_lshlrev_b32 v176, 16, v96
  v_lshlrev_b32 v180, 16, v98
  v_lshlrev_b32 v177, 16, v100
  v_mfma_f32_16x16x32_bf16 v[160:163], v[136:139], v[240:243], 0
  ds_write_b64 v18, v[188:189] offset:320
  v_cvt_pk_bf16_f32 v190, v172, v173
  v_cvt_pk_bf16_f32 v191, v174, v175
  v_lshlrev_b32 v181, 16, v102
  v_lshlrev_b32 v178, 16, v104
  v_lshlrev_b32 v182, 16, v106
  ds_write_b64 v19, v[190:191] offset:320
  v_lshlrev_b32 v179, 16, v108
  v_lshlrev_b32 v183, 16, v110
  v_pk_mul_f32 v[140:141], v[152:153], v[176:177]
  v_pk_mul_f32 v[152:153], v[152:153], v[180:181]
  v_pk_mul_f32 v[142:143], v[154:155], v[178:179]
  v_mfma_f32_16x16x32_bf16 v[164:167], v[136:139], v[244:247], 0
  v_pk_mul_f32 v[154:155], v[154:155], v[182:183]
  v_pk_fma_f32 v[140:141], v[156:157], v[180:181], v[140:141] neg_lo:[1,0,0] neg_hi:[1,0,0]
  v_pk_fma_f32 v[152:153], v[156:157], v[176:177], v[152:153]
  v_pk_fma_f32 v[142:143], v[158:159], v[182:183], v[142:143] neg_lo:[1,0,0] neg_hi:[1,0,0]
  v_pk_fma_f32 v[154:155], v[158:159], v[178:179], v[154:155]
  v_cvt_pk_bf16_f32 v140, v140, v152
  v_cvt_pk_bf16_f32 v141, v141, v153
  v_cvt_pk_bf16_f32 v142, v142, v154
  v_cvt_pk_bf16_f32 v143, v143, v155
  v_cndmask_b32 v140, v140, v96, s[16:17]
  v_cndmask_b32 v141, v141, v100, s[16:17]
  v_cndmask_b32 v142, v142, v104, s[16:17]
  v_cndmask_b32 v143, v143, v108, s[16:17]
  v_cvt_pk_bf16_f32 v184, v160, v161
  v_cvt_pk_bf16_f32 v185, v162, v163
  v_mfma_f32_16x16x32_bf16 v[168:171], v[140:143], v[248:251], 0
  ds_write_b64 v18, v[184:185] offset:640
  v_cvt_pk_bf16_f32 v186, v164, v165
  v_cvt_pk_bf16_f32 v187, v166, v167
  ds_write_b64 v19, v[186:187] offset:640
  v_mfma_f32_16x16x32_bf16 v[172:175], v[140:143], v[252:255], 0
  s_nop 2
  v_cvt_pk_bf16_f32 v188, v168, v169
  v_cvt_pk_bf16_f32 v189, v170, v171
  ds_write_b64 v18, v[188:189] offset:960
  s_nop 1
  v_cvt_pk_bf16_f32 v190, v172, v173
  v_cvt_pk_bf16_f32 v191, v174, v175
  ds_write_b64 v19, v[190:191] offset:960
  s_waitcnt lgkmcnt(0)
  s_barrier
  ds_read_b64_tr_b16 v[112:113], v8 offset:0
  ds_read_b64_tr_b16 v[114:115], v8 offset:2048
  ds_read_b64_tr_b16 v[116:117], v10 offset:0
  ds_read_b64_tr_b16 v[118:119], v10 offset:2048
  ds_read_b64_tr_b16 v[120:121], v12 offset:0
  ds_read_b64_tr_b16 v[122:123], v12 offset:2048
  ds_read_b64_tr_b16 v[124:125], v14 offset:0
  ds_read_b64_tr_b16 v[126:127], v14 offset:2048
  ds_read_b64_tr_b16 v[128:129], v8 offset:4160
  ds_read_b64_tr_b16 v[130:131], v8 offset:6208
  ds_read_b64_tr_b16 v[132:133], v10 offset:4160
  ds_read_b64_tr_b16 v[134:135], v10 offset:6208
  ds_read_b64_tr_b16 v[136:137], v12 offset:4160
  ds_read_b64_tr_b16 v[138:139], v12 offset:6208
  ds_read_b64_tr_b16 v[140:141], v14 offset:4160
  ds_read_b64_tr_b16 v[142:143], v14 offset:6208
  s_waitcnt lgkmcnt(14)
  v_mfma_f32_16x16x32_bf16 v[144:147], v[40:43], v[112:115], 0
  v_mfma_f32_16x16x32_bf16 v[148:151], v[44:47], v[112:115], 0
  s_waitcnt lgkmcnt(12)
  v_mfma_f32_16x16x32_bf16 v[152:155], v[40:43], v[116:119], 0
  v_mfma_f32_16x16x32_bf16 v[156:159], v[44:47], v[116:119], 0
  s_waitcnt lgkmcnt(10)
  v_mfma_f32_16x16x32_bf16 v[160:163], v[40:43], v[120:123], 0
  v_mfma_f32_16x16x32_bf16 v[164:167], v[44:47], v[120:123], 0
  s_waitcnt lgkmcnt(8)
  v_mfma_f32_16x16x32_bf16 v[168:171], v[40:43], v[124:127], 0
  v_mfma_f32_16x16x32_bf16 v[172:175], v[44:47], v[124:127], 0
  v_cvt_pk_bf16_f32 v48, v144, v148
  s_nop 0
  v_cvt_pk_bf16_f32 v49, v152, v156
  s_nop 1
  v_cvt_pk_bf16_f32 v50, v160, v164
  s_nop 1
  v_cvt_pk_bf16_f32 v51, v168, v172
  s_add_u32 s33, s32, 0
  buffer_store_dwordx4 v[48:51], v3, s[56:59], s33 offen sc1
  v_cvt_pk_bf16_f32 v52, v145, v149
  v_cvt_pk_bf16_f32 v53, v153, v157
  v_cvt_pk_bf16_f32 v54, v161, v165
  v_cvt_pk_bf16_f32 v55, v169, v173
  s_add_u32 s33, s32, 262144
  buffer_store_dwordx4 v[52:55], v3, s[56:59], s33 offen sc1
  v_cvt_pk_bf16_f32 v56, v146, v150
  v_cvt_pk_bf16_f32 v57, v154, v158
  v_cvt_pk_bf16_f32 v58, v162, v166
  v_cvt_pk_bf16_f32 v59, v170, v174
  s_add_u32 s33, s32, 524288
  buffer_store_dwordx4 v[56:59], v3, s[56:59], s33 offen sc1
  v_cvt_pk_bf16_f32 v60, v147, v151
  v_cvt_pk_bf16_f32 v61, v155, v159
  v_cvt_pk_bf16_f32 v62, v163, v167
  v_cvt_pk_bf16_f32 v63, v171, v175
  s_add_u32 s33, s32, 786432
  buffer_store_dwordx4 v[60:63], v3, s[56:59], s33 offen sc1
  ds_read_b64_tr_b16 v[112:113], v9 offset:8320
  ds_read_b64_tr_b16 v[114:115], v9 offset:10368
  ds_read_b64_tr_b16 v[116:117], v11 offset:8320
  ds_read_b64_tr_b16 v[118:119], v11 offset:10368
  ds_read_b64_tr_b16 v[120:121], v13 offset:8320
  ds_read_b64_tr_b16 v[122:123], v13 offset:10368
  ds_read_b64_tr_b16 v[124:125], v15 offset:8320
  ds_read_b64_tr_b16 v[126:127], v15 offset:10368
  s_waitcnt lgkmcnt(14)
  v_mfma_f32_16x16x32_bf16 v[144:147], v[40:43], v[128:131], 0
  v_mfma_f32_16x16x32_bf16 v[148:151], v[44:47], v[128:131], 0
  s_waitcnt lgkmcnt(12)
  v_mfma_f32_16x16x32_bf16 v[152:155], v[40:43], v[132:135], 0
  v_mfma_f32_16x16x32_bf16 v[156:159], v[44:47], v[132:135], 0
  s_waitcnt lgkmcnt(10)
  v_mfma_f32_16x16x32_bf16 v[160:163], v[40:43], v[136:139], 0
  v_mfma_f32_16x16x32_bf16 v[164:167], v[44:47], v[136:139], 0
  s_waitcnt lgkmcnt(8)
  v_mfma_f32_16x16x32_bf16 v[168:171], v[40:43], v[140:143], 0
  v_mfma_f32_16x16x32_bf16 v[172:175], v[44:47], v[140:143], 0
  v_cvt_pk_bf16_f32 v64, v144, v148
  s_nop 0
  v_cvt_pk_bf16_f32 v65, v152, v156
  s_nop 1
  v_cvt_pk_bf16_f32 v66, v160, v164
  s_nop 1
  v_cvt_pk_bf16_f32 v67, v168, v172
  s_add_u32 s33, s32, 16384
  buffer_store_dwordx4 v[64:67], v3, s[56:59], s33 offen sc1
  v_cvt_pk_bf16_f32 v68, v145, v149
  v_cvt_pk_bf16_f32 v69, v153, v157
  v_cvt_pk_bf16_f32 v70, v161, v165
  v_cvt_pk_bf16_f32 v71, v169, v173
  s_add_u32 s33, s32, 278528
  buffer_store_dwordx4 v[68:71], v3, s[56:59], s33 offen sc1
  v_cvt_pk_bf16_f32 v72, v146, v150
  v_cvt_pk_bf16_f32 v73, v154, v158
  v_cvt_pk_bf16_f32 v74, v162, v166
  v_cvt_pk_bf16_f32 v75, v170, v174
  s_add_u32 s33, s32, 540672
  buffer_store_dwordx4 v[72:75], v3, s[56:59], s33 offen sc1
  v_cvt_pk_bf16_f32 v76, v147, v151
  v_cvt_pk_bf16_f32 v77, v155, v159
  v_cvt_pk_bf16_f32 v78, v163, v167
  v_cvt_pk_bf16_f32 v79, v171, v175
  s_add_u32 s33, s32, 802816
  buffer_store_dwordx4 v[76:79], v3, s[56:59], s33 offen sc1
  ds_read_b64_tr_b16 v[128:129], v9 offset:12480
  ds_read_b64_tr_b16 v[130:131], v9 offset:14528
  ds_read_b64_tr_b16 v[132:133], v11 offset:12480
  ds_read_b64_tr_b16 v[134:135], v11 offset:14528
  ds_read_b64_tr_b16 v[136:137], v13 offset:12480
  ds_read_b64_tr_b16 v[138:139], v13 offset:14528
  ds_read_b64_tr_b16 v[140:141], v15 offset:12480
  ds_read_b64_tr_b16 v[142:143], v15 offset:14528
  s_waitcnt lgkmcnt(14)
  v_mfma_f32_16x16x32_bf16 v[144:147], v[40:43], v[112:115], 0
  v_mfma_f32_16x16x32_bf16 v[148:151], v[44:47], v[112:115], 0
  s_waitcnt lgkmcnt(12)
  v_mfma_f32_16x16x32_bf16 v[152:155], v[40:43], v[116:119], 0
  v_mfma_f32_16x16x32_bf16 v[156:159], v[44:47], v[116:119], 0
  s_waitcnt lgkmcnt(10)
  v_mfma_f32_16x16x32_bf16 v[160:163], v[40:43], v[120:123], 0
  v_mfma_f32_16x16x32_bf16 v[164:167], v[44:47], v[120:123], 0
  s_waitcnt lgkmcnt(8)
  v_mfma_f32_16x16x32_bf16 v[168:171], v[40:43], v[124:127], 0
  v_mfma_f32_16x16x32_bf16 v[172:175], v[44:47], v[124:127], 0
  v_cvt_pk_bf16_f32 v80, v144, v148
  s_nop 0
  v_cvt_pk_bf16_f32 v81, v152, v156
  s_nop 1
  v_cvt_pk_bf16_f32 v82, v160, v164
  s_nop 1
  v_cvt_pk_bf16_f32 v83, v168, v172
  s_add_u32 s33, s32, 32768
  buffer_store_dwordx4 v[80:83], v3, s[56:59], s33 offen sc1
  v_cvt_pk_bf16_f32 v84, v145, v149
  v_cvt_pk_bf16_f32 v85, v153, v157
  v_cvt_pk_bf16_f32 v86, v161, v165
  v_cvt_pk_bf16_f32 v87, v169, v173
  s_add_u32 s33, s32, 294912
  buffer_store_dwordx4 v[84:87], v3, s[56:59], s33 offen sc1
  v_cvt_pk_bf16_f32 v88, v146, v150
  v_cvt_pk_bf16_f32 v89, v154, v158
  v_cvt_pk_bf16_f32 v90, v162, v166
  v_cvt_pk_bf16_f32 v91, v170, v174
  s_add_u32 s33, s32, 557056
  buffer_store_dwordx4 v[88:91], v3, s[56:59], s33 offen sc1
  v_cvt_pk_bf16_f32 v92, v147, v151
  v_cvt_pk_bf16_f32 v93, v155, v159
  v_cvt_pk_bf16_f32 v94, v163, v167
  v_cvt_pk_bf16_f32 v95, v171, v175
  s_add_u32 s33, s32, 819200
  buffer_store_dwordx4 v[92:95], v3, s[56:59], s33 offen sc1
  s_waitcnt lgkmcnt(6)
  v_mfma_f32_16x16x32_bf16 v[144:147], v[40:43], v[128:131], 0
  v_mfma_f32_16x16x32_bf16 v[148:151], v[44:47], v[128:131], 0
  s_waitcnt lgkmcnt(4)
  v_mfma_f32_16x16x32_bf16 v[152:155], v[40:43], v[132:135], 0
  v_mfma_f32_16x16x32_bf16 v[156:159], v[44:47], v[132:135], 0
  s_waitcnt lgkmcnt(2)
  v_mfma_f32_16x16x32_bf16 v[160:163], v[40:43], v[136:139], 0
  v_mfma_f32_16x16x32_bf16 v[164:167], v[44:47], v[136:139], 0
  s_waitcnt lgkmcnt(0)
  v_mfma_f32_16x16x32_bf16 v[168:171], v[40:43], v[140:143], 0
  v_mfma_f32_16x16x32_bf16 v[172:175], v[44:47], v[140:143], 0
  v_cvt_pk_bf16_f32 v96, v144, v148
  s_nop 0
  v_cvt_pk_bf16_f32 v97, v152, v156
  s_nop 1
  v_cvt_pk_bf16_f32 v98, v160, v164
  s_nop 1
  v_cvt_pk_bf16_f32 v99, v168, v172
  s_add_u32 s33, s32, 49152
  buffer_store_dwordx4 v[96:99], v3, s[56:59], s33 offen sc1
  v_cvt_pk_bf16_f32 v100, v145, v149
  v_cvt_pk_bf16_f32 v101, v153, v157
  v_cvt_pk_bf16_f32 v102, v161, v165
  v_cvt_pk_bf16_f32 v103, v169, v173
  s_add_u32 s33, s32, 311296
  buffer_store_dwordx4 v[100:103], v3, s[56:59], s33 offen sc1
  v_cvt_pk_bf16_f32 v104, v146, v150
  v_cvt_pk_bf16_f32 v105, v154, v158
  v_cvt_pk_bf16_f32 v106, v162, v166
  v_cvt_pk_bf16_f32 v107, v170, v174
  s_add_u32 s33, s32, 573440
  buffer_store_dwordx4 v[104:107], v3, s[56:59], s33 offen sc1
  v_cvt_pk_bf16_f32 v108, v147, v151
  v_cvt_pk_bf16_f32 v109, v155, v159
  v_cvt_pk_bf16_f32 v110, v163, v167
  v_cvt_pk_bf16_f32 v111, v171, v175
  s_add_u32 s33, s32, 835584
  buffer_store_dwordx4 v[108:111], v3, s[56:59], s33 offen sc1
  s_barrier
  s_cmp_lt_u32 s5, 4
  s_cbranch_scc0 f_tailu
  v_mbcnt_lo_u32_b32 v147, -1, 0
  v_mbcnt_hi_u32_b32 v147, -1, v147
  s_lshr_b32 s28, s5, 1
  s_and_b32 s29, s5, 1
  v_lshrrev_b32 v148, 4, v147
  s_lshl_b32 s36, s28, 13
  v_lshl_add_u32 v140, v147, 4, s36
  v_bfe_u32 v149, v147, 2, 2
  v_lshl_add_u32 v149, v148, 2, v149
  v_and_b32 v150, 7, v149
  v_lshlrev_b32 v149, 8, v149
  v_and_b32 v151, 3, v147
  v_lshl_add_u32 v149, v151, 3, v149
  v_add_u32 v149, 81920, v149
  s_lshl_b32 s36, s29, 2
  s_add_u32 s37, s36, 0
  v_xor_b32 v151, s37, v150
  v_lshl_add_u32 v141, v151, 5, v149
  s_add_u32 s37, s36, 1
  v_xor_b32 v151, s37, v150
  v_lshl_add_u32 v142, v151, 5, v149
  s_add_u32 s37, s36, 2
  v_xor_b32 v151, s37, v150
  v_lshl_add_u32 v143, v151, 5, v149
  s_add_u32 s37, s36, 3
  v_xor_b32 v151, s37, v150
  v_lshl_add_u32 v144, v151, 5, v149
  v_and_b32 v149, 1, v148
  v_lshrrev_b32 v148, 1, v148
  v_lshl_add_u32 v148, v149, 1, v148
  s_lshl_b32 s36, s29, 3
  v_and_b32 v149, 15, v147
  v_xor_b32 v148, v148, v149
  v_xor_b32 v148, s36, v148
  s_lshl_b32 s36, s28, 14
  s_add_u32 s36, s36, 81920
  v_lshl_add_u32 v149, v149, 8, s36
  v_lshl_add_u32 v145, v148, 4, v149
  v_xor_b32 v146, 64, v145
  v_bfe_u32 v172, v147, 1, 3
  v_lshlrev_b32 v172, 8, v172
  v_add_u32 v172, s2, v172
  v_cvt_f32_u32 v172, v172
  v_mul_f32 v172, 0x3a000000, v172
  v_lshrrev_b32 v170, 4, v147
  v_lshlrev_b32 v170, 1, v170
  v_cvt_f32_u32 v170, v170
  v_and_b32 v171, 1, v147
  v_cvt_f32_u32 v171, v171
  v_mul_f32 v173, v170, v172
  v_fmac_f32 v173, 0xbe800000, v171
  v_add_f32 v170, v173, v172
  v_cos_f32 v164, v173
  v_sin_f32 v165, -v173
  v_cos_f32 v166, v170
  v_sin_f32 v167, -v170
  v_fma_f32 v122, v171, -2.0, 1.0
  v_cmp_gt_u32 vcc, 32, v147
  v_mul_f32 v164, 0x35800000, v164
  v_mul_f32 v165, 0x35800000, v165
  v_mul_f32 v166, 0x35800000, v166
  v_mul_f32 v167, 0x35800000, v167
  v_cndmask_b32 v122, 0, v122, vcc
  v_cvt_pk_bf16_f32 v120, v164, v165
  v_cvt_pk_bf16_f32 v121, v166, v167
  v_and_b32 v173, 0x13, v147
  v_bfe_u32 v172, v147, 2, 1
  v_lshl_or_b32 v173, v172, 3, v173
  v_bfe_u32 v172, v147, 3, 1
  v_lshl_or_b32 v173, v172, 2, v173
  v_cvt_f32_u32 v172, v173
  v_mul_f32 v172, 0x3d000000, v172
  v_lshrrev_b32 v170, 5, v147
  v_cvt_f32_u32 v170, v170
  v_mul_f32 v173, 0x41000000, v170
  v_mul_f32 v173, v173, v172
  v_fmamk_f32 v164, v172, 0x00000000, v173
  v_fmamk_f32 v165, v172, 0x3f800000, v173
  v_cos_f32 v166, v164
  v_cos_f32 v167, v165
  v_sin_f32 v168, v164
  v_sin_f32 v169, v165
  v_cvt_pk_bf16_f32 v124, v166, v167
  v_cvt_pk_bf16_f32 v128, v168, v169
  v_cvt_pk_bf16_f32 v132, -v168, -v169
  v_fmamk_f32 v164, v172, 0x40000000, v173
  v_fmamk_f32 v165, v172, 0x40400000, v173
  v_cos_f32 v166, v164
  v_cos_f32 v167, v165
  v_sin_f32 v168, v164
  v_sin_f32 v169, v165
  v_cvt_pk_bf16_f32 v125, v166, v167
  v_cvt_pk_bf16_f32 v129, v168, v169
  v_cvt_pk_bf16_f32 v133, -v168, -v169
  v_fmamk_f32 v164, v172, 0x40800000, v173
  v_fmamk_f32 v165, v172, 0x40a00000, v173
  v_cos_f32 v166, v164
  v_cos_f32 v167, v165
  v_sin_f32 v168, v164
  v_sin_f32 v169, v165
  v_cvt_pk_bf16_f32 v126, v166, v167
  v_cvt_pk_bf16_f32 v130, v168, v169
  v_cvt_pk_bf16_f32 v134, -v168, -v169
  v_fmamk_f32 v164, v172, 0x40c00000, v173
  v_fmamk_f32 v165, v172, 0x40e00000, v173
  v_cos_f32 v166, v164
  v_cos_f32 v167, v165
  v_sin_f32 v168, v164
  v_sin_f32 v169, v165
  v_cvt_pk_bf16_f32 v127, v166, v167
  v_cvt_pk_bf16_f32 v131, v168, v169
  v_cvt_pk_bf16_f32 v135, -v168, -v169
  v_mul_f32 v172, 0x3d000000, v172
  v_mul_f32 v173, 0x40800000, v170
  v_mul_f32 v173, v173, v172
  v_fmamk_f32 v164, v172, 0x00000000, v173
  v_cos_f32 v64, v164
  v_sin_f32 v80, v164
  v_fmamk_f32 v165, v172, 0x3f800000, v173
  v_cos_f32 v65, v165
  v_sin_f32 v81, v165
  v_fmamk_f32 v164, v172, 0x40000000, v173
  v_cos_f32 v66, v164
  v_sin_f32 v82, v164
  v_fmamk_f32 v165, v172, 0x40400000, v173
  v_cos_f32 v67, v165
  v_sin_f32 v83, v165
  v_fmamk_f32 v164, v172, 0x41000000, v173
  v_cos_f32 v68, v164
  v_sin_f32 v84, v164
  v_fmamk_f32 v165, v172, 0x41100000, v173
  v_cos_f32 v69, v165
  v_sin_f32 v85, v165
  v_fmamk_f32 v164, v172, 0x41200000, v173
  v_cos_f32 v70, v164
  v_sin_f32 v86, v164
  v_fmamk_f32 v165, v172, 0x41300000, v173
  v_cos_f32 v71, v165
  v_sin_f32 v87, v165
  v_fmamk_f32 v164, v172, 0x41800000, v173
  v_cos_f32 v72, v164
  v_sin_f32 v88, v164
  v_fmamk_f32 v165, v172, 0x41880000, v173
  v_cos_f32 v73, v165
  v_sin_f32 v89, v165
  v_fmamk_f32 v164, v172, 0x41900000, v173
  v_cos_f32 v74, v164
  v_sin_f32 v90, v164
  v_fmamk_f32 v165, v172, 0x41980000, v173
  v_cos_f32 v75, v165
  v_sin_f32 v91, v165
  v_fmamk_f32 v164, v172, 0x41c00000, v173
  v_cos_f32 v76, v164
  v_sin_f32 v92, v164
  v_fmamk_f32 v165, v172, 0x41c80000, v173
  v_cos_f32 v77, v165
  v_sin_f32 v93, v165
  v_fmamk_f32 v164, v172, 0x41d00000, v173
  v_cos_f32 v78, v164
  v_sin_f32 v94, v164
  v_fmamk_f32 v165, v172, 0x41d80000, v173
  v_cos_f32 v79, v165
  v_sin_f32 v95, v165
  v_and_b32 v172, 31, v147
  v_cvt_f32_u32 v172, v172
  v_mul_f32 v172, 0x3d000000, v172
  v_mul_f32 v173, 0x40800000, v170
  v_mul_f32 v173, v173, v172
  v_fmamk_f32 v164, v172, 0x00000000, v173
  v_fmamk_f32 v165, v172, 0x3f800000, v173
  v_cos_f32 v166, v164
  v_cos_f32 v167, v165
  v_sin_f32 v168, -v164
  v_sin_f32 v169, -v165
  v_cvt_pk_bf16_f32 v148, v166, v167
  v_cvt_pk_bf16_f32 v156, v168, v169
  v_fmamk_f32 v164, v172, 0x40000000, v173
  v_fmamk_f32 v165, v172, 0x40400000, v173
  v_cos_f32 v166, v164
  v_cos_f32 v167, v165
  v_sin_f32 v168, -v164
  v_sin_f32 v169, -v165
  v_cvt_pk_bf16_f32 v149, v166, v167
  v_cvt_pk_bf16_f32 v157, v168, v169
  v_fmamk_f32 v164, v172, 0x41000000, v173
  v_fmamk_f32 v165, v172, 0x41100000, v173
  v_cos_f32 v166, v164
  v_cos_f32 v167, v165
  v_sin_f32 v168, -v164
  v_sin_f32 v169, -v165
  v_cvt_pk_bf16_f32 v150, v166, v167
  v_cvt_pk_bf16_f32 v158, v168, v169
  v_fmamk_f32 v164, v172, 0x41200000, v173
  v_fmamk_f32 v165, v172, 0x41300000, v173
  v_cos_f32 v166, v164
  v_cos_f32 v167, v165
  v_sin_f32 v168, -v164
  v_sin_f32 v169, -v165
  v_cvt_pk_bf16_f32 v151, v166, v167
  v_cvt_pk_bf16_f32 v159, v168, v169
  v_fmamk_f32 v164, v172, 0x41800000, v173
  v_fmamk_f32 v165, v172, 0x41880000, v173
  v_cos_f32 v166, v164
  v_cos_f32 v167, v165
  v_sin_f32 v168, -v164
  v_sin_f32 v169, -v165
  v_cvt_pk_bf16_f32 v152, v166, v167
  v_cvt_pk_bf16_f32 v160, v168, v169
  v_fmamk_f32 v164, v172, 0x41900000, v173
  v_fmamk_f32 v165, v172, 0x41980000, v173
  v_cos_f32 v166, v164
  v_cos_f32 v167, v165
  v_sin_f32 v168, -v164
  v_sin_f32 v169, -v165
  v_cvt_pk_bf16_f32 v153, v166, v167
  v_cvt_pk_bf16_f32 v161, v168, v169
  v_fmamk_f32 v164, v172, 0x41c00000, v173
  v_fmamk_f32 v165, v172, 0x41c80000, v173
  v_cos_f32 v166, v164
  v_cos_f32 v167, v165
  v_sin_f32 v168, -v164
  v_sin_f32 v169, -v165
  v_cvt_pk_bf16_f32 v154, v166, v167
  v_cvt_pk_bf16_f32 v162, v168, v169
  v_fmamk_f32 v164, v172, 0x41d00000, v173
  v_fmamk_f32 v165, v172, 0x41d80000, v173
  v_cos_f32 v166, v164
  v_cos_f32 v167, v165
  v_sin_f32 v168, -v164
  v_sin_f32 v169, -v165
  v_cvt_pk_bf16_f32 v155, v166, v167
  v_cvt_pk_bf16_f32 v163, v168, v169
  v_and_b32 v164, 15, v147
  v_lshrrev_b32 v166, 4, v147
  v_lshlrev_b32 v165, 3, v166
  v_and_b32 v167, 7, v147
  v_lshlrev_b32 v167, 4, v167
  v_xor_b32 v165, v165, v167
  v_lshl_add_u32 v165, v164, 10, v165
  s_lshl_b32 s28, s5, 8
  s_add_u32 s28, s28, 65536
  v_add_u32 v136, s28, v165
  v_xor_b32 v137, 32, v136
  v_xor_b32 v138, 64, v136
  v_xor_b32 v139, 96, v136
  v_lshrrev_b32 v165, 1, v164
  s_lshl_b32 s28, s5, 1
  v_xor_b32 v165, s28, v165
  v_lshlrev_b32 v165, 4, v165
  v_lshl_add_u32 v165, v164, 7, v165
  v_lshl_add_u32 v165, v166, 12, v165
  v_add_u32 v178, 147456, v165
  v_xor_b32 v179, 16, v178
  s_lshl_b32 s28, s5, 11
  s_add_u32 s28, s28, 65536
  s_lshl_b32 s29, s5, 5
  v_and_b32 v164, 31, v147
  v_lshlrev_b32 v164, 5, v164
  v_lshrrev_b32 v165, 5, v147
  v_lshl_add_u32 v164, v165, 4, v164
  v_xor_b32 v164, s29, v164
  v_add_u32 v176, s28, v164
  v_xor_b32 v177, 16, v176
  s_add_u32 s28, s28, s29
  s_add_u32 s28, s28, 16
  v_mov_b32 v123, s28
  v_and_b32 v164, 15, v147
  v_lshlrev_b32 v180, 6, v164
  v_bfe_u32 v164, v147, 4, 1
  v_lshl_add_u32 v180, v164, 5, v180
  v_lshrrev_b32 v164, 5, v147
  v_lshl_add_u32 v180, v164, 4, v180
  s_branch f_g2go
f_tailu:
  s_sub_u32 s5, s5, 4
  v_lshlrev_b32 v1, 4, v0
  s_branch f_tailh
f_exit:
  s_endpgm
.section .rodata,"a"
.p2align 6
.amdhsa_kernel fused_kernel
  .amdhsa_next_free_vgpr 256
  .amdhsa_next_free_sgpr 76
  .amdhsa_accum_offset 256
  .amdhsa_group_segment_fixed_size 0
  .amdhsa_kernarg_size 88
  .amdhsa_user_sgpr_count 2
  .amdhsa_user_sgpr_kernarg_segment_ptr 1
  .amdhsa_system_sgpr_workgroup_id_x 1
  .amdhsa_float_denorm_mode_32 3
.end_amdhsa_kernel
```
